```python
import torch

def _softmax(x, axis=-1):
    return torch.softmax(x, dim=axis)

def _gelu(x):
    return torch.nn.functional.gelu(x, approximate='tanh')

def _silu(x):
    return torch.nn.functional.silu(x)

def _sigmoid(x):
    return torch.sigmoid(x)

def _layernorm(x, axis=-1, eps=1e-05):
    m = x.mean(dim=axis, keepdim=True)
    v = x.var(dim=axis, keepdim=True, unbiased=False)
    return (x - m) / torch.sqrt(v + eps)

def _scatter_add(tgt, idx, src, axis=0):
    return tgt.clone().index_add_(axis, idx, src)

def _segment_sum(src, seg, n):
    out = torch.zeros((n,) + src.shape[1:], dtype=src.dtype)
    return out.index_add_(0, seg, src)

def _pad(x, pw):
    flat = tuple((v for pair in reversed(pw) for v in pair))
    return torch.nn.functional.pad(x, flat)
kernel_name = 'sequential_preLN__softmax_full_mha__mixer_gmlp__prompt'

def setup_inputs():

    _w = lambda a: (lambda t: t.to(torch.bfloat16) if t.is_floating_point() else t)(torch.as_tensor(a))

    def _A_setup():
        B, S, D = (1, 2048, 448)
        return {'x': _w((lambda *s: torch.randn(*s, dtype=torch.bfloat16) * 0.05)(B, S, D)), 'wqkv': _w((lambda *s: torch.randn(*s, dtype=torch.bfloat16) * 0.05)(D, 3 * D)), 'wo': _w((lambda *s: torch.randn(*s, dtype=torch.bfloat16) * 0.05)(D, D))}
    _A_in = _A_setup()

    def _B_setup():
        B, S, D, F = (1, 2048, 448, 1792)
        Fh = F // 2
        return {'x': _w((lambda *s: torch.randn(*s, dtype=torch.bfloat16) * 0.05)(B, S, D)), 'w_in': _w((lambda *s: torch.randn(*s, dtype=torch.bfloat16) * 0.4)(D, 2 * Fh)), 'w_sp': _w(0.01 * (lambda *s: torch.randn(*s, dtype=torch.bfloat16) * 0.4)(S, S)), 'b_sp': _w(1.0 + 0.01 * (lambda *s: torch.randn(*s, dtype=torch.bfloat16) * 0.05)(S)), 'w_out': _w((lambda *s: torch.randn(*s, dtype=torch.bfloat16) * 0.05)(Fh, D))}
    _B_in = _B_setup()
    return {'A_x': _A_in['x'], 'A_wqkv': _A_in['wqkv'], 'A_wo': _A_in['wo'], 'B_x': _B_in['x'], 'B_w_in': _B_in['w_in'], 'B_w_sp': _B_in['w_sp'], 'B_b_sp': _B_in['b_sp'], 'B_w_out': _B_in['w_out']}

def reference(A_x, A_wqkv, A_wo, B_x, B_w_in, B_w_sp, B_b_sp, B_w_out):

    def _A_ref(x, wqkv, wo):
        B, S, D = x.shape
        H = 16
        Dh = D // H
        qkv = (lambda x, *d: x.permute(*d))((x @ wqkv).reshape(B, S, 3, H, Dh), 2, 0, 3, 1, 4)
        q, k, v = (qkv[0], qkv[1], qkv[2])
        scale = Dh ** (-0.5)
        scores = torch.einsum('bhqd,bhkd->bhqk', q, k) * scale
        p = _softmax(scores, axis=-1)
        o = torch.einsum('bhqk,bhkd->bhqd', p, v)
        return (lambda x, *d: x.permute(*d))(o, 0, 2, 1, 3).reshape(B, S, D) @ wo

    def _B_ref(x, w_in, w_sp, b_sp, w_out):
        B, S, D = x.shape
        F = w_in.shape[-1]
        Fh = F // 2
        z = _gelu(torch.einsum('bsd,df->bsf', x, w_in))
        z1 = z[..., :Fh].clone()
        z2 = _layernorm(z[..., Fh:], axis=-1)
        g = torch.einsum('ts,bsf->btf', w_sp, z2) + b_sp[None, :, None]
        return torch.einsum('bsf,fd->bsd', z1 * g, w_out)
    x = A_x
    h = x + _A_ref(_layernorm(x, axis=-1), A_wqkv, A_wo)
    h2 = h + _B_ref(_layernorm(h, axis=-1), B_w_in, B_w_sp, B_b_sp, B_w_out)
    return h2
```

```asm
; @launch grid=(256,1,1) block=(256,1,1) lds=163840
.amdgcn_target "amdgcn-amd-amdhsa--gfx950"
.text
.globl sequential_preLN__softmax_full_mha__mixer_gmlp__prompt_kernel
.p2align 8
.type sequential_preLN__softmax_full_mha__mixer_gmlp__prompt_kernel,@function
sequential_preLN__softmax_full_mha__mixer_gmlp__prompt_kernel:
    s_getpc_b64 s[86:87]
.Lpc0:
    s_cmp_ge_u32 s2, 256
    s_cbranch_scc1 .Lend
    s_load_dwordx2 s[8:9], s[0:1], 0
    s_load_dwordx2 s[12:13], s[0:1], 8
    s_load_dwordx2 s[16:17], s[0:1], 80
    s_load_dwordx2 s[36:37], s[0:1], 16
    s_load_dwordx2 s[40:41], s[0:1], 32
    s_load_dwordx2 s[20:21], s[0:1], 40
    s_load_dwordx2 s[24:25], s[0:1], 48
    s_load_dwordx2 s[44:45], s[0:1], 56
    s_load_dwordx2 s[28:29], s[0:1], 64
    s_load_dwordx2 s[32:33], s[0:1], 72
    v_lshrrev_b32 v6, 6, v0
    v_and_b32 v0, 63, v0
    v_readfirstlane_b32 s48, v6
    s_mov_b32 s10, 1835008
    s_mov_b32 s11, 0x20000
    s_mov_b32 s14, 1204224
    s_mov_b32 s15, 0x20000
    s_mov_b32 s18, 25165824
    s_mov_b32 s19, 0x20000
    s_mov_b32 s38, 401408
    s_mov_b32 s39, 0x20000
    s_mov_b32 s42, 1605632
    s_mov_b32 s43, 0x20000
    s_mov_b32 s22, 8392704
    s_mov_b32 s23, 0x20000
    s_mov_b32 s26, 4096
    s_mov_b32 s27, 0x20000
    s_mov_b32 s46, 802816
    s_mov_b32 s47, 0x20000
    s_mov_b32 s30, 1835008
    s_mov_b32 s31, 0x20000
    s_mov_b32 s34, 256
    s_mov_b32 s35, 0x20000
    v_lshlrev_b32 v1, 4, v0
    v_and_b32 v2, 15, v0
    v_lshrrev_b32 v3, 4, v0
    v_add_u32 v4, 0x10000, v1
    v_add_u32 v5, 0x20000, v1
    v_mov_b32 v225, 1
    s_and_b32 s53, s2, 7
    s_lshr_b32 s54, s2, 3
    s_lshr_b32 s57, s53, 1
    s_and_b32 s58, s53, 1
    s_mov_b32 s59, 400000
    s_mov_b32 s60, 0
    s_lshr_b32 s62, s54, 2
    s_lshl_b32 s49, s57, 3
    s_add_u32 s49, s49, s62
    s_and_b32 s62, s54, 3
    s_lshl_b32 s50, s58, 2
    s_add_u32 s50, s50, s62
    s_lshl_b32 s61, s49, 2
    s_add_u32 s61, s61, s48
    s_and_b32 s62, s54, 1
    s_lshl_b32 s52, s53, 1
    s_add_u32 s52, s52, s62
    s_lshr_b32 s51, s54, 1
    s_and_b32 s62, s53, 1
    s_lshl_b32 s62, s62, 2
    s_lshr_b32 s63, s54, 3
    s_add_u32 s56, s62, s63
    s_lshr_b32 s62, s53, 1
    s_lshl_b32 s62, s62, 3
    s_and_b32 s63, s54, 7
    s_add_u32 s55, s62, s63
    s_lshl_b32 s62, s53, 2
    s_add_u32 s62, s62, s63
    s_cmp_ge_u32 s54, 24
    s_cselect_b32 s56, 3, s56
    s_cselect_b32 s55, s62, s55
    s_waitcnt lgkmcnt(0)
    s_sub_u32 s20, s20, 4096
    s_subb_u32 s21, s21, 0
    s_cmp_ge_u32 s54, 28
    s_cbranch_scc1 .Lspare
    v_lshrrev_b32 v6, 3, v0
    v_and_b32 v7, 7, v0
    v_xor_b32 v8, v7, v3
    v_mul_u32_u24 v152, 896, v6
    v_xor_b32 v9, 4, v8
    v_lshl_add_u32 v153, v9, 4, v152
    v_lshl_add_u32 v152, v8, 4, v152
    v_add_u32 v153, 6144, v153
    v_and_b32 v8, 1, v3
    v_lshlrev_b32 v8, 1, v8
    v_xor_b32 v8, v8, v7
    v_mul_u32_u24 v154, 2688, v6
    v_xor_b32 v9, 4, v8
    v_lshl_add_u32 v155, v9, 4, v154
    v_lshl_add_u32 v154, v8, 4, v154
    v_add_u32 v155, 20480, v155
    s_lshl_b32 s62, s55, 2
    s_add_u32 s62, s62, s48
    s_mul_i32 s74, s62, 14336
    s_mul_i32 s75, s48, 43008
    s_lshl_b32 s62, s56, 7
    s_add_u32 s75, s75, s62
    s_lshl_b32 s76, s48, 11
    s_and_b32 s77, s55, 7
    s_and_b32 s62, s56, 3
    s_lshl_b32 s62, s62, 1
    s_add_u32 s77, s77, s62
    s_sub_u32 s62, s77, 7
    s_cmp_ge_u32 s77, 7
    s_cselect_b32 s77, s62, s77
    s_lshl_b32 s66, s77, 7
    s_mul_i32 s67, s77, 172032
    s_add_u32 s66, s66, s74
    s_add_u32 s67, s67, s75
    s_add_u32 m0, s76, 0
    s_nop 0
    buffer_load_dwordx4 v152, s[8:11], s66 offen lds
    buffer_load_dwordx4 v153, s[8:11], s66 offen offset:1024 lds
    s_add_u32 m0, s76, 8192
    s_nop 0
    buffer_load_dwordx4 v154, s[12:15], s67 offen lds
    buffer_load_dwordx4 v155, s[12:15], s67 offen offset:1024 lds
    s_add_u32 m0, s76, 16384
    s_add_u32 s67, s67, 896
    buffer_load_dwordx4 v154, s[12:15], s67 offen lds
    buffer_load_dwordx4 v155, s[12:15], s67 offen offset:1024 lds
    s_add_u32 m0, s76, 24576
    s_add_u32 s67, s67, 896
    buffer_load_dwordx4 v154, s[12:15], s67 offen lds
    buffer_load_dwordx4 v155, s[12:15], s67 offen offset:1024 lds
    s_add_u32 s77, s77, 1
    s_cmp_eq_u32 s77, 7
    s_cselect_b32 s77, 0, s77
    s_lshl_b32 s66, s77, 7
    s_mul_i32 s67, s77, 172032
    s_add_u32 s66, s66, s74
    s_add_u32 s67, s67, s75
    s_add_u32 m0, s76, 32768
    s_nop 0
    buffer_load_dwordx4 v152, s[8:11], s66 offen lds
    buffer_load_dwordx4 v153, s[8:11], s66 offen offset:1024 lds
    s_add_u32 m0, s76, 40960
    s_nop 0
    buffer_load_dwordx4 v154, s[12:15], s67 offen lds
    buffer_load_dwordx4 v155, s[12:15], s67 offen offset:1024 lds
    s_add_u32 m0, s76, 49152
    s_add_u32 s67, s67, 896
    buffer_load_dwordx4 v154, s[12:15], s67 offen lds
    buffer_load_dwordx4 v155, s[12:15], s67 offen offset:1024 lds
    s_add_u32 m0, s76, 57344
    s_add_u32 s67, s67, 896
    buffer_load_dwordx4 v154, s[12:15], s67 offen lds
    buffer_load_dwordx4 v155, s[12:15], s67 offen offset:1024 lds
    v_lshrrev_b32 v6, 1, v2
    v_xor_b32 v6, v6, v3
    v_lshlrev_b32 v6, 4, v6
    v_lshl_add_u32 v156, v2, 7, v6
    v_xor_b32 v157, 64, v156
    v_add_u32 v158, s76, v156
    v_add_u32 v159, s76, v157
    v_lshrrev_b32 v6, 2, v2
    v_lshl_add_u32 v160, v3, 3, v6
    v_lshlrev_b32 v160, 7, v160
    v_lshrrev_b32 v6, 3, v2
    v_and_b32 v7, 1, v3
    v_lshl_add_u32 v6, v7, 1, v6
    v_xor_b32 v6, s48, v6
    v_lshl_add_u32 v160, v6, 5, v160
    v_and_b32 v6, 3, v2
    v_lshl_add_u32 v160, v6, 3, v160
    v_mov_b32 v148, 0x3f803f80
    v_mov_b32 v149, 0x3f803f80
    v_mov_b32 v150, 0x3f803f80
    v_mov_b32 v151, 0x3f803f80
    v_and_b32 v6, 1, v2
    v_cmp_ne_u32 s[68:69], 0, v6
    v_and_b32 v6, 2, v2
    v_cmp_ne_u32 s[70:71], 0, v6
    v_lshrrev_b32 v6, 2, v2
    v_lshl_add_u32 v6, v6, 4, v2
    v_lshlrev_b32 v161, 2, v6
    s_lshl_b32 s62, s56, 2
    s_add_u32 s78, s62, s48
    s_lshl_b32 s62, s78, 1
    v_lshrrev_b32 v164, 1, v3
    v_add_u32 v164, s62, v164
    v_mul_u32_u24 v165, 37, v164
    v_lshrrev_b32 v165, 8, v165
    v_mul_u32_u24 v166, 7, v165
    v_sub_u32 v164, v164, v166
    v_cmp_eq_u32 s[72:73], 3, v164
    v_lshrrev_b32 v166, 2, v164
    v_lshl_add_u32 v165, v165, 1, v166
    v_and_b32 v166, 3, v164
    v_lshlrev_b32 v166, 9, v166
    v_lshl_add_u32 v167, v165, 17, v166
    v_lshl_add_u32 v168, v165, 18, v166
    v_and_b32 v166, 31, v0
    v_lshl_add_u32 v167, v166, 4, v167
    v_and_b32 v166, 8, v2
    v_add_u32 v166, v166, v2
    v_and_b32 v164, 1, v3
    v_lshl_add_u32 v166, v164, 3, v166
    v_lshl_add_u32 v168, v166, 4, v168
    v_mov_b32 v166, 2130706432
    v_add_u32 v169, 0x20000, v167
    v_add_u32 v170, 0x40000, v168
    v_cndmask_b32 v169, v166, v169, s[72:73]
    v_cndmask_b32 v170, v166, v170, s[72:73]
    s_lshl_b32 s62, s78, 4
    v_add_u32 v164, s62, v2
    v_mul_u32_u24 v165, 2341, v164
    v_lshrrev_b32 v165, 16, v165
    v_mul_u32_u24 v171, 28, v165
    v_sub_u32 v164, v164, v171
    v_lshlrev_b32 v171, 18, v165
    v_lshl_add_u32 v171, v3, 9, v171
    v_lshl_add_u32 v171, v164, 4, v171
    v_cmp_le_u32 vcc, 24, v164
    v_add_u32 v172, 64, v171
    s_nop 0
    v_cndmask_b32 v172, v166, v172, vcc
    v_cmp_eq_u32 vcc, 24, v164
    v_mov_b32 v174, 0x3f803f80
    v_mov_b32 v175, 0x3f80
    v_cndmask_b32 v176, 0, v174, vcc
    v_mov_b32 v177, v176
    v_mov_b32 v178, v176
    v_mov_b32 v179, v176
    s_lshl_b32 s62, s78, 2
    s_lshr_b32 s63, s55, 3
    s_add_u32 s62, s62, s63
    s_lshl_b32 s62, s62, 8
    v_lshlrev_b32 v173, 7, v0
    v_add_u32 v173, s62, v173
    s_lshl_b32 s62, s48, 7
    s_add_u32 s62, s62, 159744
    v_lshlrev_b32 v180, 3, v2
    v_add_u32 v165, s62, v180
    v_add_u32 v180, 159744, v180
    v_lshlrev_b32 v181, 5, v3
    v_add_u32 v181, 159744, v181
    s_lshl_b32 s88, s55, 12
    s_add_u32 s88, s88, 1048576
    s_lshl_b32 s89, s55, 13
    s_add_u32 s89, s89, 3145728
    s_add_u32 s90, s89, 4096
    s_cmp_ge_u32 s61, 56
    s_cselect_b32 s62, 1, 0
    s_mul_i32 s63, s62, 56
    s_sub_u32 s63, s61, s63
    s_lshr_b32 s63, s63, 2
    s_and_b32 s64, s61, 3
    s_mul_i32 s94, s63, 114688
    s_mul_i32 s65, s50, 224
    s_add_u32 s94, s94, s65
    s_lshl_b32 s65, s64, 6
    s_add_u32 s94, s94, s65
    s_xor_b32 s65, s62, 1
    s_mul_i32 s65, s65, 1792
    s_add_u32 s94, s94, s65
    s_lshl_b32 s95, s50, 1
    s_add_u32 s95, s95, s62
    s_mul_i32 s95, s95, 105
    s_mul_i32 s65, s63, 7
    s_add_u32 s95, s95, s65
    s_lshl_b32 s65, s64, 1
    s_add_u32 s95, s95, s65
    s_lshl_b32 s95, s95, 10
    s_add_u32 s95, s95, 20971520
    s_cmp_ge_u32 s61, 112
    s_cselect_b32 s94, 2130706432, s94
    s_cselect_b32 s95, 2130706432, s95
    s_cmp_eq_u32 s64, 3
    s_cselect_b64 vcc, -1, 0
    s_mul_i32 s66, s48, 4096
    s_add_u32 s66, s66, 131072
    v_and_b32 v7, 3, v2
    v_add_u32 v252, s66, v1
    v_and_b32 v6, 60, v0
    v_lshrrev_b32 v253, 1, v7
    v_add_u32 v6, v6, v253
    v_lshlrev_b32 v6, 4, v6
    v_and_b32 v253, 1, v7
    v_lshl_add_u32 v6, v253, 3, v6
    v_add_u32 v6, s66, v6
    v_mov_b32 v238, 2130706432
    v_cndmask_b32 v253, v252, v6, vcc
    v_cndmask_b32 v238, v1, v238, vcc
    v_lshrrev_b32 v8, 2, v2
    v_lshl_add_u32 v6, v3, 3, v8
    v_mul_u32_u24 v240, 3584, v6
    v_lshl_add_u32 v240, v7, 4, v240
    v_lshrrev_b32 v241, 1, v3
    v_lshlrev_b32 v241, 4, v241
    v_and_b32 v9, 1, v3
    v_lshl_add_u32 v241, v9, 2, v241
    v_add_u32 v241, v241, v8
    s_mov_b32 s101, 3584
    s_mov_b32 s63, 28672
    s_mov_b32 s65, 23068672
    s_cmp_ge_u32 s61, 96
    s_cselect_b64 vcc, -1, 0
    s_cselect_b64 s[4:5], s[36:37], s[44:45]
    s_cselect_b32 s6, s38, s46
    s_cselect_b32 s101, 7168, s101
    s_cselect_b32 s62, 96, 0
    s_cselect_b32 s63, 25088, s63
    s_cselect_b32 s64, 16, 28
    s_cselect_b32 s65, 19922944, s65
    s_mov_b32 s7, 0x20000
    s_sub_u32 s62, s61, s62
    s_lshr_b32 s62, s62, 1
    s_mul_i32 s3, s62, s63
    s_mul_i32 s63, s50, 112
    s_add_u32 s3, s3, s63
    s_and_b32 s63, s61, 1
    s_lshl_b32 s66, s63, 6
    s_add_u32 s3, s3, s66
    s_mul_i32 s81, s50, s64
    s_add_u32 s81, s81, s62
    s_lshl_b32 s81, s81, 1
    s_add_u32 s81, s81, s63
    s_lshl_b32 s81, s81, 11
    s_add_u32 s81, s81, s65
    s_sub_u32 s62, s61, 56
    s_cmp_lt_u32 s62, 40
    s_cselect_b32 s3, 2130706432, s3
    s_cselect_b32 s81, 2130706432, s81
    v_cndmask_b32 v241, v6, v241, vcc
    v_mul_u32_u24 v241, 896, v241
    v_lshl_add_u32 v241, v7, 4, v241
    s_lshl_b32 s62, s61, 3
    s_add_u32 s62, s62, s50
    s_lshl_b32 s62, s62, 7
    s_add_u32 s62, s62, 131072
    v_mov_b32 v8, -1
    v_mov_b32 v9, -1
    v_mov_b32 v10, -1
    v_mov_b32 v11, -1
    s_mov_b64 exec, 0xff
    buffer_store_dwordx4 v[8:11], v1, s[16:19], s62 offen sc1
    s_mov_b64 exec, -1
    s_mul_i32 s91, s61, 14336
    s_mul_i32 s92, s50, 1792
    s_add_u32 s91, s91, s92
    s_add_u32 s91, s91, 9437184
    v_cmp_eq_u32 vcc, 3, v3
    v_mov_b32 v245, 2130706432
    s_nop 0
    v_cndmask_b32 v245, v1, v245, vcc
    v_mov_b32 v248, -1
    v_mov_b32 v249, -1
    v_mov_b32 v250, -1
    v_mov_b32 v251, -1
    s_waitcnt vmcnt(9)
    s_barrier
    ds_read_b64_tr_b16 v[128:129], v160 offset:16384
    ds_read_b64_tr_b16 v[130:131], v160 offset:16896
    ds_read_b128 v[84:87], v156
    ds_read_b128 v[88:91], v156 offset:2048
    ds_read_b128 v[92:95], v156 offset:4096
    ds_read_b128 v[96:99], v156 offset:6144
    ds_read_b64_tr_b16 v[132:133], v160 offset:24576
    ds_read_b64_tr_b16 v[134:135], v160 offset:25088
    ds_read_b64_tr_b16 v[124:125], v160 offset:8192
    ds_read_b64_tr_b16 v[126:127], v160 offset:8704
    ds_read_b128 v[100:103], v158
    s_waitcnt lgkmcnt(8)
    v_mfma_f32_16x16x32_bf16 v[32:35], v[128:131], v[84:87], 0
    s_add_u32 s77, s77, 1
    ds_read_b64_tr_b16 v[140:141], v160 offset:20480
    s_waitcnt lgkmcnt(8)
    v_mfma_f32_16x16x32_bf16 v[36:39], v[128:131], v[88:91], 0
    s_cmp_eq_u32 s77, 7
    s_cselect_b32 s77, 0, s77
    ds_read_b64_tr_b16 v[142:143], v160 offset:20992
    s_waitcnt lgkmcnt(8)
    v_mfma_f32_16x16x32_bf16 v[40:43], v[128:131], v[92:95], 0
    s_lshl_b32 s66, s77, 7
    s_waitcnt lgkmcnt(7)
    v_mfma_f32_16x16x32_bf16 v[44:47], v[128:131], v[96:99], 0
    s_mul_i32 s67, s77, 172032
    ds_read_b128 v[104:107], v157
    v_mfma_f32_16x16x32_bf16 v[68:71], v[128:131], v[148:151], 0
    s_add_u32 s66, s66, s74
    ds_read_b128 v[108:111], v157 offset:2048
    s_waitcnt lgkmcnt(7)
    v_mfma_f32_16x16x32_bf16 v[48:51], v[84:87], v[132:135], 0
    s_add_u32 s67, s67, s75
    v_mfma_f32_16x16x32_bf16 v[52:55], v[88:91], v[132:135], 0
    s_add_u32 m0, s76, 65536
    ds_read_b128 v[112:115], v157 offset:4096
    v_mfma_f32_16x16x32_bf16 v[56:59], v[92:95], v[132:135], 0
    ds_read_b128 v[116:119], v157 offset:6144
    v_mfma_f32_16x16x32_bf16 v[60:63], v[96:99], v[132:135], 0
    buffer_load_dwordx4 v152, s[8:11], s66 offen lds
    v_mfma_f32_16x16x32_bf16 v[72:75], v[148:151], v[132:135], 0
    ds_read_b64_tr_b16 v[144:145], v160 offset:28672
    s_waitcnt lgkmcnt(8)
    v_mfma_f32_16x16x32_bf16 v[16:19], v[124:127], v[84:87], 0
    ds_read_b64_tr_b16 v[146:147], v160 offset:29184
    v_mfma_f32_16x16x32_bf16 v[20:23], v[124:127], v[88:91], 0
    buffer_load_dwordx4 v153, s[8:11], s66 offen offset:1024 lds
    v_mfma_f32_16x16x32_bf16 v[24:27], v[124:127], v[92:95], 0
    s_add_u32 m0, s76, 73728
    ds_read_b64_tr_b16 v[136:137], v160 offset:12288
    v_mfma_f32_16x16x32_bf16 v[28:31], v[124:127], v[96:99], 0
    ds_read_b64_tr_b16 v[138:139], v160 offset:12800
    v_mfma_f32_16x16x32_bf16 v[64:67], v[124:127], v[148:151], 0
    buffer_load_dwordx4 v154, s[12:15], s67 offen lds
    s_waitcnt lgkmcnt(10)
    v_mfma_f32_16x16x32_bf16 v[76:79], v[148:151], v[100:103], 0
    ds_read_b128 v[120:123], v159
    v_mfma_f32_16x16x32_bf16 v[80:83], v[100:103], v[100:103], 0
    buffer_load_dwordx4 v155, s[12:15], s67 offen offset:1024 lds
    s_add_u32 m0, s76, 81920
    s_add_u32 s67, s67, 896
    buffer_load_dwordx4 v154, s[12:15], s67 offen lds
    buffer_load_dwordx4 v155, s[12:15], s67 offen offset:1024 lds
    s_add_u32 m0, s76, 90112
    s_add_u32 s67, s67, 896
    buffer_load_dwordx4 v154, s[12:15], s67 offen lds
    buffer_load_dwordx4 v155, s[12:15], s67 offen offset:1024 lds
    s_waitcnt vmcnt(9)
    s_barrier
    s_waitcnt lgkmcnt(8)
    v_mfma_f32_16x16x32_bf16 v[32:35], v[140:143], v[104:107], v[32:35]
    s_add_u32 s77, s77, 1
    ds_read_b64_tr_b16 v[128:129], v160 offset:49152
    s_waitcnt lgkmcnt(8)
    v_mfma_f32_16x16x32_bf16 v[36:39], v[140:143], v[108:111], v[36:39]
    s_cmp_eq_u32 s77, 7
    s_cselect_b32 s77, 0, s77
    ds_read_b64_tr_b16 v[130:131], v160 offset:49664
    s_waitcnt lgkmcnt(8)
    v_mfma_f32_16x16x32_bf16 v[40:43], v[140:143], v[112:115], v[40:43]
    s_lshl_b32 s66, s77, 7
    s_waitcnt lgkmcnt(7)
    v_mfma_f32_16x16x32_bf16 v[44:47], v[140:143], v[116:119], v[44:47]
    s_mul_i32 s67, s77, 172032
    ds_read_b128 v[84:87], v156 offset:32768
    v_mfma_f32_16x16x32_bf16 v[68:71], v[140:143], v[148:151], v[68:71]
    s_add_u32 s66, s66, s74
    ds_read_b128 v[88:91], v156 offset:34816
    s_waitcnt lgkmcnt(7)
    v_mfma_f32_16x16x32_bf16 v[48:51], v[104:107], v[144:147], v[48:51]
    s_add_u32 s67, s67, s75
    v_mfma_f32_16x16x32_bf16 v[52:55], v[108:111], v[144:147], v[52:55]
    s_add_u32 m0, s76, 98304
    ds_read_b128 v[92:95], v156 offset:36864
    v_mfma_f32_16x16x32_bf16 v[56:59], v[112:115], v[144:147], v[56:59]
    ds_read_b128 v[96:99], v156 offset:38912
    v_mfma_f32_16x16x32_bf16 v[60:63], v[116:119], v[144:147], v[60:63]
    buffer_load_dwordx4 v152, s[8:11], s66 offen lds
    v_mfma_f32_16x16x32_bf16 v[72:75], v[148:151], v[144:147], v[72:75]
    ds_read_b64_tr_b16 v[132:133], v160 offset:57344
    s_waitcnt lgkmcnt(8)
    v_mfma_f32_16x16x32_bf16 v[16:19], v[136:139], v[104:107], v[16:19]
    ds_read_b64_tr_b16 v[134:135], v160 offset:57856
    v_mfma_f32_16x16x32_bf16 v[20:23], v[136:139], v[108:111], v[20:23]
    buffer_load_dwordx4 v153, s[8:11], s66 offen offset:1024 lds
    v_mfma_f32_16x16x32_bf16 v[24:27], v[136:139], v[112:115], v[24:27]
    s_add_u32 m0, s76, 106496
    ds_read_b64_tr_b16 v[124:125], v160 offset:40960
    v_mfma_f32_16x16x32_bf16 v[28:31], v[136:139], v[116:119], v[28:31]
    ds_read_b64_tr_b16 v[126:127], v160 offset:41472
    v_mfma_f32_16x16x32_bf16 v[64:67], v[136:139], v[148:151], v[64:67]
    buffer_load_dwordx4 v154, s[12:15], s67 offen lds
    s_waitcnt lgkmcnt(10)
    v_mfma_f32_16x16x32_bf16 v[76:79], v[148:151], v[120:123], v[76:79]
    ds_read_b128 v[100:103], v158 offset:32768
    v_mfma_f32_16x16x32_bf16 v[80:83], v[120:123], v[120:123], v[80:83]
    buffer_load_dwordx4 v155, s[12:15], s67 offen offset:1024 lds
    s_waitcnt lgkmcnt(8)
    v_mfma_f32_16x16x32_bf16 v[32:35], v[128:131], v[84:87], v[32:35]
    s_add_u32 m0, s76, 114688
    ds_read_b64_tr_b16 v[140:141], v160 offset:53248
    s_waitcnt lgkmcnt(8)
    v_mfma_f32_16x16x32_bf16 v[36:39], v[128:131], v[88:91], v[36:39]
    s_add_u32 s67, s67, 896
    ds_read_b64_tr_b16 v[142:143], v160 offset:53760
    s_waitcnt lgkmcnt(8)
    v_mfma_f32_16x16x32_bf16 v[40:43], v[128:131], v[92:95], v[40:43]
    buffer_load_dwordx4 v154, s[12:15], s67 offen lds
    s_waitcnt lgkmcnt(7)
    v_mfma_f32_16x16x32_bf16 v[44:47], v[128:131], v[96:99], v[44:47]
    ds_read_b128 v[104:107], v157 offset:32768
    v_mfma_f32_16x16x32_bf16 v[68:71], v[128:131], v[148:151], v[68:71]
    ds_read_b128 v[108:111], v157 offset:34816
    s_waitcnt lgkmcnt(7)
    v_mfma_f32_16x16x32_bf16 v[48:51], v[84:87], v[132:135], v[48:51]
    buffer_load_dwordx4 v155, s[12:15], s67 offen offset:1024 lds
    v_mfma_f32_16x16x32_bf16 v[52:55], v[88:91], v[132:135], v[52:55]
    s_add_u32 m0, s76, 122880
    ds_read_b128 v[112:115], v157 offset:36864
    v_mfma_f32_16x16x32_bf16 v[56:59], v[92:95], v[132:135], v[56:59]
    s_add_u32 s67, s67, 896
    ds_read_b128 v[116:119], v157 offset:38912
    v_mfma_f32_16x16x32_bf16 v[60:63], v[96:99], v[132:135], v[60:63]
    buffer_load_dwordx4 v154, s[12:15], s67 offen lds
    v_mfma_f32_16x16x32_bf16 v[72:75], v[148:151], v[132:135], v[72:75]
    ds_read_b64_tr_b16 v[144:145], v160 offset:61440
    s_waitcnt lgkmcnt(8)
    v_mfma_f32_16x16x32_bf16 v[16:19], v[124:127], v[84:87], v[16:19]
    ds_read_b64_tr_b16 v[146:147], v160 offset:61952
    v_mfma_f32_16x16x32_bf16 v[20:23], v[124:127], v[88:91], v[20:23]
    buffer_load_dwordx4 v155, s[12:15], s67 offen offset:1024 lds
    v_mfma_f32_16x16x32_bf16 v[24:27], v[124:127], v[92:95], v[24:27]
    ds_read_b64_tr_b16 v[136:137], v160 offset:45056
    v_mfma_f32_16x16x32_bf16 v[28:31], v[124:127], v[96:99], v[28:31]
    ds_read_b64_tr_b16 v[138:139], v160 offset:45568
    v_mfma_f32_16x16x32_bf16 v[64:67], v[124:127], v[148:151], v[64:67]
    s_waitcnt lgkmcnt(10)
    v_mfma_f32_16x16x32_bf16 v[76:79], v[148:151], v[100:103], v[76:79]
    ds_read_b128 v[120:123], v159 offset:32768
    v_mfma_f32_16x16x32_bf16 v[80:83], v[100:103], v[100:103], v[80:83]
    s_waitcnt vmcnt(8)
    s_barrier
    v_add_u32 v156, 65536, v156
    v_add_u32 v157, 65536, v157
    v_add_u32 v158, 65536, v158
    v_add_u32 v159, 65536, v159
    v_add_u32 v160, 65536, v160
    s_waitcnt lgkmcnt(8)
    v_mfma_f32_16x16x32_bf16 v[32:35], v[140:143], v[104:107], v[32:35]
    s_add_u32 s77, s77, 1
    ds_read_b64_tr_b16 v[128:129], v160 offset:16384
    s_waitcnt lgkmcnt(8)
    v_mfma_f32_16x16x32_bf16 v[36:39], v[140:143], v[108:111], v[36:39]
    s_cmp_eq_u32 s77, 7
    s_cselect_b32 s77, 0, s77
    ds_read_b64_tr_b16 v[130:131], v160 offset:16896
    s_waitcnt lgkmcnt(8)
    v_mfma_f32_16x16x32_bf16 v[40:43], v[140:143], v[112:115], v[40:43]
    s_lshl_b32 s66, s77, 7
    s_waitcnt lgkmcnt(7)
    v_mfma_f32_16x16x32_bf16 v[44:47], v[140:143], v[116:119], v[44:47]
    s_mul_i32 s67, s77, 172032
    ds_read_b128 v[84:87], v156
    v_mfma_f32_16x16x32_bf16 v[68:71], v[140:143], v[148:151], v[68:71]
    s_add_u32 s66, s66, s74
    ds_read_b128 v[88:91], v156 offset:2048
    s_waitcnt lgkmcnt(7)
    v_mfma_f32_16x16x32_bf16 v[48:51], v[104:107], v[144:147], v[48:51]
    s_add_u32 s67, s67, s75
    v_mfma_f32_16x16x32_bf16 v[52:55], v[108:111], v[144:147], v[52:55]
    s_add_u32 m0, s76, 0
    ds_read_b128 v[92:95], v156 offset:4096
    v_mfma_f32_16x16x32_bf16 v[56:59], v[112:115], v[144:147], v[56:59]
    ds_read_b128 v[96:99], v156 offset:6144
    v_mfma_f32_16x16x32_bf16 v[60:63], v[116:119], v[144:147], v[60:63]
    buffer_load_dwordx4 v152, s[8:11], s66 offen lds
    v_mfma_f32_16x16x32_bf16 v[72:75], v[148:151], v[144:147], v[72:75]
    ds_read_b64_tr_b16 v[132:133], v160 offset:24576
    s_waitcnt lgkmcnt(8)
    v_mfma_f32_16x16x32_bf16 v[16:19], v[136:139], v[104:107], v[16:19]
    ds_read_b64_tr_b16 v[134:135], v160 offset:25088
    v_mfma_f32_16x16x32_bf16 v[20:23], v[136:139], v[108:111], v[20:23]
    buffer_load_dwordx4 v153, s[8:11], s66 offen offset:1024 lds
    v_mfma_f32_16x16x32_bf16 v[24:27], v[136:139], v[112:115], v[24:27]
    s_add_u32 m0, s76, 8192
    ds_read_b64_tr_b16 v[124:125], v160 offset:8192
    v_mfma_f32_16x16x32_bf16 v[28:31], v[136:139], v[116:119], v[28:31]
    ds_read_b64_tr_b16 v[126:127], v160 offset:8704
    v_mfma_f32_16x16x32_bf16 v[64:67], v[136:139], v[148:151], v[64:67]
    buffer_load_dwordx4 v154, s[12:15], s67 offen lds
    s_waitcnt lgkmcnt(10)
    v_mfma_f32_16x16x32_bf16 v[76:79], v[148:151], v[120:123], v[76:79]
    ds_read_b128 v[100:103], v158
    v_mfma_f32_16x16x32_bf16 v[80:83], v[120:123], v[120:123], v[80:83]
    buffer_load_dwordx4 v155, s[12:15], s67 offen offset:1024 lds
    s_waitcnt lgkmcnt(8)
    v_mfma_f32_16x16x32_bf16 v[32:35], v[128:131], v[84:87], v[32:35]
    s_add_u32 m0, s76, 16384
    ds_read_b64_tr_b16 v[140:141], v160 offset:20480
    s_waitcnt lgkmcnt(8)
    v_mfma_f32_16x16x32_bf16 v[36:39], v[128:131], v[88:91], v[36:39]
    s_add_u32 s67, s67, 896
    ds_read_b64_tr_b16 v[142:143], v160 offset:20992
    s_waitcnt lgkmcnt(8)
    v_mfma_f32_16x16x32_bf16 v[40:43], v[128:131], v[92:95], v[40:43]
    buffer_load_dwordx4 v154, s[12:15], s67 offen lds
    s_waitcnt lgkmcnt(7)
    v_mfma_f32_16x16x32_bf16 v[44:47], v[128:131], v[96:99], v[44:47]
    ds_read_b128 v[104:107], v157
    v_mfma_f32_16x16x32_bf16 v[68:71], v[128:131], v[148:151], v[68:71]
    ds_read_b128 v[108:111], v157 offset:2048
    s_waitcnt lgkmcnt(7)
    v_mfma_f32_16x16x32_bf16 v[48:51], v[84:87], v[132:135], v[48:51]
    buffer_load_dwordx4 v155, s[12:15], s67 offen offset:1024 lds
    v_mfma_f32_16x16x32_bf16 v[52:55], v[88:91], v[132:135], v[52:55]
    s_add_u32 m0, s76, 24576
    ds_read_b128 v[112:115], v157 offset:4096
    v_mfma_f32_16x16x32_bf16 v[56:59], v[92:95], v[132:135], v[56:59]
    s_add_u32 s67, s67, 896
    ds_read_b128 v[116:119], v157 offset:6144
    v_mfma_f32_16x16x32_bf16 v[60:63], v[96:99], v[132:135], v[60:63]
    buffer_load_dwordx4 v154, s[12:15], s67 offen lds
    v_mfma_f32_16x16x32_bf16 v[72:75], v[148:151], v[132:135], v[72:75]
    ds_read_b64_tr_b16 v[144:145], v160 offset:28672
    s_waitcnt lgkmcnt(8)
    v_mfma_f32_16x16x32_bf16 v[16:19], v[124:127], v[84:87], v[16:19]
    ds_read_b64_tr_b16 v[146:147], v160 offset:29184
    v_mfma_f32_16x16x32_bf16 v[20:23], v[124:127], v[88:91], v[20:23]
    buffer_load_dwordx4 v155, s[12:15], s67 offen offset:1024 lds
    v_mfma_f32_16x16x32_bf16 v[24:27], v[124:127], v[92:95], v[24:27]
    ds_read_b64_tr_b16 v[136:137], v160 offset:12288
    v_mfma_f32_16x16x32_bf16 v[28:31], v[124:127], v[96:99], v[28:31]
    ds_read_b64_tr_b16 v[138:139], v160 offset:12800
    v_mfma_f32_16x16x32_bf16 v[64:67], v[124:127], v[148:151], v[64:67]
    s_waitcnt lgkmcnt(10)
    v_mfma_f32_16x16x32_bf16 v[76:79], v[148:151], v[100:103], v[76:79]
    ds_read_b128 v[120:123], v159
    v_mfma_f32_16x16x32_bf16 v[80:83], v[100:103], v[100:103], v[80:83]
    s_waitcnt vmcnt(8)
    s_barrier
    s_waitcnt lgkmcnt(8)
    v_mfma_f32_16x16x32_bf16 v[32:35], v[140:143], v[104:107], v[32:35]
    s_add_u32 s77, s77, 1
    ds_read_b64_tr_b16 v[128:129], v160 offset:49152
    s_waitcnt lgkmcnt(8)
    v_mfma_f32_16x16x32_bf16 v[36:39], v[140:143], v[108:111], v[36:39]
    s_cmp_eq_u32 s77, 7
    s_cselect_b32 s77, 0, s77
    ds_read_b64_tr_b16 v[130:131], v160 offset:49664
    s_waitcnt lgkmcnt(8)
    v_mfma_f32_16x16x32_bf16 v[40:43], v[140:143], v[112:115], v[40:43]
    s_lshl_b32 s66, s77, 7
    s_waitcnt lgkmcnt(7)
    v_mfma_f32_16x16x32_bf16 v[44:47], v[140:143], v[116:119], v[44:47]
    s_mul_i32 s67, s77, 172032
    ds_read_b128 v[84:87], v156 offset:32768
    v_mfma_f32_16x16x32_bf16 v[68:71], v[140:143], v[148:151], v[68:71]
    s_add_u32 s66, s66, s74
    ds_read_b128 v[88:91], v156 offset:34816
    s_waitcnt lgkmcnt(7)
    v_mfma_f32_16x16x32_bf16 v[48:51], v[104:107], v[144:147], v[48:51]
    s_add_u32 s67, s67, s75
    v_mfma_f32_16x16x32_bf16 v[52:55], v[108:111], v[144:147], v[52:55]
    s_add_u32 m0, s76, 32768
    ds_read_b128 v[92:95], v156 offset:36864
    v_mfma_f32_16x16x32_bf16 v[56:59], v[112:115], v[144:147], v[56:59]
    ds_read_b128 v[96:99], v156 offset:38912
    v_mfma_f32_16x16x32_bf16 v[60:63], v[116:119], v[144:147], v[60:63]
    buffer_load_dwordx4 v152, s[8:11], s66 offen lds
    v_mfma_f32_16x16x32_bf16 v[72:75], v[148:151], v[144:147], v[72:75]
    ds_read_b64_tr_b16 v[132:133], v160 offset:57344
    s_waitcnt lgkmcnt(8)
    v_mfma_f32_16x16x32_bf16 v[16:19], v[136:139], v[104:107], v[16:19]
    ds_read_b64_tr_b16 v[134:135], v160 offset:57856
    v_mfma_f32_16x16x32_bf16 v[20:23], v[136:139], v[108:111], v[20:23]
    buffer_load_dwordx4 v153, s[8:11], s66 offen offset:1024 lds
    v_mfma_f32_16x16x32_bf16 v[24:27], v[136:139], v[112:115], v[24:27]
    s_add_u32 m0, s76, 40960
    ds_read_b64_tr_b16 v[124:125], v160 offset:40960
    v_mfma_f32_16x16x32_bf16 v[28:31], v[136:139], v[116:119], v[28:31]
    ds_read_b64_tr_b16 v[126:127], v160 offset:41472
    v_mfma_f32_16x16x32_bf16 v[64:67], v[136:139], v[148:151], v[64:67]
    buffer_load_dwordx4 v154, s[12:15], s67 offen lds
    s_waitcnt lgkmcnt(10)
    v_mfma_f32_16x16x32_bf16 v[76:79], v[148:151], v[120:123], v[76:79]
    ds_read_b128 v[100:103], v158 offset:32768
    v_mfma_f32_16x16x32_bf16 v[80:83], v[120:123], v[120:123], v[80:83]
    buffer_load_dwordx4 v155, s[12:15], s67 offen offset:1024 lds
    s_waitcnt lgkmcnt(8)
    v_mfma_f32_16x16x32_bf16 v[32:35], v[128:131], v[84:87], v[32:35]
    s_add_u32 m0, s76, 49152
    ds_read_b64_tr_b16 v[140:141], v160 offset:53248
    s_waitcnt lgkmcnt(8)
    v_mfma_f32_16x16x32_bf16 v[36:39], v[128:131], v[88:91], v[36:39]
    s_add_u32 s67, s67, 896
    ds_read_b64_tr_b16 v[142:143], v160 offset:53760
    s_waitcnt lgkmcnt(8)
    v_mfma_f32_16x16x32_bf16 v[40:43], v[128:131], v[92:95], v[40:43]
    buffer_load_dwordx4 v154, s[12:15], s67 offen lds
    s_waitcnt lgkmcnt(7)
    v_mfma_f32_16x16x32_bf16 v[44:47], v[128:131], v[96:99], v[44:47]
    ds_read_b128 v[104:107], v157 offset:32768
    v_mfma_f32_16x16x32_bf16 v[68:71], v[128:131], v[148:151], v[68:71]
    ds_read_b128 v[108:111], v157 offset:34816
    s_waitcnt lgkmcnt(7)
    v_mfma_f32_16x16x32_bf16 v[48:51], v[84:87], v[132:135], v[48:51]
    buffer_load_dwordx4 v155, s[12:15], s67 offen offset:1024 lds
    v_mfma_f32_16x16x32_bf16 v[52:55], v[88:91], v[132:135], v[52:55]
    s_add_u32 m0, s76, 57344
    ds_read_b128 v[112:115], v157 offset:36864
    v_mfma_f32_16x16x32_bf16 v[56:59], v[92:95], v[132:135], v[56:59]
    s_add_u32 s67, s67, 896
    ds_read_b128 v[116:119], v157 offset:38912
    v_mfma_f32_16x16x32_bf16 v[60:63], v[96:99], v[132:135], v[60:63]
    buffer_load_dwordx4 v154, s[12:15], s67 offen lds
    v_mfma_f32_16x16x32_bf16 v[72:75], v[148:151], v[132:135], v[72:75]
    ds_read_b64_tr_b16 v[144:145], v160 offset:61440
    s_waitcnt lgkmcnt(8)
    v_mfma_f32_16x16x32_bf16 v[16:19], v[124:127], v[84:87], v[16:19]
    ds_read_b64_tr_b16 v[146:147], v160 offset:61952
    v_mfma_f32_16x16x32_bf16 v[20:23], v[124:127], v[88:91], v[20:23]
    buffer_load_dwordx4 v155, s[12:15], s67 offen offset:1024 lds
    v_mfma_f32_16x16x32_bf16 v[24:27], v[124:127], v[92:95], v[24:27]
    s_mul_i32 s80, s48, 4096
    s_add_u32 m0, s80, 131072
    ds_read_b64_tr_b16 v[136:137], v160 offset:45056
    v_mfma_f32_16x16x32_bf16 v[28:31], v[124:127], v[96:99], v[28:31]
    ds_read_b64_tr_b16 v[138:139], v160 offset:45568
    v_mfma_f32_16x16x32_bf16 v[64:67], v[124:127], v[148:151], v[64:67]
    buffer_load_dwordx4 v240, s[40:43], s94 offen lds
    s_waitcnt lgkmcnt(10)
    v_mfma_f32_16x16x32_bf16 v[76:79], v[148:151], v[100:103], v[76:79]
    s_add_u32 s79, s94, 13312
    ds_read_b128 v[120:123], v159 offset:32768
    v_mfma_f32_16x16x32_bf16 v[80:83], v[100:103], v[100:103], v[80:83]
    buffer_load_dwordx4 v240, s[40:43], s79 offen offset:1024 lds
    s_add_u32 m0, s80, 133120
    s_nop 0
    buffer_load_dwordx4 v241, s[4:7], s3 offen lds
    s_add_u32 s79, s3, s101
    s_sub_u32 s79, s79, 1024
    buffer_load_dwordx4 v241, s[4:7], s79 offen offset:1024 lds
    s_waitcnt vmcnt(12)
    s_barrier
    v_add_u32 v156, 4294901760, v156
    v_add_u32 v157, 4294901760, v157
    v_add_u32 v158, 4294901760, v158
    v_add_u32 v159, 4294901760, v159
    v_add_u32 v160, 4294901760, v160
    s_waitcnt lgkmcnt(8)
    v_mfma_f32_16x16x32_bf16 v[32:35], v[140:143], v[104:107], v[32:35]
    s_add_u32 s77, s77, 1
    ds_read_b64_tr_b16 v[128:129], v160 offset:16384
    s_waitcnt lgkmcnt(8)
    v_mfma_f32_16x16x32_bf16 v[36:39], v[140:143], v[108:111], v[36:39]
    s_cmp_eq_u32 s77, 7
    s_cselect_b32 s77, 0, s77
    ds_read_b64_tr_b16 v[130:131], v160 offset:16896
    s_waitcnt lgkmcnt(8)
    v_mfma_f32_16x16x32_bf16 v[40:43], v[140:143], v[112:115], v[40:43]
    s_lshl_b32 s66, s77, 7
    s_waitcnt lgkmcnt(7)
    v_mfma_f32_16x16x32_bf16 v[44:47], v[140:143], v[116:119], v[44:47]
    s_mul_i32 s67, s77, 172032
    ds_read_b128 v[84:87], v156
    v_mfma_f32_16x16x32_bf16 v[68:71], v[140:143], v[148:151], v[68:71]
    s_add_u32 s66, s66, s74
    ds_read_b128 v[88:91], v156 offset:2048
    s_waitcnt lgkmcnt(7)
    v_mfma_f32_16x16x32_bf16 v[48:51], v[104:107], v[144:147], v[48:51]
    s_add_u32 s67, s67, s75
    v_mfma_f32_16x16x32_bf16 v[52:55], v[108:111], v[144:147], v[52:55]
    s_add_u32 m0, s76, 65536
    ds_read_b128 v[92:95], v156 offset:4096
    v_mfma_f32_16x16x32_bf16 v[56:59], v[112:115], v[144:147], v[56:59]
    ds_read_b128 v[96:99], v156 offset:6144
    v_mfma_f32_16x16x32_bf16 v[60:63], v[116:119], v[144:147], v[60:63]
    buffer_load_dwordx4 v152, s[8:11], s66 offen lds
    v_mfma_f32_16x16x32_bf16 v[72:75], v[148:151], v[144:147], v[72:75]
    ds_read_b64_tr_b16 v[132:133], v160 offset:24576
    s_waitcnt lgkmcnt(8)
    v_mfma_f32_16x16x32_bf16 v[16:19], v[136:139], v[104:107], v[16:19]
    ds_read_b64_tr_b16 v[134:135], v160 offset:25088
    v_mfma_f32_16x16x32_bf16 v[20:23], v[136:139], v[108:111], v[20:23]
    buffer_load_dwordx4 v153, s[8:11], s66 offen offset:1024 lds
    v_mfma_f32_16x16x32_bf16 v[24:27], v[136:139], v[112:115], v[24:27]
    s_add_u32 m0, s76, 73728
    ds_read_b64_tr_b16 v[124:125], v160 offset:8192
    v_mfma_f32_16x16x32_bf16 v[28:31], v[136:139], v[116:119], v[28:31]
    ds_read_b64_tr_b16 v[126:127], v160 offset:8704
    v_mfma_f32_16x16x32_bf16 v[64:67], v[136:139], v[148:151], v[64:67]
    buffer_load_dwordx4 v154, s[12:15], s67 offen lds
    s_waitcnt lgkmcnt(10)
    v_mfma_f32_16x16x32_bf16 v[76:79], v[148:151], v[120:123], v[76:79]
    ds_read_b128 v[100:103], v158
    v_mfma_f32_16x16x32_bf16 v[80:83], v[120:123], v[120:123], v[80:83]
    buffer_load_dwordx4 v155, s[12:15], s67 offen offset:1024 lds
    s_waitcnt lgkmcnt(8)
    v_mfma_f32_16x16x32_bf16 v[32:35], v[128:131], v[84:87], v[32:35]
    s_add_u32 m0, s76, 81920
    ds_read_b64_tr_b16 v[140:141], v160 offset:20480
    s_waitcnt lgkmcnt(8)
    v_mfma_f32_16x16x32_bf16 v[36:39], v[128:131], v[88:91], v[36:39]
    s_add_u32 s67, s67, 896
    ds_read_b64_tr_b16 v[142:143], v160 offset:20992
    s_waitcnt lgkmcnt(8)
    v_mfma_f32_16x16x32_bf16 v[40:43], v[128:131], v[92:95], v[40:43]
    buffer_load_dwordx4 v154, s[12:15], s67 offen lds
    s_waitcnt lgkmcnt(7)
    v_mfma_f32_16x16x32_bf16 v[44:47], v[128:131], v[96:99], v[44:47]
    ds_read_b128 v[104:107], v157
    v_mfma_f32_16x16x32_bf16 v[68:71], v[128:131], v[148:151], v[68:71]
    ds_read_b128 v[108:111], v157 offset:2048
    s_waitcnt lgkmcnt(7)
    v_mfma_f32_16x16x32_bf16 v[48:51], v[84:87], v[132:135], v[48:51]
    buffer_load_dwordx4 v155, s[12:15], s67 offen offset:1024 lds
    v_mfma_f32_16x16x32_bf16 v[52:55], v[88:91], v[132:135], v[52:55]
    s_add_u32 m0, s76, 90112
    ds_read_b128 v[112:115], v157 offset:4096
    v_mfma_f32_16x16x32_bf16 v[56:59], v[92:95], v[132:135], v[56:59]
    s_add_u32 s67, s67, 896
    ds_read_b128 v[116:119], v157 offset:6144
    v_mfma_f32_16x16x32_bf16 v[60:63], v[96:99], v[132:135], v[60:63]
    buffer_load_dwordx4 v154, s[12:15], s67 offen lds
    v_mfma_f32_16x16x32_bf16 v[72:75], v[148:151], v[132:135], v[72:75]
    ds_read_b64_tr_b16 v[144:145], v160 offset:28672
    s_waitcnt lgkmcnt(8)
    v_mfma_f32_16x16x32_bf16 v[16:19], v[124:127], v[84:87], v[16:19]
    ds_read_b64_tr_b16 v[146:147], v160 offset:29184
    v_mfma_f32_16x16x32_bf16 v[20:23], v[124:127], v[88:91], v[20:23]
    buffer_load_dwordx4 v155, s[12:15], s67 offen offset:1024 lds
    v_mfma_f32_16x16x32_bf16 v[24:27], v[124:127], v[92:95], v[24:27]
    ds_read_b64_tr_b16 v[136:137], v160 offset:12288
    v_mfma_f32_16x16x32_bf16 v[28:31], v[124:127], v[96:99], v[28:31]
    ds_read_b64_tr_b16 v[138:139], v160 offset:12800
    v_mfma_f32_16x16x32_bf16 v[64:67], v[124:127], v[148:151], v[64:67]
    s_waitcnt lgkmcnt(10)
    v_mfma_f32_16x16x32_bf16 v[76:79], v[148:151], v[100:103], v[76:79]
    ds_read_b128 v[120:123], v159
    v_mfma_f32_16x16x32_bf16 v[80:83], v[100:103], v[100:103], v[80:83]
    v_mov_b32 v162, 0
    buffer_load_dword v162, v162, s[32:35], 0 offen sc1
    s_waitcnt vmcnt(13)
    s_barrier
    s_waitcnt lgkmcnt(8)
    v_mfma_f32_16x16x32_bf16 v[32:35], v[140:143], v[104:107], v[32:35]
    ds_read_b64_tr_b16 v[128:129], v160 offset:49152
    s_waitcnt lgkmcnt(8)
    v_mfma_f32_16x16x32_bf16 v[36:39], v[140:143], v[108:111], v[36:39]
    ds_read_b64_tr_b16 v[130:131], v160 offset:49664
    s_waitcnt lgkmcnt(8)
    v_mfma_f32_16x16x32_bf16 v[40:43], v[140:143], v[112:115], v[40:43]
    buffer_store_dwordx4 v[248:251], v1, s[16:19], s91 offen sc1
    s_waitcnt lgkmcnt(7)
    v_mfma_f32_16x16x32_bf16 v[44:47], v[140:143], v[116:119], v[44:47]
    ds_read_b128 v[84:87], v156 offset:32768
    v_mfma_f32_16x16x32_bf16 v[68:71], v[140:143], v[148:151], v[68:71]
    ds_read_b128 v[88:91], v156 offset:34816
    s_waitcnt lgkmcnt(7)
    v_mfma_f32_16x16x32_bf16 v[48:51], v[104:107], v[144:147], v[48:51]
    buffer_store_dwordx4 v[248:251], v245, s[16:19], s91 offen offset:1024 sc1
    v_mfma_f32_16x16x32_bf16 v[52:55], v[108:111], v[144:147], v[52:55]
    ds_read_b128 v[92:95], v156 offset:36864
    v_mfma_f32_16x16x32_bf16 v[56:59], v[112:115], v[144:147], v[56:59]
    ds_read_b128 v[96:99], v156 offset:38912
    v_mfma_f32_16x16x32_bf16 v[60:63], v[116:119], v[144:147], v[60:63]
    v_mfma_f32_16x16x32_bf16 v[72:75], v[148:151], v[144:147], v[72:75]
    ds_read_b64_tr_b16 v[132:133], v160 offset:57344
    s_waitcnt lgkmcnt(8)
    v_mfma_f32_16x16x32_bf16 v[16:19], v[136:139], v[104:107], v[16:19]
    ds_read_b64_tr_b16 v[134:135], v160 offset:57856
    v_mfma_f32_16x16x32_bf16 v[20:23], v[136:139], v[108:111], v[20:23]
    v_mfma_f32_16x16x32_bf16 v[24:27], v[136:139], v[112:115], v[24:27]
    ds_read_b64_tr_b16 v[124:125], v160 offset:40960
    v_mfma_f32_16x16x32_bf16 v[28:31], v[136:139], v[116:119], v[28:31]
    ds_read_b64_tr_b16 v[126:127], v160 offset:41472
    v_mfma_f32_16x16x32_bf16 v[64:67], v[136:139], v[148:151], v[64:67]
    s_waitcnt lgkmcnt(10)
    v_mfma_f32_16x16x32_bf16 v[76:79], v[148:151], v[120:123], v[76:79]
    ds_read_b128 v[100:103], v158 offset:32768
    v_mfma_f32_16x16x32_bf16 v[80:83], v[120:123], v[120:123], v[80:83]
    s_waitcnt lgkmcnt(8)
    v_mfma_f32_16x16x32_bf16 v[32:35], v[128:131], v[84:87], v[32:35]
    ds_read_b64_tr_b16 v[140:141], v160 offset:53248
    s_waitcnt lgkmcnt(8)
    v_mfma_f32_16x16x32_bf16 v[36:39], v[128:131], v[88:91], v[36:39]
    ds_read_b64_tr_b16 v[142:143], v160 offset:53760
    s_waitcnt lgkmcnt(8)
    v_mfma_f32_16x16x32_bf16 v[40:43], v[128:131], v[92:95], v[40:43]
    s_waitcnt vmcnt(11)
    ds_read_b64_tr_b16 a[0:1], v253
    s_waitcnt lgkmcnt(8)
    v_mfma_f32_16x16x32_bf16 v[44:47], v[128:131], v[96:99], v[44:47]
    ds_read_b128 v[104:107], v157 offset:32768
    v_mfma_f32_16x16x32_bf16 v[68:71], v[128:131], v[148:151], v[68:71]
    ds_read_b128 v[108:111], v157 offset:34816
    s_waitcnt lgkmcnt(8)
    v_mfma_f32_16x16x32_bf16 v[48:51], v[84:87], v[132:135], v[48:51]
    ds_read_b64_tr_b16 a[2:3], v253 offset:1024
    v_mfma_f32_16x16x32_bf16 v[52:55], v[88:91], v[132:135], v[52:55]
    ds_read_b128 v[112:115], v157 offset:36864
    v_mfma_f32_16x16x32_bf16 v[56:59], v[92:95], v[132:135], v[56:59]
    ds_read_b128 v[116:119], v157 offset:38912
    v_mfma_f32_16x16x32_bf16 v[60:63], v[96:99], v[132:135], v[60:63]
    ds_read_b64_tr_b16 a[4:5], v252 offset:8
    v_mfma_f32_16x16x32_bf16 v[72:75], v[148:151], v[132:135], v[72:75]
    ds_read_b64_tr_b16 v[144:145], v160 offset:61440
    s_waitcnt lgkmcnt(11)
    v_mfma_f32_16x16x32_bf16 v[16:19], v[124:127], v[84:87], v[16:19]
    ds_read_b64_tr_b16 v[146:147], v160 offset:61952
    v_mfma_f32_16x16x32_bf16 v[20:23], v[124:127], v[88:91], v[20:23]
    ds_read_b64_tr_b16 a[6:7], v252 offset:1032
    v_mfma_f32_16x16x32_bf16 v[24:27], v[124:127], v[92:95], v[24:27]
    ds_read_b64_tr_b16 v[136:137], v160 offset:45056
    v_mfma_f32_16x16x32_bf16 v[28:31], v[124:127], v[96:99], v[28:31]
    ds_read_b64_tr_b16 v[138:139], v160 offset:45568
    v_mfma_f32_16x16x32_bf16 v[64:67], v[124:127], v[148:151], v[64:67]
    ds_read_b64_tr_b16 a[8:9], v252 offset:2048
    s_waitcnt lgkmcnt(15)
    v_mfma_f32_16x16x32_bf16 v[76:79], v[148:151], v[100:103], v[76:79]
    ds_read_b128 v[120:123], v159 offset:32768
    v_mfma_f32_16x16x32_bf16 v[80:83], v[100:103], v[100:103], v[80:83]
    ds_read_b64_tr_b16 a[10:11], v252 offset:3072
    s_waitcnt vmcnt(3)
    s_barrier
    v_add_u32 v156, 65536, v156
    v_add_u32 v157, 65536, v157
    v_add_u32 v158, 65536, v158
    v_add_u32 v159, 65536, v159
    v_add_u32 v160, 65536, v160
    s_waitcnt lgkmcnt(13)
    v_mfma_f32_16x16x32_bf16 v[32:35], v[140:143], v[104:107], v[32:35]
    ds_read_b64_tr_b16 v[128:129], v160 offset:16384
    s_waitcnt lgkmcnt(13)
    v_mfma_f32_16x16x32_bf16 v[36:39], v[140:143], v[108:111], v[36:39]
    ds_read_b64_tr_b16 v[130:131], v160 offset:16896
    s_waitcnt lgkmcnt(12)
    v_mfma_f32_16x16x32_bf16 v[40:43], v[140:143], v[112:115], v[40:43]
    ds_read_b64_tr_b16 a[12:13], v252 offset:2056
    s_waitcnt lgkmcnt(12)
    v_mfma_f32_16x16x32_bf16 v[44:47], v[140:143], v[116:119], v[44:47]
    ds_read_b128 v[84:87], v156
    v_mfma_f32_16x16x32_bf16 v[68:71], v[140:143], v[148:151], v[68:71]
    ds_read_b128 v[88:91], v156 offset:2048
    s_waitcnt lgkmcnt(11)
    v_mfma_f32_16x16x32_bf16 v[48:51], v[104:107], v[144:147], v[48:51]
    ds_read_b64_tr_b16 a[14:15], v252 offset:3080
    v_mfma_f32_16x16x32_bf16 v[52:55], v[108:111], v[144:147], v[52:55]
    ds_read_b128 v[92:95], v156 offset:4096
    v_mfma_f32_16x16x32_bf16 v[56:59], v[112:115], v[144:147], v[56:59]
    ds_read_b128 v[96:99], v156 offset:6144
    v_mfma_f32_16x16x32_bf16 v[60:63], v[116:119], v[144:147], v[60:63]
    buffer_store_dwordx4 a[0:3], v1, s[16:19], s95 offen sc1
    v_mfma_f32_16x16x32_bf16 v[72:75], v[148:151], v[144:147], v[72:75]
    ds_read_b64_tr_b16 v[132:133], v160 offset:24576
    s_waitcnt lgkmcnt(12)
    v_mfma_f32_16x16x32_bf16 v[16:19], v[136:139], v[104:107], v[16:19]
    ds_read_b64_tr_b16 v[134:135], v160 offset:25088
    v_mfma_f32_16x16x32_bf16 v[20:23], v[136:139], v[108:111], v[20:23]
    buffer_store_dwordx4 a[4:7], v238, s[16:19], s95 offen offset:1024 sc1
    v_mfma_f32_16x16x32_bf16 v[24:27], v[136:139], v[112:115], v[24:27]
    ds_read_b64_tr_b16 v[124:125], v160 offset:8192
    v_mfma_f32_16x16x32_bf16 v[28:31], v[136:139], v[116:119], v[28:31]
    ds_read_b64_tr_b16 v[126:127], v160 offset:8704
    v_mfma_f32_16x16x32_bf16 v[64:67], v[136:139], v[148:151], v[64:67]
    s_waitcnt lgkmcnt(12)
    buffer_store_dwordx4 a[8:11], v1, s[16:19], s81 offen sc1
    v_mfma_f32_16x16x32_bf16 v[76:79], v[148:151], v[120:123], v[76:79]
    ds_read_b128 v[100:103], v158
    v_mfma_f32_16x16x32_bf16 v[80:83], v[120:123], v[120:123], v[80:83]
    ds_read_b128 v[228:231], v159
    s_waitcnt lgkmcnt(1)
    v_mfma_f32_16x16x32_bf16 v[76:79], v[148:151], v[100:103], v[76:79]
    ds_read_b64_tr_b16 v[140:141], v160 offset:20480
    v_mfma_f32_16x16x32_bf16 v[80:83], v[100:103], v[100:103], v[80:83]
    ds_read_b64_tr_b16 v[142:143], v160 offset:20992
    s_waitcnt lgkmcnt(2)
    v_mfma_f32_16x16x32_bf16 v[76:79], v[148:151], v[228:231], v[76:79]
    buffer_store_dwordx4 a[12:15], v1, s[16:19], s81 offen offset:1024 sc1
    v_mfma_f32_16x16x32_bf16 v[80:83], v[228:231], v[228:231], v[80:83]
    ds_read_b128 v[104:107], v157
    v_mfma_f32_16x16x32_bf16 v[32:35], v[128:131], v[84:87], v[32:35]
    ds_read_b128 v[108:111], v157 offset:2048
    v_mfma_f32_16x16x32_bf16 v[36:39], v[128:131], v[88:91], v[36:39]
    buffer_store_dwordx4 v[176:179], v172, s[16:19], s89 offen offset:2048 sc1
    v_mfma_f32_16x16x32_bf16 v[40:43], v[128:131], v[92:95], v[40:43]
    ds_read_b128 v[112:115], v157 offset:4096
    v_mfma_f32_16x16x32_bf16 v[44:47], v[128:131], v[96:99], v[44:47]
    ds_read_b128 v[116:119], v157 offset:6144
    v_cndmask_b32 v6, v80, v81, s[68:69]
    v_mfma_f32_16x16x32_bf16 v[68:71], v[128:131], v[148:151], v[68:71]
    buffer_store_dwordx4 v[176:179], v172, s[16:19], s90 offen offset:2048 sc1
    v_cndmask_b32 v7, v82, v83, s[68:69]
    v_mfma_f32_16x16x32_bf16 v[48:51], v[84:87], v[132:135], v[48:51]
    ds_read_b64_tr_b16 v[144:145], v160 offset:28672
    v_cndmask_b32 v6, v6, v7, s[70:71]
    v_mfma_f32_16x16x32_bf16 v[52:55], v[88:91], v[132:135], v[52:55]
    ds_read_b64_tr_b16 v[146:147], v160 offset:29184
    ds_bpermute_b32 v6, v161, v6
    v_mfma_f32_16x16x32_bf16 v[56:59], v[92:95], v[132:135], v[56:59]
    v_mul_f32 v11, 0xbb124925, v76
    v_mfma_f32_16x16x32_bf16 v[60:63], v[96:99], v[132:135], v[60:63]
    ds_read_b64_tr_b16 v[136:137], v160 offset:12288
    v_mul_f32 v7, v11, v11
    v_mfma_f32_16x16x32_bf16 v[72:75], v[148:151], v[132:135], v[72:75]
    ds_read_b64_tr_b16 v[138:139], v160 offset:12800
    v_sub_f32 v7, 0x3727c5ac, v7
    v_mfma_f32_16x16x32_bf16 v[16:19], v[124:127], v[84:87], v[16:19]
    s_waitcnt lgkmcnt(2)
    v_fmac_f32 v7, 0x3b124925, v6
    v_mfma_f32_16x16x32_bf16 v[20:23], v[124:127], v[88:91], v[20:23]
    v_max_f32 v7, 0x3727c5ac, v7
    v_mfma_f32_16x16x32_bf16 v[24:27], v[124:127], v[92:95], v[24:27]
    v_rsq_f32 v10, v7
    v_mfma_f32_16x16x32_bf16 v[28:31], v[124:127], v[96:99], v[28:31]
    s_mov_b64 exec, 0xffff
    ds_write_b64 v165, v[10:11]
    s_mov_b64 exec, -1
    v_mfma_f32_16x16x32_bf16 v[64:67], v[124:127], v[148:151], v[64:67]
    s_waitcnt lgkmcnt(0)
    s_barrier
    v_mfma_f32_16x16x32_bf16 v[32:35], v[140:143], v[104:107], v[32:35]
    ds_read_b64 v[184:185], v180
    v_mfma_f32_16x16x32_bf16 v[36:39], v[140:143], v[108:111], v[36:39]
    ds_read_b64 v[186:187], v180 offset:128
    v_mfma_f32_16x16x32_bf16 v[40:43], v[140:143], v[112:115], v[40:43]
    v_mfma_f32_16x16x32_bf16 v[44:47], v[140:143], v[116:119], v[44:47]
    ds_read_b64 v[188:189], v180 offset:256
    v_mfma_f32_16x16x32_bf16 v[68:71], v[140:143], v[148:151], v[68:71]
    ds_read_b64 v[190:191], v180 offset:384
    v_mfma_f32_16x16x32_bf16 v[48:51], v[104:107], v[144:147], v[48:51]
    v_mfma_f32_16x16x32_bf16 v[52:55], v[108:111], v[144:147], v[52:55]
    ds_read_b128 v[192:195], v181
    v_mfma_f32_16x16x32_bf16 v[56:59], v[112:115], v[144:147], v[56:59]
    ds_read_b128 v[196:199], v181 offset:16
    v_mfma_f32_16x16x32_bf16 v[60:63], v[116:119], v[144:147], v[60:63]
    v_mfma_f32_16x16x32_bf16 v[72:75], v[148:151], v[144:147], v[72:75]
    ds_read_b128 v[200:203], v181 offset:128
    v_mfma_f32_16x16x32_bf16 v[16:19], v[136:139], v[104:107], v[16:19]
    ds_read_b128 v[204:207], v181 offset:144
    v_mfma_f32_16x16x32_bf16 v[20:23], v[136:139], v[108:111], v[20:23]
    ds_read_b128 v[208:211], v181 offset:256
    v_mfma_f32_16x16x32_bf16 v[24:27], v[136:139], v[112:115], v[24:27]
    ds_read_b128 v[212:215], v181 offset:272
    v_mfma_f32_16x16x32_bf16 v[28:31], v[136:139], v[116:119], v[28:31]
    ds_read_b128 v[216:219], v181 offset:384
    v_mfma_f32_16x16x32_bf16 v[64:67], v[136:139], v[148:151], v[64:67]
    ds_read_b128 v[220:223], v181 offset:400
    s_waitcnt lgkmcnt(11)
    v_pk_fma_f32 v[32:33], v[68:69], v[184:185], v[32:33] op_sel:[0,1,0] op_sel_hi:[1,1,1]
    v_pk_mul_f32 v[32:33], v[32:33], v[184:185] op_sel_hi:[1,0]
    v_pk_fma_f32 v[34:35], v[70:71], v[184:185], v[34:35] op_sel:[0,1,0] op_sel_hi:[1,1,1]
    v_pk_mul_f32 v[34:35], v[34:35], v[184:185] op_sel_hi:[1,0]
    v_cvt_pk_bf16_f32 v84, v32, v33
    v_cvt_pk_bf16_f32 v85, v34, v35
    s_waitcnt lgkmcnt(10)
    v_pk_fma_f32 v[36:37], v[68:69], v[186:187], v[36:37] op_sel:[0,1,0] op_sel_hi:[1,1,1]
    v_pk_mul_f32 v[36:37], v[36:37], v[186:187] op_sel_hi:[1,0]
    v_pk_fma_f32 v[38:39], v[70:71], v[186:187], v[38:39] op_sel:[0,1,0] op_sel_hi:[1,1,1]
    v_pk_mul_f32 v[38:39], v[38:39], v[186:187] op_sel_hi:[1,0]
    v_cvt_pk_bf16_f32 v86, v36, v37
    v_cvt_pk_bf16_f32 v87, v38, v39
    v_mov_b32 v90, v174
    v_mov_b32 v91, v175
    v_permlane16_swap_b32 v84, v86
    v_permlane16_swap_b32 v85, v87
    v_mov_b32 v88, v86
    v_mov_b32 v89, v87
    v_cndmask_b32 v86, v86, v90, s[72:73]
    v_cndmask_b32 v87, v87, v91, s[72:73]
    buffer_store_dwordx4 v[84:87], v168, s[16:19], s89 offen sc1
    buffer_store_dwordx4 v[88:91], v170, s[16:19], s89 offen sc1
    s_waitcnt lgkmcnt(9)
    v_pk_fma_f32 v[40:41], v[68:69], v[188:189], v[40:41] op_sel:[0,1,0] op_sel_hi:[1,1,1]
    v_pk_mul_f32 v[40:41], v[40:41], v[188:189] op_sel_hi:[1,0]
    v_pk_fma_f32 v[42:43], v[70:71], v[188:189], v[42:43] op_sel:[0,1,0] op_sel_hi:[1,1,1]
    v_pk_mul_f32 v[42:43], v[42:43], v[188:189] op_sel_hi:[1,0]
    v_cvt_pk_bf16_f32 v92, v40, v41
    v_cvt_pk_bf16_f32 v93, v42, v43
    s_waitcnt lgkmcnt(8)
    v_pk_fma_f32 v[44:45], v[68:69], v[190:191], v[44:45] op_sel:[0,1,0] op_sel_hi:[1,1,1]
    v_pk_mul_f32 v[44:45], v[44:45], v[190:191] op_sel_hi:[1,0]
    v_pk_fma_f32 v[46:47], v[70:71], v[190:191], v[46:47] op_sel:[0,1,0] op_sel_hi:[1,1,1]
    v_pk_mul_f32 v[46:47], v[46:47], v[190:191] op_sel_hi:[1,0]
    v_cvt_pk_bf16_f32 v94, v44, v45
    v_cvt_pk_bf16_f32 v95, v46, v47
    v_mov_b32 v98, v174
    v_mov_b32 v99, v175
    v_permlane16_swap_b32 v92, v94
    v_permlane16_swap_b32 v93, v95
    v_mov_b32 v96, v94
    v_mov_b32 v97, v95
    v_cndmask_b32 v94, v94, v98, s[72:73]
    v_cndmask_b32 v95, v95, v99, s[72:73]
    buffer_store_dwordx4 v[92:95], v168, s[16:19], s90 offen sc1
    buffer_store_dwordx4 v[96:99], v170, s[16:19], s90 offen sc1
    s_waitcnt lgkmcnt(7)
    v_fmac_f32 v48, v193, v72
    v_mul_f32 v48, v48, v192
    v_fmac_f32 v49, v195, v72
    v_mul_f32 v49, v49, v194
    s_waitcnt lgkmcnt(6)
    v_fmac_f32 v50, v197, v72
    v_mul_f32 v50, v50, v196
    v_fmac_f32 v51, v199, v72
    v_mul_f32 v51, v51, v198
    v_cvt_pk_bf16_f32 v100, v48, v49
    v_cvt_pk_bf16_f32 v101, v50, v51
    s_waitcnt lgkmcnt(5)
    v_fmac_f32 v52, v201, v72
    v_mul_f32 v52, v52, v200
    v_fmac_f32 v53, v203, v72
    v_mul_f32 v53, v53, v202
    s_waitcnt lgkmcnt(4)
    v_fmac_f32 v54, v205, v72
    v_mul_f32 v54, v54, v204
    v_fmac_f32 v55, v207, v72
    v_mul_f32 v55, v55, v206
    v_cvt_pk_bf16_f32 v102, v52, v53
    v_cvt_pk_bf16_f32 v103, v54, v55
    buffer_store_dwordx4 v[100:103], v171, s[16:19], s89 offen offset:2048 sc1
    s_waitcnt lgkmcnt(3)
    v_fmac_f32 v56, v209, v72
    v_mul_f32 v56, v56, v208
    v_fmac_f32 v57, v211, v72
    v_mul_f32 v57, v57, v210
    s_waitcnt lgkmcnt(2)
    v_fmac_f32 v58, v213, v72
    v_mul_f32 v58, v58, v212
    v_fmac_f32 v59, v215, v72
    v_mul_f32 v59, v59, v214
    v_cvt_pk_bf16_f32 v104, v56, v57
    v_cvt_pk_bf16_f32 v105, v58, v59
    s_waitcnt lgkmcnt(1)
    v_fmac_f32 v60, v217, v72
    v_mul_f32 v60, v60, v216
    v_fmac_f32 v61, v219, v72
    v_mul_f32 v61, v61, v218
    s_waitcnt lgkmcnt(0)
    v_fmac_f32 v62, v221, v72
    v_mul_f32 v62, v62, v220
    v_fmac_f32 v63, v223, v72
    v_mul_f32 v63, v63, v222
    v_cvt_pk_bf16_f32 v106, v60, v61
    v_cvt_pk_bf16_f32 v107, v62, v63
    buffer_store_dwordx4 v[104:107], v171, s[16:19], s90 offen offset:2048 sc1
    v_mul_f32 v184, 0x3e8b97f6, v184
    v_mul_f32 v186, 0x3e8b97f6, v186
    v_mul_f32 v188, 0x3e8b97f6, v188
    v_mul_f32 v190, 0x3e8b97f6, v190
    v_pk_fma_f32 v[16:17], v[64:65], v[184:185], v[16:17] op_sel:[0,1,0] op_sel_hi:[1,1,1]
    v_pk_mul_f32 v[16:17], v[16:17], v[184:185] op_sel_hi:[1,0]
    v_pk_fma_f32 v[18:19], v[66:67], v[184:185], v[18:19] op_sel:[0,1,0] op_sel_hi:[1,1,1]
    v_pk_mul_f32 v[18:19], v[18:19], v[184:185] op_sel_hi:[1,0]
    v_cvt_pk_bf16_f32 v108, v16, v17
    v_cvt_pk_bf16_f32 v109, v18, v19
    v_pk_fma_f32 v[20:21], v[64:65], v[186:187], v[20:21] op_sel:[0,1,0] op_sel_hi:[1,1,1]
    v_pk_mul_f32 v[20:21], v[20:21], v[186:187] op_sel_hi:[1,0]
    v_pk_fma_f32 v[22:23], v[66:67], v[186:187], v[22:23] op_sel:[0,1,0] op_sel_hi:[1,1,1]
    v_pk_mul_f32 v[22:23], v[22:23], v[186:187] op_sel_hi:[1,0]
    v_cvt_pk_bf16_f32 v110, v20, v21
    v_cvt_pk_bf16_f32 v111, v22, v23
    v_mov_b32 v114, 0
    v_mov_b32 v115, 0
    v_permlane16_swap_b32 v108, v110
    v_permlane16_swap_b32 v109, v111
    v_mov_b32 v112, v110
    v_mov_b32 v113, v111
    v_cndmask_b32 v110, v110, v114, s[72:73]
    v_cndmask_b32 v111, v111, v115, s[72:73]
    buffer_store_dwordx4 v[108:111], v167, s[16:19], s88 offen sc1
    buffer_store_dwordx4 v[112:115], v169, s[16:19], s88 offen sc1
    v_pk_fma_f32 v[24:25], v[64:65], v[188:189], v[24:25] op_sel:[0,1,0] op_sel_hi:[1,1,1]
    v_pk_mul_f32 v[24:25], v[24:25], v[188:189] op_sel_hi:[1,0]
    v_pk_fma_f32 v[26:27], v[66:67], v[188:189], v[26:27] op_sel:[0,1,0] op_sel_hi:[1,1,1]
    v_pk_mul_f32 v[26:27], v[26:27], v[188:189] op_sel_hi:[1,0]
    v_cvt_pk_bf16_f32 v116, v24, v25
    v_cvt_pk_bf16_f32 v117, v26, v27
    v_pk_fma_f32 v[28:29], v[64:65], v[190:191], v[28:29] op_sel:[0,1,0] op_sel_hi:[1,1,1]
    v_pk_mul_f32 v[28:29], v[28:29], v[190:191] op_sel_hi:[1,0]
    v_pk_fma_f32 v[30:31], v[66:67], v[190:191], v[30:31] op_sel:[0,1,0] op_sel_hi:[1,1,1]
    v_pk_mul_f32 v[30:31], v[30:31], v[190:191] op_sel_hi:[1,0]
    v_cvt_pk_bf16_f32 v118, v28, v29
    v_cvt_pk_bf16_f32 v119, v30, v31
    v_mov_b32 v122, 0
    v_mov_b32 v123, 0
    v_permlane16_swap_b32 v116, v118
    v_permlane16_swap_b32 v117, v119
    v_mov_b32 v120, v118
    v_mov_b32 v121, v119
    v_cndmask_b32 v118, v118, v122, s[72:73]
    v_cndmask_b32 v119, v119, v123, s[72:73]
    buffer_store_dwordx4 v[116:119], v167, s[16:19], s88 offen offset:2048 sc1
    buffer_store_dwordx4 v[120:123], v169, s[16:19], s88 offen offset:2048 sc1
    v_mov_b32 v164, 0
    s_waitcnt vmcnt(18)
    v_cmp_gt_u32 vcc, 32, v162
    s_cbranch_vccz .Lok_1
.Lpoll_2:
    buffer_load_dword v162, v164, s[32:35], 0 offen sc1
    s_waitcnt vmcnt(0)
    v_cmp_gt_u32 vcc, 32, v162
    s_cbranch_vccz .Lgot_3
    s_sub_u32 s59, s59, 1
    s_cmp_lg_u32 s59, 0
    s_cbranch_scc1 .Lpoll_2
    s_branch .Lexit
.Lgot_3:
.Lok_1:
    s_waitcnt vmcnt(0)
    s_mov_b64 exec, 3
    buffer_atomic_add v225, v173, s[16:19], 0 offen sc1
    s_mov_b64 exec, -1
    s_mul_i32 s62, s52, 28
    s_lshr_b32 s63, s62, 4
    s_add_u32 s62, s62, 27
    s_lshr_b32 s64, s62, 4
    s_lshr_b32 s65, s51, 2
    s_lshr_b32 s66, s52, 1
    v_and_b32 v7, 3, v0
    v_add_u32 v7, s63, v7
    v_min_u32 v7, s64, v7
    v_mul_u32_u24 v244, 37456, v7
    v_lshrrev_b32 v244, 17, v244
    v_sub_u32 v244, s66, v244
    v_lshl_add_u32 v7, v7, 3, v244
    v_mov_b32 v244, s48
    v_mov_b32 v246, s65
    v_and_b32 v245, 4, v0
    v_cmp_ne_u32 vcc, 0, v245
    s_nop 1
    v_cndmask_b32 v244, v244, v246, vcc
    v_bfe_u32 v244, v0, 2, 2
    v_lshl_add_u32 v7, v244, 1, v7
    v_lshlrev_b32 v7, 7, v7
    s_lshl_b32 s62, s50, 9
    s_add_u32 s62, s62, 126976
    v_lshlrev_b32 v10, 7, v0
    v_add_u32 v14, s62, v10
    s_lshl_b32 s63, s57, 7
    s_add_u32 s63, s63, 126976
    v_and_b32 v9, 7, v0
    v_lshlrev_b32 v9, 9, v9
    v_add_u32 v9, s63, v9
    v_cmp_lt_u32 s[72:73], 31, v0
    v_lshrrev_b32 v244, 3, v0
    v_and_b32 v245, 7, v0
    v_xor_b32 v245, v245, v3
    v_lshlrev_b32 v244, 12, v244
    v_lshl_add_u32 v244, v245, 4, v244
    v_xor_b32 v245, 64, v244
    v_lshrrev_b32 v246, 1, v2
    v_xor_b32 v246, v246, v3
    v_lshlrev_b32 v246, 4, v246
    v_lshl_add_u32 v246, v2, 7, v246
    v_xor_b32 v247, 64, v246
    s_lshl_b32 s75, s48, 14
    s_mul_i32 s76, s48, 12288
    s_add_u32 s76, s76, 108544
    v_add_u32 v234, s75, v246
    v_add_u32 v235, s75, v247
    v_add_u32 v236, s76, v246
    v_add_u32 v237, s76, v247
    v_add_u32 v8, s76, v1
    s_lshl_b32 s74, s49, 18
    s_add_u32 s62, s48, 1
    s_and_b32 s62, s62, 3
    s_lshl_b32 s63, s62, 16
    s_lshl_b32 s64, s48, 10
    s_add_u32 s63, s63, s64
    s_add_u32 s64, s63, 4096
    v_add_u32 v226, s64, v244
    s_add_u32 s64, s63, 35840
    v_add_u32 v227, s64, v245
    s_add_u32 s63, s48, 3
    s_and_b32 s63, s63, 3
    s_mul_i32 s63, s63, 12288
    s_add_u32 s63, s63, 108544
    v_add_u32 v11, s63, v1
    s_lshl_b32 s63, s52, 6
    s_lshl_b32 s64, s51, 2
    s_add_u32 s63, s63, s64
    s_add_u32 s63, s63, s62
    s_lshl_b32 s63, s63, 11
    s_add_u32 s88, s63, 1048576
    s_add_u32 s62, s48, 2
    s_and_b32 s62, s62, 3
    s_lshl_b32 s63, s62, 16
    s_lshl_b32 s64, s48, 10
    s_add_u32 s63, s63, s64
    s_add_u32 s64, s63, 2048
    v_add_u32 v228, s64, v244
    s_add_u32 s64, s63, 33792
    v_add_u32 v229, s64, v245
    s_add_u32 s63, s48, 2
    s_and_b32 s63, s63, 3
    s_mul_i32 s63, s63, 12288
    s_add_u32 s63, s63, 112640
    v_add_u32 v12, s63, v1
    s_lshl_b32 s63, s52, 6
    s_lshl_b32 s64, s51, 2
    s_add_u32 s63, s63, s64
    s_add_u32 s63, s63, s62
    s_lshl_b32 s63, s63, 11
    s_add_u32 s89, s63, 1048576
    s_add_u32 s62, s48, 3
    s_and_b32 s62, s62, 3
    s_lshl_b32 s63, s62, 16
    s_lshl_b32 s64, s48, 10
    s_add_u32 s63, s63, s64
    s_add_u32 s64, s63, 4096
    v_add_u32 v230, s64, v244
    s_add_u32 s64, s63, 35840
    v_add_u32 v231, s64, v245
    s_add_u32 s63, s48, 1
    s_and_b32 s63, s63, 3
    s_mul_i32 s63, s63, 12288
    s_add_u32 s63, s63, 116736
    v_add_u32 v13, s63, v1
    s_lshl_b32 s63, s52, 6
    s_lshl_b32 s64, s51, 2
    s_add_u32 s63, s63, s64
    s_add_u32 s63, s63, s62
    s_lshl_b32 s63, s63, 11
    s_add_u32 s90, s63, 1048576
    s_add_u32 s62, s48, 4
    s_and_b32 s62, s62, 3
    s_lshl_b32 s63, s62, 16
    s_lshl_b32 s64, s48, 10
    s_add_u32 s63, s63, s64
    s_add_u32 s64, s63, 2048
    v_add_u32 v232, s64, v244
    s_add_u32 s64, s63, 33792
    v_add_u32 v233, s64, v245
    s_lshl_b32 s63, s52, 6
    s_lshl_b32 s64, s51, 2
    s_add_u32 s63, s63, s64
    s_add_u32 s63, s63, s62
    s_lshl_b32 s63, s63, 11
    s_add_u32 s91, s63, 1048576
    s_lshl_b32 s62, s52, 18
    s_add_u32 s62, s62, 3145728
    s_lshl_b32 s63, s51, 14
    s_add_u32 s92, s62, s63
    s_lshl_b32 s63, s48, 16
    s_add_u32 s93, s62, s63
    s_and_b32 s85, s50, 3
    s_lshl_b32 s85, s85, 8
    s_add_u32 s66, s85, 0
    s_and_b32 s66, s66, 1023
    s_add_u32 s36, s66, s74
    s_add_u32 s66, s85, 128
    s_and_b32 s66, s66, 1023
    s_add_u32 s37, s66, s74
    s_add_u32 s66, s85, 256
    s_and_b32 s66, s66, 1023
    s_add_u32 s38, s66, s74
    s_add_u32 s66, s85, 384
    s_and_b32 s66, s66, 1023
    s_add_u32 s39, s66, s74
    s_add_u32 s66, s85, 512
    s_and_b32 s66, s66, 1023
    s_add_u32 s40, s66, s74
    s_add_u32 s66, s85, 640
    s_and_b32 s66, s66, 1023
    s_add_u32 s41, s66, s74
    s_add_u32 s66, s85, 768
    s_and_b32 s66, s66, 1023
    s_add_u32 s42, s66, s74
    s_add_u32 s66, s85, 896
    s_and_b32 s66, s66, 1023
    s_add_u32 s43, s66, s74
    s_mul_i32 s63, s50, 215040
    s_mul_i32 s67, s48, 11264
    s_min_u32 s67, s67, 31744
    s_add_u32 s44, s63, s67
    s_add_u32 s44, s44, 20971520
    s_add_u32 s45, s67, 65536
    s_lshl_b32 s46, s50, 16
    s_mov_b32 s63, s48
    s_and_b32 s63, s63, 3
    s_lshl_b32 s63, s63, 14
    s_add_u32 s46, s46, s63
    s_add_u32 s46, s46, 19922944
    s_mul_i32 s47, s61, 14336
    s_mul_i32 s63, s50, 112
    s_add_u32 s47, s47, s63
    v_mul_u32_u24 v239, 896, v2
    v_lshl_add_u32 v239, v3, 4, v239
    s_lshl_b32 s88, s61, 5
    v_lshlrev_b32 v15, 1, v2
    s_branch .Lattn
.Lspare:
    s_lshl_b32 s74, s53, 2
    s_add_u32 s74, s74, s54
    s_sub_u32 s74, s74, 28
    s_lshl_b32 s74, s74, 2
    s_add_u32 s74, s74, s48
    s_lshl_b32 s63, s74, 10
    v_mov_b32 v8, 0
    v_mov_b32 v9, 0
    v_mov_b32 v10, 0
    v_mov_b32 v11, 0
    buffer_store_dwordx4 v[8:11], v1, s[16:19], s63 offen sc1
    s_sub_u32 s63, s54, 28
    s_lshl_b32 s63, s63, 2
    s_add_u32 s63, s63, s48
    s_lshl_b32 s63, s63, 13
    v_lshlrev_b32 v6, 7, v0
    v_add_u32 v6, s63, v6
    s_mov_b32 s63, .Lend-.Lpc0
    v_min_u32 v6, s63, v6
    global_load_dword v250, v6, s[86:87]
    s_waitcnt vmcnt(1)
    s_barrier
    s_cmp_lg_u32 s48, 0
    s_cbranch_scc1 .Lnozero
    s_mov_b64 exec, 1
    buffer_atomic_add v225, v8, s[32:35], 0 offen sc1
    s_mov_b64 exec, -1
.Lnozero:
    v_lshlrev_b32 v100, 7, v0
    s_mul_i32 s63, s74, 6272
    s_mul_i32 s64, s74, 3200
    s_mov_b32 exec_hi, 0x1ffff
    buffer_load_dword v101, v100, s[44:47], s63 offen
    s_mov_b64 exec, 0x1ffffff
    buffer_load_dword v102, v100, s[36:39], s64 offen
    s_mov_b64 exec, -1
    s_mul_i32 s62, s74, 2341
    s_lshr_b32 s75, s62, 16
    s_mul_i32 s62, s75, 28
    s_sub_u32 s76, s74, s62
    s_mul_i32 s62, s75, 401408
    s_lshl_b32 s63, s76, 7
    s_add_u32 s62, s62, s63
    v_lshrrev_b32 v6, 3, v0
    v_and_b32 v7, 7, v0
    v_mul_u32_u24 v14, 3584, v6
    v_lshl_add_u32 v14, v7, 4, v14
    s_add_u32 s63, s62, 0
    buffer_load_dwordx4 v[16:19], v14, s[40:43], s63 offen
    s_add_u32 s63, s62, 28672
    buffer_load_dwordx4 v[20:23], v14, s[40:43], s63 offen
    s_add_u32 s63, s62, 57344
    buffer_load_dwordx4 v[24:27], v14, s[40:43], s63 offen
    s_add_u32 s63, s62, 86016
    buffer_load_dwordx4 v[28:31], v14, s[40:43], s63 offen
    s_add_u32 s63, s62, 114688
    buffer_load_dwordx4 v[32:35], v14, s[40:43], s63 offen
    s_add_u32 s63, s62, 143360
    buffer_load_dwordx4 v[36:39], v14, s[40:43], s63 offen
    s_add_u32 s63, s62, 172032
    buffer_load_dwordx4 v[40:43], v14, s[40:43], s63 offen
    s_add_u32 s63, s62, 200704
    buffer_load_dwordx4 v[44:47], v14, s[40:43], s63 offen
    s_add_u32 s63, s62, 229376
    buffer_load_dwordx4 v[48:51], v14, s[40:43], s63 offen
    s_add_u32 s63, s62, 258048
    buffer_load_dwordx4 v[52:55], v14, s[40:43], s63 offen
    s_add_u32 s63, s62, 286720
    buffer_load_dwordx4 v[56:59], v14, s[40:43], s63 offen
    s_add_u32 s63, s62, 315392
    buffer_load_dwordx4 v[60:63], v14, s[40:43], s63 offen
    s_add_u32 s63, s62, 344064
    buffer_load_dwordx4 v[64:67], v14, s[40:43], s63 offen
    s_add_u32 s63, s62, 372736
    buffer_load_dwordx4 v[68:71], v14, s[40:43], s63 offen
    s_lshl_b32 s63, s76, 6
    v_lshl_add_u32 v80, v7, 3, v6
    v_add_u32 v80, s63, v80
    v_cmp_gt_u32 vcc, 896, v80
    v_subrev_u32 v81, 896, v80
    s_nop 0
    v_cndmask_b32 v81, v81, v80, vcc
    v_cndmask_b32 v80, 0, v225, vcc
    v_lshrrev_b32 v82, 4, v81
    v_mul_u32_u24 v82, 37, v82
    v_lshrrev_b32 v82, 8, v82
    v_mul_u32_u24 v83, 112, v82
    v_sub_u32 v81, v81, v83
    v_lshl_add_u32 v82, v82, 1, v80
    v_mul_u32_u24 v82, 105, v82
    v_lshrrev_b32 v83, 5, v81
    v_bfe_u32 v80, v81, 2, 1
    v_lshl_add_u32 v83, v83, 1, v80
    v_bfe_u32 v84, v81, 3, 2
    v_and_b32 v80, 3, v81
    v_lshl_add_u32 v84, v84, 2, v80
    v_cmp_gt_u32 vcc, 96, v81
    v_subrev_u32 v80, 96, v81
    s_nop 0
    v_cndmask_b32 v84, v80, v84, vcc
    v_cndmask_b32 v83, 6, v83, vcc
    v_add_u32 v82, v82, v83
    v_lshlrev_b32 v82, 10, v82
    v_lshl_add_u32 v82, v84, 4, v82
    s_lshl_b32 s63, s75, 8
    s_add_u32 s63, s63, 21071872
    s_cmp_ge_u32 s74, 112
    s_cselect_b32 s77, 2130706432, s63
    s_cmp_ge_u32 s61, 56
    s_cselect_b32 s62, 1, 0
    s_mul_i32 s63, s62, 56
    s_sub_u32 s63, s61, s63
    s_lshr_b32 s63, s63, 2
    s_and_b32 s64, s61, 3
    s_mul_i32 s94, s63, 114688
    s_mul_i32 s65, s50, 224
    s_add_u32 s94, s94, s65
    s_lshl_b32 s65, s64, 6
    s_add_u32 s94, s94, s65
    s_xor_b32 s65, s62, 1
    s_mul_i32 s65, s65, 1792
    s_add_u32 s94, s94, s65
    s_lshl_b32 s95, s50, 1
    s_add_u32 s95, s95, s62
    s_mul_i32 s95, s95, 105
    s_mul_i32 s65, s63, 7
    s_add_u32 s95, s95, s65
    s_lshl_b32 s65, s64, 1
    s_add_u32 s95, s95, s65
    s_lshl_b32 s95, s95, 10
    s_add_u32 s95, s95, 20971520
    s_cmp_ge_u32 s61, 112
    s_cselect_b32 s94, 2130706432, s94
    s_cselect_b32 s95, 2130706432, s95
    s_cmp_eq_u32 s64, 3
    s_cselect_b64 vcc, -1, 0
    s_mul_i32 s66, s48, 4096
    s_add_u32 s66, s66, 131072
    v_and_b32 v7, 3, v2
    v_add_u32 v252, s66, v1
    v_and_b32 v6, 60, v0
    v_lshrrev_b32 v253, 1, v7
    v_add_u32 v6, v6, v253
    v_lshlrev_b32 v6, 4, v6
    v_and_b32 v253, 1, v7
    v_lshl_add_u32 v6, v253, 3, v6
    v_add_u32 v6, s66, v6
    v_mov_b32 v238, 2130706432
    v_cndmask_b32 v253, v252, v6, vcc
    v_cndmask_b32 v238, v1, v238, vcc
    v_lshrrev_b32 v8, 2, v2
    v_lshl_add_u32 v6, v3, 3, v8
    v_mul_u32_u24 v240, 3584, v6
    v_lshl_add_u32 v240, v7, 4, v240
    v_lshrrev_b32 v241, 1, v3
    v_lshlrev_b32 v241, 4, v241
    v_and_b32 v9, 1, v3
    v_lshl_add_u32 v241, v9, 2, v241
    v_add_u32 v241, v241, v8
    s_mov_b32 s101, 3584
    s_mov_b32 s63, 28672
    s_mov_b32 s65, 23068672
    s_cmp_ge_u32 s61, 96
    s_cselect_b64 vcc, -1, 0
    s_cselect_b64 s[4:5], s[36:37], s[44:45]
    s_cselect_b32 s6, s38, s46
    s_cselect_b32 s101, 7168, s101
    s_cselect_b32 s62, 96, 0
    s_cselect_b32 s63, 25088, s63
    s_cselect_b32 s64, 16, 28
    s_cselect_b32 s65, 19922944, s65
    s_mov_b32 s7, 0x20000
    s_sub_u32 s62, s61, s62
    s_lshr_b32 s62, s62, 1
    s_mul_i32 s3, s62, s63
    s_mul_i32 s63, s50, 112
    s_add_u32 s3, s3, s63
    s_and_b32 s63, s61, 1
    s_lshl_b32 s66, s63, 6
    s_add_u32 s3, s3, s66
    s_mul_i32 s81, s50, s64
    s_add_u32 s81, s81, s62
    s_lshl_b32 s81, s81, 1
    s_add_u32 s81, s81, s63
    s_lshl_b32 s81, s81, 11
    s_add_u32 s81, s81, s65
    s_sub_u32 s62, s61, 56
    s_cmp_lt_u32 s62, 40
    s_cselect_b32 s3, 2130706432, s3
    s_cselect_b32 s81, 2130706432, s81
    v_cndmask_b32 v241, v6, v241, vcc
    v_mul_u32_u24 v241, 896, v241
    v_lshl_add_u32 v241, v7, 4, v241
    s_mul_i32 s80, s48, 4096
    s_add_u32 m0, s80, 131072
    s_nop 0
    buffer_load_dwordx4 v240, s[40:43], s94 offen lds
    s_add_u32 s79, s94, 13312
    buffer_load_dwordx4 v240, s[40:43], s79 offen offset:1024 lds
    s_add_u32 m0, s80, 133120
    s_nop 0
    buffer_load_dwordx4 v241, s[4:7], s3 offen lds
    s_add_u32 s79, s3, s101
    s_sub_u32 s79, s79, 1024
    buffer_load_dwordx4 v241, s[4:7], s79 offen offset:1024 lds
    s_lshl_b32 s62, s61, 3
    s_add_u32 s62, s62, s50
    s_lshl_b32 s62, s62, 7
    s_add_u32 s62, s62, 131072
    v_mov_b32 v8, -1
    v_mov_b32 v9, -1
    v_mov_b32 v10, -1
    v_mov_b32 v11, -1
    s_mov_b64 exec, 0xff
    buffer_store_dwordx4 v[8:11], v1, s[16:19], s62 offen sc1
    s_mov_b64 exec, -1
    s_waitcnt vmcnt(18)
    v_lshlrev_b32 v72, 16, v16
    v_and_b32 v73, 0xffff0000, v16
    v_lshlrev_b32 v74, 16, v17
    v_and_b32 v75, 0xffff0000, v17
    v_lshlrev_b32 v76, 16, v18
    v_and_b32 v77, 0xffff0000, v18
    v_lshlrev_b32 v78, 16, v19
    v_and_b32 v79, 0xffff0000, v19
    s_waitcnt vmcnt(17)
    v_lshlrev_b32 v86, 16, v20
    v_and_b32 v87, 0xffff0000, v20
    v_pk_add_f32 v[72:73], v[72:73], v[86:87]
    v_lshlrev_b32 v88, 16, v21
    v_and_b32 v89, 0xffff0000, v21
    v_pk_add_f32 v[74:75], v[74:75], v[88:89]
    v_lshlrev_b32 v86, 16, v22
    v_and_b32 v87, 0xffff0000, v22
    v_pk_add_f32 v[76:77], v[76:77], v[86:87]
    v_lshlrev_b32 v88, 16, v23
    v_and_b32 v89, 0xffff0000, v23
    v_pk_add_f32 v[78:79], v[78:79], v[88:89]
    s_waitcnt vmcnt(16)
    v_lshlrev_b32 v86, 16, v24
    v_and_b32 v87, 0xffff0000, v24
    v_pk_add_f32 v[72:73], v[72:73], v[86:87]
    v_lshlrev_b32 v88, 16, v25
    v_and_b32 v89, 0xffff0000, v25
    v_pk_add_f32 v[74:75], v[74:75], v[88:89]
    v_lshlrev_b32 v86, 16, v26
    v_and_b32 v87, 0xffff0000, v26
    v_pk_add_f32 v[76:77], v[76:77], v[86:87]
    v_lshlrev_b32 v88, 16, v27
    v_and_b32 v89, 0xffff0000, v27
    v_pk_add_f32 v[78:79], v[78:79], v[88:89]
    s_waitcnt vmcnt(15)
    v_lshlrev_b32 v86, 16, v28
    v_and_b32 v87, 0xffff0000, v28
    v_pk_add_f32 v[72:73], v[72:73], v[86:87]
    v_lshlrev_b32 v88, 16, v29
    v_and_b32 v89, 0xffff0000, v29
    v_pk_add_f32 v[74:75], v[74:75], v[88:89]
    v_lshlrev_b32 v86, 16, v30
    v_and_b32 v87, 0xffff0000, v30
    v_pk_add_f32 v[76:77], v[76:77], v[86:87]
    v_lshlrev_b32 v88, 16, v31
    v_and_b32 v89, 0xffff0000, v31
    v_pk_add_f32 v[78:79], v[78:79], v[88:89]
    s_waitcnt vmcnt(14)
    v_lshlrev_b32 v86, 16, v32
    v_and_b32 v87, 0xffff0000, v32
    v_pk_add_f32 v[72:73], v[72:73], v[86:87]
    v_lshlrev_b32 v88, 16, v33
    v_and_b32 v89, 0xffff0000, v33
    v_pk_add_f32 v[74:75], v[74:75], v[88:89]
    v_lshlrev_b32 v86, 16, v34
    v_and_b32 v87, 0xffff0000, v34
    v_pk_add_f32 v[76:77], v[76:77], v[86:87]
    v_lshlrev_b32 v88, 16, v35
    v_and_b32 v89, 0xffff0000, v35
    v_pk_add_f32 v[78:79], v[78:79], v[88:89]
    s_waitcnt vmcnt(13)
    v_lshlrev_b32 v86, 16, v36
    v_and_b32 v87, 0xffff0000, v36
    v_pk_add_f32 v[72:73], v[72:73], v[86:87]
    v_lshlrev_b32 v88, 16, v37
    v_and_b32 v89, 0xffff0000, v37
    v_pk_add_f32 v[74:75], v[74:75], v[88:89]
    v_lshlrev_b32 v86, 16, v38
    v_and_b32 v87, 0xffff0000, v38
    v_pk_add_f32 v[76:77], v[76:77], v[86:87]
    v_lshlrev_b32 v88, 16, v39
    v_and_b32 v89, 0xffff0000, v39
    v_pk_add_f32 v[78:79], v[78:79], v[88:89]
    s_waitcnt vmcnt(12)
    v_lshlrev_b32 v86, 16, v40
    v_and_b32 v87, 0xffff0000, v40
    v_pk_add_f32 v[72:73], v[72:73], v[86:87]
    v_lshlrev_b32 v88, 16, v41
    v_and_b32 v89, 0xffff0000, v41
    v_pk_add_f32 v[74:75], v[74:75], v[88:89]
    v_lshlrev_b32 v86, 16, v42
    v_and_b32 v87, 0xffff0000, v42
    v_pk_add_f32 v[76:77], v[76:77], v[86:87]
    v_lshlrev_b32 v88, 16, v43
    v_and_b32 v89, 0xffff0000, v43
    v_pk_add_f32 v[78:79], v[78:79], v[88:89]
    s_waitcnt vmcnt(11)
    v_lshlrev_b32 v86, 16, v44
    v_and_b32 v87, 0xffff0000, v44
    v_pk_add_f32 v[72:73], v[72:73], v[86:87]
    v_lshlrev_b32 v88, 16, v45
    v_and_b32 v89, 0xffff0000, v45
    v_pk_add_f32 v[74:75], v[74:75], v[88:89]
    v_lshlrev_b32 v86, 16, v46
    v_and_b32 v87, 0xffff0000, v46
    v_pk_add_f32 v[76:77], v[76:77], v[86:87]
    v_lshlrev_b32 v88, 16, v47
    v_and_b32 v89, 0xffff0000, v47
    v_pk_add_f32 v[78:79], v[78:79], v[88:89]
    s_waitcnt vmcnt(10)
    v_lshlrev_b32 v86, 16, v48
    v_and_b32 v87, 0xffff0000, v48
    v_pk_add_f32 v[72:73], v[72:73], v[86:87]
    v_lshlrev_b32 v88, 16, v49
    v_and_b32 v89, 0xffff0000, v49
    v_pk_add_f32 v[74:75], v[74:75], v[88:89]
    v_lshlrev_b32 v86, 16, v50
    v_and_b32 v87, 0xffff0000, v50
    v_pk_add_f32 v[76:77], v[76:77], v[86:87]
    v_lshlrev_b32 v88, 16, v51
    v_and_b32 v89, 0xffff0000, v51
    v_pk_add_f32 v[78:79], v[78:79], v[88:89]
    s_waitcnt vmcnt(9)
    v_lshlrev_b32 v86, 16, v52
    v_and_b32 v87, 0xffff0000, v52
    v_pk_add_f32 v[72:73], v[72:73], v[86:87]
    v_lshlrev_b32 v88, 16, v53
    v_and_b32 v89, 0xffff0000, v53
    v_pk_add_f32 v[74:75], v[74:75], v[88:89]
    v_lshlrev_b32 v86, 16, v54
    v_and_b32 v87, 0xffff0000, v54
    v_pk_add_f32 v[76:77], v[76:77], v[86:87]
    v_lshlrev_b32 v88, 16, v55
    v_and_b32 v89, 0xffff0000, v55
    v_pk_add_f32 v[78:79], v[78:79], v[88:89]
    s_waitcnt vmcnt(8)
    v_lshlrev_b32 v86, 16, v56
    v_and_b32 v87, 0xffff0000, v56
    v_pk_add_f32 v[72:73], v[72:73], v[86:87]
    v_lshlrev_b32 v88, 16, v57
    v_and_b32 v89, 0xffff0000, v57
    v_pk_add_f32 v[74:75], v[74:75], v[88:89]
    v_lshlrev_b32 v86, 16, v58
    v_and_b32 v87, 0xffff0000, v58
    v_pk_add_f32 v[76:77], v[76:77], v[86:87]
    v_lshlrev_b32 v88, 16, v59
    v_and_b32 v89, 0xffff0000, v59
    v_pk_add_f32 v[78:79], v[78:79], v[88:89]
    s_waitcnt vmcnt(7)
    v_lshlrev_b32 v86, 16, v60
    v_and_b32 v87, 0xffff0000, v60
    v_pk_add_f32 v[72:73], v[72:73], v[86:87]
    v_lshlrev_b32 v88, 16, v61
    v_and_b32 v89, 0xffff0000, v61
    v_pk_add_f32 v[74:75], v[74:75], v[88:89]
    v_lshlrev_b32 v86, 16, v62
    v_and_b32 v87, 0xffff0000, v62
    v_pk_add_f32 v[76:77], v[76:77], v[86:87]
    v_lshlrev_b32 v88, 16, v63
    v_and_b32 v89, 0xffff0000, v63
    v_pk_add_f32 v[78:79], v[78:79], v[88:89]
    s_waitcnt vmcnt(6)
    v_lshlrev_b32 v86, 16, v64
    v_and_b32 v87, 0xffff0000, v64
    v_pk_add_f32 v[72:73], v[72:73], v[86:87]
    v_lshlrev_b32 v88, 16, v65
    v_and_b32 v89, 0xffff0000, v65
    v_pk_add_f32 v[74:75], v[74:75], v[88:89]
    v_lshlrev_b32 v86, 16, v66
    v_and_b32 v87, 0xffff0000, v66
    v_pk_add_f32 v[76:77], v[76:77], v[86:87]
    v_lshlrev_b32 v88, 16, v67
    v_and_b32 v89, 0xffff0000, v67
    v_pk_add_f32 v[78:79], v[78:79], v[88:89]
    s_waitcnt vmcnt(5)
    v_lshlrev_b32 v86, 16, v68
    v_and_b32 v87, 0xffff0000, v68
    v_pk_add_f32 v[72:73], v[72:73], v[86:87]
    v_lshlrev_b32 v88, 16, v69
    v_and_b32 v89, 0xffff0000, v69
    v_pk_add_f32 v[74:75], v[74:75], v[88:89]
    v_lshlrev_b32 v86, 16, v70
    v_and_b32 v87, 0xffff0000, v70
    v_pk_add_f32 v[76:77], v[76:77], v[86:87]
    v_lshlrev_b32 v88, 16, v71
    v_and_b32 v89, 0xffff0000, v71
    v_pk_add_f32 v[78:79], v[78:79], v[88:89]
    v_permlane32_swap_b32 v72, v76
    v_permlane32_swap_b32 v73, v77
    v_permlane32_swap_b32 v74, v78
    v_permlane32_swap_b32 v75, v79
    v_add_f32 v72, v72, v76
    v_add_f32 v73, v73, v77
    v_add_f32 v74, v74, v78
    v_add_f32 v75, v75, v79
    s_nop 0
    v_permlane16_swap_b32 v72, v74
    v_permlane16_swap_b32 v73, v75
    v_add_f32 v72, v72, v74
    v_add_f32 v73, v73, v75
    s_nop 0
    v_add_f32_dpp v72, v72, v72 row_ror:8 row_mask:0xf bank_mask:0xf
    v_add_f32_dpp v73, v73, v73 row_ror:8 row_mask:0xf bank_mask:0xf
    s_nop 1
    v_mov_b32_dpp v72, v73 quad_perm:[0,1,2,3] row_mask:0xf bank_mask:0xc
    v_cvt_pk_bf16_f32 v16, v72, v72
    v_and_b32 v73, 0xffff0000, v16
    v_sub_f32 v72, v72, v73
    v_cvt_pk_bf16_f32 v17, v72, v72
    v_mov_b32 v18, 0
    v_mov_b32 v19, 0
    buffer_store_dwordx4 v[16:19], v82, s[16:19], s77 offen sc1
    s_waitcnt vmcnt(2)
    ds_read_b64_tr_b16 a[0:1], v253
    ds_read_b64_tr_b16 a[2:3], v253 offset:1024
    ds_read_b64_tr_b16 a[4:5], v252 offset:8
    ds_read_b64_tr_b16 a[6:7], v252 offset:1032
    ds_read_b64_tr_b16 a[8:9], v252 offset:2048
    ds_read_b64_tr_b16 a[10:11], v252 offset:3072
    ds_read_b64_tr_b16 a[12:13], v252 offset:2056
    ds_read_b64_tr_b16 a[14:15], v252 offset:3080
    s_waitcnt lgkmcnt(6)
    buffer_store_dwordx4 a[0:3], v1, s[16:19], s95 offen sc1
    s_waitcnt lgkmcnt(4)
    buffer_store_dwordx4 a[4:7], v238, s[16:19], s95 offen offset:1024 sc1
    s_waitcnt lgkmcnt(2)
    buffer_store_dwordx4 a[8:11], v1, s[16:19], s81 offen sc1
    s_waitcnt lgkmcnt(0)
    buffer_store_dwordx4 a[12:15], v1, s[16:19], s81 offen offset:1024 sc1
    s_mul_i32 s91, s61, 14336
    s_mul_i32 s92, s50, 1792
    s_add_u32 s91, s91, s92
    s_add_u32 s91, s91, 9437184
    v_cmp_eq_u32 vcc, 3, v3
    v_mov_b32 v245, 2130706432
    s_nop 0
    v_cndmask_b32 v245, v1, v245, vcc
    v_mov_b32 v248, -1
    v_mov_b32 v249, -1
    v_mov_b32 v250, -1
    v_mov_b32 v251, -1
    buffer_store_dwordx4 v[248:251], v1, s[16:19], s91 offen sc1
    buffer_store_dwordx4 v[248:251], v245, s[16:19], s91 offen offset:1024 sc1
    v_mov_b32 v12, 0
.Lpoll_4:
    buffer_load_dword v13, v12, s[32:35], 0 offen sc1
    s_waitcnt vmcnt(0)
    v_cmp_gt_u32 vcc, 32, v13
    s_cbranch_vccz .Lgot_5
    s_sub_u32 s59, s59, 1
    s_cmp_lg_u32 s59, 0
    s_cbranch_scc1 .Lpoll_4
    s_branch .Lexit
.Lgot_5:
    v_lshlrev_b32 v15, 7, v0
    v_add_u32 v15, 126976, v15
    s_barrier
    s_cmp_lg_u32 s48, 0
    s_cbranch_scc1 .Lnoarr_6
    s_mov_b32 exec_hi, 0
    buffer_atomic_add v225, v15, s[16:19], 0 offen sc1
    s_mov_b64 exec, -1
.Lnoarr_6:
    s_mul_i32 s62, s52, 28
    s_lshr_b32 s63, s62, 4
    s_add_u32 s62, s62, 27
    s_lshr_b32 s64, s62, 4
    s_lshr_b32 s65, s51, 2
    s_lshr_b32 s66, s52, 1
    v_and_b32 v7, 3, v0
    v_add_u32 v7, s63, v7
    v_min_u32 v7, s64, v7
    v_mul_u32_u24 v244, 37456, v7
    v_lshrrev_b32 v244, 17, v244
    v_sub_u32 v244, s66, v244
    v_lshl_add_u32 v7, v7, 3, v244
    v_mov_b32 v244, s48
    v_mov_b32 v246, s65
    v_and_b32 v245, 4, v0
    v_cmp_ne_u32 vcc, 0, v245
    s_nop 1
    v_cndmask_b32 v244, v244, v246, vcc
    v_bfe_u32 v244, v0, 2, 2
    v_lshl_add_u32 v7, v244, 1, v7
    v_lshlrev_b32 v7, 7, v7
    s_lshl_b32 s62, s50, 9
    s_add_u32 s62, s62, 126976
    v_lshlrev_b32 v10, 7, v0
    v_add_u32 v14, s62, v10
    s_lshl_b32 s63, s57, 7
    s_add_u32 s63, s63, 126976
    v_and_b32 v9, 7, v0
    v_lshlrev_b32 v9, 9, v9
    v_add_u32 v9, s63, v9
    v_cmp_lt_u32 s[72:73], 31, v0
    v_lshrrev_b32 v244, 3, v0
    v_and_b32 v245, 7, v0
    v_xor_b32 v245, v245, v3
    v_lshlrev_b32 v244, 12, v244
    v_lshl_add_u32 v244, v245, 4, v244
    v_xor_b32 v245, 64, v244
    v_lshrrev_b32 v246, 1, v2
    v_xor_b32 v246, v246, v3
    v_lshlrev_b32 v246, 4, v246
    v_lshl_add_u32 v246, v2, 7, v246
    v_xor_b32 v247, 64, v246
    s_lshl_b32 s75, s48, 14
    s_mul_i32 s76, s48, 12288
    s_add_u32 s76, s76, 108544
    v_add_u32 v234, s75, v246
    v_add_u32 v235, s75, v247
    v_add_u32 v236, s76, v246
    v_add_u32 v237, s76, v247
    v_add_u32 v8, s76, v1
    s_lshl_b32 s74, s49, 18
    s_add_u32 s62, s48, 1
    s_and_b32 s62, s62, 3
    s_lshl_b32 s63, s62, 16
    s_lshl_b32 s64, s48, 10
    s_add_u32 s63, s63, s64
    s_add_u32 s64, s63, 4096
    v_add_u32 v226, s64, v244
    s_add_u32 s64, s63, 35840
    v_add_u32 v227, s64, v245
    s_add_u32 s63, s48, 3
    s_and_b32 s63, s63, 3
    s_mul_i32 s63, s63, 12288
    s_add_u32 s63, s63, 108544
    v_add_u32 v11, s63, v1
    s_lshl_b32 s63, s52, 6
    s_lshl_b32 s64, s51, 2
    s_add_u32 s63, s63, s64
    s_add_u32 s63, s63, s62
    s_lshl_b32 s63, s63, 11
    s_add_u32 s88, s63, 1048576
    s_add_u32 s62, s48, 2
    s_and_b32 s62, s62, 3
    s_lshl_b32 s63, s62, 16
    s_lshl_b32 s64, s48, 10
    s_add_u32 s63, s63, s64
    s_add_u32 s64, s63, 2048
    v_add_u32 v228, s64, v244
    s_add_u32 s64, s63, 33792
    v_add_u32 v229, s64, v245
    s_add_u32 s63, s48, 2
    s_and_b32 s63, s63, 3
    s_mul_i32 s63, s63, 12288
    s_add_u32 s63, s63, 112640
    v_add_u32 v12, s63, v1
    s_lshl_b32 s63, s52, 6
    s_lshl_b32 s64, s51, 2
    s_add_u32 s63, s63, s64
    s_add_u32 s63, s63, s62
    s_lshl_b32 s63, s63, 11
    s_add_u32 s89, s63, 1048576
    s_add_u32 s62, s48, 3
    s_and_b32 s62, s62, 3
    s_lshl_b32 s63, s62, 16
    s_lshl_b32 s64, s48, 10
    s_add_u32 s63, s63, s64
    s_add_u32 s64, s63, 4096
    v_add_u32 v230, s64, v244
    s_add_u32 s64, s63, 35840
    v_add_u32 v231, s64, v245
    s_add_u32 s63, s48, 1
    s_and_b32 s63, s63, 3
    s_mul_i32 s63, s63, 12288
    s_add_u32 s63, s63, 116736
    v_add_u32 v13, s63, v1
    s_lshl_b32 s63, s52, 6
    s_lshl_b32 s64, s51, 2
    s_add_u32 s63, s63, s64
    s_add_u32 s63, s63, s62
    s_lshl_b32 s63, s63, 11
    s_add_u32 s90, s63, 1048576
    s_add_u32 s62, s48, 4
    s_and_b32 s62, s62, 3
    s_lshl_b32 s63, s62, 16
    s_lshl_b32 s64, s48, 10
    s_add_u32 s63, s63, s64
    s_add_u32 s64, s63, 2048
    v_add_u32 v232, s64, v244
    s_add_u32 s64, s63, 33792
    v_add_u32 v233, s64, v245
    s_lshl_b32 s63, s52, 6
    s_lshl_b32 s64, s51, 2
    s_add_u32 s63, s63, s64
    s_add_u32 s63, s63, s62
    s_lshl_b32 s63, s63, 11
    s_add_u32 s91, s63, 1048576
    s_lshl_b32 s62, s52, 18
    s_add_u32 s62, s62, 3145728
    s_lshl_b32 s63, s51, 14
    s_add_u32 s92, s62, s63
    s_lshl_b32 s63, s48, 16
    s_add_u32 s93, s62, s63
    s_and_b32 s85, s50, 3
    s_lshl_b32 s85, s85, 8
    s_add_u32 s66, s85, 0
    s_and_b32 s66, s66, 1023
    s_add_u32 s36, s66, s74
    s_add_u32 s66, s85, 128
    s_and_b32 s66, s66, 1023
    s_add_u32 s37, s66, s74
    s_add_u32 s66, s85, 256
    s_and_b32 s66, s66, 1023
    s_add_u32 s38, s66, s74
    s_add_u32 s66, s85, 384
    s_and_b32 s66, s66, 1023
    s_add_u32 s39, s66, s74
    s_add_u32 s66, s85, 512
    s_and_b32 s66, s66, 1023
    s_add_u32 s40, s66, s74
    s_add_u32 s66, s85, 640
    s_and_b32 s66, s66, 1023
    s_add_u32 s41, s66, s74
    s_add_u32 s66, s85, 768
    s_and_b32 s66, s66, 1023
    s_add_u32 s42, s66, s74
    s_add_u32 s66, s85, 896
    s_and_b32 s66, s66, 1023
    s_add_u32 s43, s66, s74
    s_mul_i32 s63, s50, 215040
    s_mul_i32 s67, s48, 11264
    s_min_u32 s67, s67, 31744
    s_add_u32 s44, s63, s67
    s_add_u32 s44, s44, 20971520
    s_add_u32 s45, s67, 65536
    s_lshl_b32 s46, s50, 16
    s_mov_b32 s63, s48
    s_and_b32 s63, s63, 3
    s_lshl_b32 s63, s63, 14
    s_add_u32 s46, s46, s63
    s_add_u32 s46, s46, 19922944
    s_mul_i32 s47, s61, 14336
    s_mul_i32 s63, s50, 112
    s_add_u32 s47, s47, s63
    v_mul_u32_u24 v239, 896, v2
    v_lshl_add_u32 v239, v3, 4, v239
    s_lshl_b32 s88, s61, 5
    v_lshlrev_b32 v15, 1, v2
.Lattn:
    s_cmp_lg_u32 s48, 0
    s_cbranch_scc1 .Lnopoll_7
.Lpoll_8:
    buffer_load_dword v6, v7, s[16:19], 0 offen sc1
    s_waitcnt vmcnt(0)
    v_cmp_gt_u32 vcc, 8, v6
    s_cbranch_vccz .Lgot_9
    s_sub_u32 s59, s59, 1
    s_cmp_lg_u32 s59, 0
    s_cbranch_scc1 .Lpoll_8
    s_branch .Lexit
.Lgot_9:
.Lnopoll_7:
    s_barrier
    buffer_load_dwordx4 v[200:203], v1, s[16:19], s92 offen sc1
    buffer_load_dwordx4 v[40:43], v1, s[16:19], s91 offen sc1
    buffer_load_dwordx4 v[204:207], v1, s[16:19], s92 offen offset:1024 sc1
    buffer_load_dwordx4 v[44:47], v1, s[16:19], s91 offen offset:1024 sc1
    s_lshl_b32 s84, s51, 12
    s_add_u32 s84, s84, 4096
    s_and_b32 s84, s84, 0xffff
    s_add_u32 s78, s93, s84
    buffer_load_dwordx4 a[16:19], v1, s[16:19], s78 offen sc1
    buffer_load_dwordx4 a[20:23], v1, s[16:19], s78 offen offset:1024 sc1
    buffer_load_dwordx4 a[80:83], v1, s[16:19], s78 offen offset:2048 sc1
    buffer_load_dwordx4 a[84:87], v1, s[16:19], s78 offen offset:3072 sc1
    s_add_u32 s62, s48, 1
    s_and_b32 s62, s62, 3
    s_lshl_b32 s62, s62, 11
    v_add_u32 v248, s62, v4
    s_add_u32 s62, s48, 2
    s_and_b32 s62, s62, 3
    s_lshl_b32 s62, s62, 11
    v_add_u32 v249, s62, v4
    s_add_u32 s62, s48, 3
    s_and_b32 s62, s62, 3
    s_lshl_b32 s62, s62, 11
    v_add_u32 v250, s62, v4
    s_add_u32 s62, s48, 4
    s_and_b32 s62, s62, 3
    s_lshl_b32 s62, s62, 11
    v_add_u32 v251, s62, v4
    s_waitcnt vmcnt(6)
    v_mfma_f32_32x32x16_bf16 v[128:143], v[200:203], v[40:43], 0
    s_waitcnt vmcnt(4)
    v_mfma_f32_32x32x16_bf16 v[128:143], v[204:207], v[44:47], v[128:143]
    s_add_u32 s84, s84, 4096
    s_and_b32 s84, s84, 0xffff
    s_add_u32 s78, s93, s84
    buffer_load_dwordx4 a[144:147], v1, s[16:19], s78 offen sc1
    buffer_load_dwordx4 a[148:151], v1, s[16:19], s78 offen offset:1024 sc1
    buffer_load_dwordx4 a[208:211], v1, s[16:19], s78 offen offset:2048 sc1
    buffer_load_dwordx4 a[212:215], v1, s[16:19], s78 offen offset:3072 sc1
    s_nop 4
    v_max3_f32 v243, v128, v129, v130
    v_max3_f32 v243, v131, v132, v243
    v_max3_f32 v243, v133, v134, v243
    v_max3_f32 v243, v135, v136, v243
    v_max3_f32 v243, v137, v138, v243
    v_max3_f32 v243, v139, v140, v243
    v_max3_f32 v243, v141, v142, v243
    v_max_f32 v243, v143, v243
    v_mov_b32 v247, v243
    s_nop 1
    v_permlane32_swap_b32 v247, v243
    v_max_f32 v243, v247, v243
    v_sub_f32 v243, 0, v243
    v_cvt_pk_bf16_f32 v244, v243, 0
    v_cndmask_b32 v46, v46, v244, s[72:73]
    ds_write_b128 v251, v[40:43] offset:32768
    ds_write_b128 v251, v[44:47] offset:33792
    s_add_u32 s84, s84, 4096
    s_and_b32 s84, s84, 0xffff
    s_add_u32 s78, s93, s84
    buffer_load_dwordx4 a[24:27], v1, s[16:19], s78 offen sc1
    buffer_load_dwordx4 a[28:31], v1, s[16:19], s78 offen offset:1024 sc1
    buffer_load_dwordx4 a[88:91], v1, s[16:19], s78 offen offset:2048 sc1
    buffer_load_dwordx4 a[92:95], v1, s[16:19], s78 offen offset:3072 sc1
    s_waitcnt lgkmcnt(0)
    s_barrier
    ds_read_b128 v[16:19], v248 offset:32768
    ds_read_b128 v[20:23], v248 offset:33792
    ds_read_b128 v[24:27], v249 offset:32768
    ds_read_b128 v[28:31], v249 offset:33792
    ds_read_b128 v[32:35], v250 offset:32768
    ds_read_b128 v[36:39], v250 offset:33792
    v_and_b32 v7, 1, v3
    v_lshlrev_b32 v7, 10, v7
    v_lshrrev_b32 v244, 1, v3
    v_lshl_add_u32 v7, v244, 8, v7
    v_lshl_add_u32 v7, v2, 4, v7
    s_mul_i32 s89, s61, 14336
    s_mul_i32 s64, s50, 1792
    s_add_u32 s89, s89, s64
    s_add_u32 s89, s89, 9437184
    v_cmp_eq_u32 vcc, 3, v3
    v_mov_b32 v244, 2130706432
    s_nop 0
    v_cndmask_b32 v244, v1, v244, vcc
    v_mov_b32 v240, -1
    v_mov_b32 v241, -1
    v_mov_b32 v242, -1
    v_mov_b32 v243, -1
    s_mov_b32 s90, s91
.Lsweep:
    s_lshl_b32 s77, s48, 13
    s_add_u32 s77, s77, 65536
    s_sub_u32 s62, s77, s75
    v_add_u32 v250, s62, v234
    v_add_u32 v251, s62, v235
    s_add_u32 s84, s84, 4096
    s_and_b32 s84, s84, 0xffff
    s_add_u32 s80, s93, s84
    s_waitcnt vmcnt(11) lgkmcnt(5)
    v_mfma_f32_32x32x16_bf16 v[112:127], a[16:19], v[16:19], 0
    s_waitcnt vmcnt(10) lgkmcnt(4)
    v_mfma_f32_32x32x16_bf16 v[112:127], a[20:23], v[20:23], v[112:127]
    s_waitcnt lgkmcnt(3)
    v_mfma_f32_32x32x16_bf16 v[128:143], a[16:19], v[24:27], 0
    s_add_u32 s84, s84, 4096
    buffer_load_dwordx4 a[152:155], v1, s[16:19], s80 offen sc1
    s_nop 7
    v_exp_f32 v112, v112
    v_exp_f32 v113, v113
    v_exp_f32 v114, v114
    v_exp_f32 v115, v115
    v_cvt_pk_bf16_f32 v144, v112, v113
    v_cvt_pk_bf16_f32 v145, v114, v115
    s_waitcnt lgkmcnt(2)
    v_mfma_f32_32x32x16_bf16 v[128:143], a[20:23], v[28:31], v[128:143]
    s_and_b32 s84, s84, 0xffff
    buffer_load_dwordx4 a[156:159], v1, s[16:19], s80 offen offset:1024 sc1
    v_exp_f32 v116, v116
    v_exp_f32 v117, v117
    v_exp_f32 v118, v118
    v_exp_f32 v119, v119
    v_cvt_pk_bf16_f32 v146, v116, v117
    v_cvt_pk_bf16_f32 v147, v118, v119
    v_exp_f32 v120, v120
    v_exp_f32 v121, v121
    v_exp_f32 v122, v122
    v_exp_f32 v123, v123
    v_cvt_pk_bf16_f32 v148, v120, v121
    v_cvt_pk_bf16_f32 v149, v122, v123
    s_waitcnt vmcnt(11)
    v_mfma_f32_32x32x16_bf16 v[48:63], a[80:83], v[144:147], 0
    s_add_u32 s78, s93, s84
    buffer_load_dwordx4 a[216:219], v1, s[16:19], s80 offen offset:2048 sc1
    v_exp_f32 v124, v124
    v_exp_f32 v125, v125
    v_exp_f32 v126, v126
    v_exp_f32 v127, v127
    v_cvt_pk_bf16_f32 v150, v124, v125
    v_cvt_pk_bf16_f32 v151, v126, v127
    s_waitcnt lgkmcnt(1)
    v_mfma_f32_32x32x16_bf16 v[112:127], a[16:19], v[32:35], 0
    buffer_load_dwordx4 a[220:223], v1, s[16:19], s80 offen offset:3072 sc1
    v_exp_f32 v128, v128
    v_exp_f32 v129, v129
    v_exp_f32 v130, v130
    v_exp_f32 v131, v131
    v_cvt_pk_bf16_f32 v144, v128, v129
    v_cvt_pk_bf16_f32 v145, v130, v131
    s_waitcnt lgkmcnt(0)
    v_mfma_f32_32x32x16_bf16 v[112:127], a[20:23], v[36:39], v[112:127]
    s_add_u32 s84, s84, 4096
    buffer_load_dwordx4 a[32:35], v1, s[16:19], s78 offen sc1
    v_exp_f32 v132, v132
    v_exp_f32 v133, v133
    v_exp_f32 v134, v134
    v_exp_f32 v135, v135
    v_cvt_pk_bf16_f32 v146, v132, v133
    v_cvt_pk_bf16_f32 v147, v134, v135
    s_waitcnt vmcnt(13)
    v_mfma_f32_32x32x16_bf16 v[48:63], a[84:87], v[148:151], v[48:63]
    s_and_b32 s84, s84, 0xffff
    buffer_load_dwordx4 a[36:39], v1, s[16:19], s78 offen offset:1024 sc1
    v_exp_f32 v136, v136
    v_exp_f32 v137, v137
    v_exp_f32 v138, v138
    v_exp_f32 v139, v139
    v_cvt_pk_bf16_f32 v148, v136, v137
    v_cvt_pk_bf16_f32 v149, v138, v139
    v_mfma_f32_32x32x16_bf16 v[64:79], a[80:83], v[144:147], 0
    s_add_u32 s80, s93, s84
    buffer_load_dwordx4 a[96:99], v1, s[16:19], s78 offen offset:2048 sc1
    v_exp_f32 v140, v140
    v_exp_f32 v141, v141
    v_exp_f32 v142, v142
    v_exp_f32 v143, v143
    v_cvt_pk_bf16_f32 v150, v140, v141
    v_cvt_pk_bf16_f32 v151, v142, v143
    v_mfma_f32_32x32x16_bf16 v[128:143], a[16:19], v[40:43], 0
    v_exp_f32 v112, v112
    v_exp_f32 v113, v113
    v_exp_f32 v114, v114
    v_exp_f32 v115, v115
    v_cvt_pk_bf16_f32 v144, v112, v113
    v_cvt_pk_bf16_f32 v145, v114, v115
    v_mfma_f32_32x32x16_bf16 v[128:143], a[20:23], v[44:47], v[128:143]
    buffer_load_dwordx4 a[100:103], v1, s[16:19], s78 offen offset:3072 sc1
    v_exp_f32 v116, v116
    v_exp_f32 v117, v117
    v_exp_f32 v118, v118
    v_exp_f32 v119, v119
    v_cvt_pk_bf16_f32 v146, v116, v117
    v_cvt_pk_bf16_f32 v147, v118, v119
    v_mfma_f32_32x32x16_bf16 v[64:79], a[84:87], v[148:151], v[64:79]
    v_exp_f32 v120, v120
    v_exp_f32 v121, v121
    v_exp_f32 v122, v122
    v_exp_f32 v123, v123
    v_cvt_pk_bf16_f32 v148, v120, v121
    v_cvt_pk_bf16_f32 v149, v122, v123
    v_mfma_f32_32x32x16_bf16 v[80:95], a[80:83], v[144:147], 0
    buffer_store_dwordx4 v[240:243], v1, s[16:19], s90 offen sc1
    v_exp_f32 v124, v124
    v_exp_f32 v125, v125
    v_exp_f32 v126, v126
    v_exp_f32 v127, v127
    v_cvt_pk_bf16_f32 v150, v124, v125
    v_cvt_pk_bf16_f32 v151, v126, v127
    s_waitcnt vmcnt(16)
    v_mfma_f32_32x32x16_bf16 v[112:127], a[144:147], v[16:19], 0
    buffer_store_dwordx4 v[240:243], v1, s[16:19], s90 offen offset:1024 sc1
    v_exp_f32 v128, v128
    v_exp_f32 v129, v129
    v_exp_f32 v130, v130
    v_exp_f32 v131, v131
    v_cvt_pk_bf16_f32 v144, v128, v129
    v_cvt_pk_bf16_f32 v145, v130, v131
    s_waitcnt vmcnt(16)
    v_mfma_f32_32x32x16_bf16 v[112:127], a[148:151], v[20:23], v[112:127]
    s_add_u32 s84, s84, 4096
    buffer_load_dwordx4 a[160:163], v1, s[16:19], s80 offen sc1
    v_exp_f32 v132, v132
    v_exp_f32 v133, v133
    v_exp_f32 v134, v134
    v_exp_f32 v135, v135
    v_cvt_pk_bf16_f32 v146, v132, v133
    v_cvt_pk_bf16_f32 v147, v134, v135
    v_mfma_f32_32x32x16_bf16 v[80:95], a[84:87], v[148:151], v[80:95]
    s_and_b32 s84, s84, 0xffff
    buffer_load_dwordx4 a[164:167], v1, s[16:19], s80 offen offset:1024 sc1
    v_exp_f32 v136, v136
    v_exp_f32 v137, v137
    v_exp_f32 v138, v138
    v_exp_f32 v139, v139
    v_cvt_pk_bf16_f32 v148, v136, v137
    v_cvt_pk_bf16_f32 v149, v138, v139
    v_mfma_f32_32x32x16_bf16 v[96:111], a[80:83], v[144:147], 0
    s_add_u32 s78, s93, s84
    buffer_load_dwordx4 a[224:227], v1, s[16:19], s80 offen offset:2048 sc1
    v_exp_f32 v140, v140
    v_exp_f32 v141, v141
    v_exp_f32 v142, v142
    v_exp_f32 v143, v143
    v_cvt_pk_bf16_f32 v150, v140, v141
    v_cvt_pk_bf16_f32 v151, v142, v143
    v_mfma_f32_32x32x16_bf16 v[128:143], a[144:147], v[24:27], 0
    v_exp_f32 v112, v112
    v_exp_f32 v113, v113
    v_exp_f32 v114, v114
    v_exp_f32 v115, v115
    v_cvt_pk_bf16_f32 v144, v112, v113
    v_cvt_pk_bf16_f32 v145, v114, v115
    v_mfma_f32_32x32x16_bf16 v[128:143], a[148:151], v[28:31], v[128:143]
    buffer_load_dwordx4 a[228:231], v1, s[16:19], s80 offen offset:3072 sc1
    v_exp_f32 v116, v116
    v_exp_f32 v117, v117
    v_exp_f32 v118, v118
    v_exp_f32 v119, v119
    v_cvt_pk_bf16_f32 v146, v116, v117
    v_cvt_pk_bf16_f32 v147, v118, v119
    v_mfma_f32_32x32x16_bf16 v[96:111], a[84:87], v[148:151], v[96:111]
    s_add_u32 s84, s84, 4096
    buffer_load_dwordx4 a[40:43], v1, s[16:19], s78 offen sc1
    v_exp_f32 v120, v120
    v_exp_f32 v121, v121
    v_exp_f32 v122, v122
    v_exp_f32 v123, v123
    v_cvt_pk_bf16_f32 v148, v120, v121
    v_cvt_pk_bf16_f32 v149, v122, v123
    s_waitcnt vmcnt(20)
    v_mfma_f32_32x32x16_bf16 v[48:63], a[208:211], v[144:147], v[48:63]
    s_and_b32 s84, s84, 0xffff
    buffer_load_dwordx4 a[44:47], v1, s[16:19], s78 offen offset:1024 sc1
    v_exp_f32 v124, v124
    v_exp_f32 v125, v125
    v_exp_f32 v126, v126
    v_exp_f32 v127, v127
    v_cvt_pk_bf16_f32 v150, v124, v125
    v_cvt_pk_bf16_f32 v151, v126, v127
    v_mfma_f32_32x32x16_bf16 v[112:127], a[144:147], v[32:35], 0
    s_add_u32 s80, s93, s84
    buffer_load_dwordx4 a[104:107], v1, s[16:19], s78 offen offset:2048 sc1
    v_exp_f32 v128, v128
    v_exp_f32 v129, v129
    v_exp_f32 v130, v130
    v_exp_f32 v131, v131
    v_cvt_pk_bf16_f32 v144, v128, v129
    v_cvt_pk_bf16_f32 v145, v130, v131
    v_mfma_f32_32x32x16_bf16 v[112:127], a[148:151], v[36:39], v[112:127]
    v_exp_f32 v132, v132
    v_exp_f32 v133, v133
    v_exp_f32 v134, v134
    v_exp_f32 v135, v135
    v_cvt_pk_bf16_f32 v146, v132, v133
    v_cvt_pk_bf16_f32 v147, v134, v135
    s_waitcnt vmcnt(21)
    v_mfma_f32_32x32x16_bf16 v[48:63], a[212:215], v[148:151], v[48:63]
    buffer_load_dwordx4 a[108:111], v1, s[16:19], s78 offen offset:3072 sc1
    v_exp_f32 v136, v136
    v_exp_f32 v137, v137
    v_exp_f32 v138, v138
    v_exp_f32 v139, v139
    v_cvt_pk_bf16_f32 v148, v136, v137
    v_cvt_pk_bf16_f32 v149, v138, v139
    v_mfma_f32_32x32x16_bf16 v[64:79], a[208:211], v[144:147], v[64:79]
    s_add_u32 s84, s84, 4096
    buffer_load_dwordx4 a[168:171], v1, s[16:19], s80 offen sc1
    v_exp_f32 v140, v140
    v_exp_f32 v141, v141
    v_exp_f32 v142, v142
    v_exp_f32 v143, v143
    v_cvt_pk_bf16_f32 v150, v140, v141
    v_cvt_pk_bf16_f32 v151, v142, v143
    v_mfma_f32_32x32x16_bf16 v[128:143], a[144:147], v[40:43], 0
    s_and_b32 s84, s84, 0xffff
    buffer_load_dwordx4 a[172:175], v1, s[16:19], s80 offen offset:1024 sc1
    v_exp_f32 v112, v112
    v_exp_f32 v113, v113
    v_exp_f32 v114, v114
    v_exp_f32 v115, v115
    v_cvt_pk_bf16_f32 v144, v112, v113
    v_cvt_pk_bf16_f32 v145, v114, v115
    v_mfma_f32_32x32x16_bf16 v[128:143], a[148:151], v[44:47], v[128:143]
    s_add_u32 s78, s93, s84
    buffer_load_dwordx4 a[232:235], v1, s[16:19], s80 offen offset:2048 sc1
    v_exp_f32 v116, v116
    v_exp_f32 v117, v117
    v_exp_f32 v118, v118
    v_exp_f32 v119, v119
    v_cvt_pk_bf16_f32 v146, v116, v117
    v_cvt_pk_bf16_f32 v147, v118, v119
    v_mfma_f32_32x32x16_bf16 v[64:79], a[212:215], v[148:151], v[64:79]
    v_exp_f32 v120, v120
    v_exp_f32 v121, v121
    v_exp_f32 v122, v122
    v_exp_f32 v123, v123
    v_cvt_pk_bf16_f32 v148, v120, v121
    v_cvt_pk_bf16_f32 v149, v122, v123
    v_mfma_f32_32x32x16_bf16 v[80:95], a[208:211], v[144:147], v[80:95]
    buffer_load_dwordx4 a[236:239], v1, s[16:19], s80 offen offset:3072 sc1
    v_exp_f32 v124, v124
    v_exp_f32 v125, v125
    v_exp_f32 v126, v126
    v_exp_f32 v127, v127
    v_cvt_pk_bf16_f32 v150, v124, v125
    v_cvt_pk_bf16_f32 v151, v126, v127
    s_waitcnt vmcnt(25)
    v_mfma_f32_32x32x16_bf16 v[112:127], a[24:27], v[16:19], 0
    s_add_u32 s84, s84, 4096
    buffer_load_dwordx4 a[48:51], v1, s[16:19], s78 offen sc1
    v_exp_f32 v128, v128
    v_exp_f32 v129, v129
    v_exp_f32 v130, v130
    v_exp_f32 v131, v131
    v_cvt_pk_bf16_f32 v144, v128, v129
    v_cvt_pk_bf16_f32 v145, v130, v131
    s_waitcnt vmcnt(25)
    v_mfma_f32_32x32x16_bf16 v[112:127], a[28:31], v[20:23], v[112:127]
    s_and_b32 s84, s84, 0xffff
    buffer_load_dwordx4 a[52:55], v1, s[16:19], s78 offen offset:1024 sc1
    v_exp_f32 v132, v132
    v_exp_f32 v133, v133
    v_exp_f32 v134, v134
    v_exp_f32 v135, v135
    v_cvt_pk_bf16_f32 v146, v132, v133
    v_cvt_pk_bf16_f32 v147, v134, v135
    v_mfma_f32_32x32x16_bf16 v[80:95], a[212:215], v[148:151], v[80:95]
    s_add_u32 s80, s93, s84
    buffer_load_dwordx4 a[112:115], v1, s[16:19], s78 offen offset:2048 sc1
    v_exp_f32 v136, v136
    v_exp_f32 v137, v137
    v_exp_f32 v138, v138
    v_exp_f32 v139, v139
    v_cvt_pk_bf16_f32 v148, v136, v137
    v_cvt_pk_bf16_f32 v149, v138, v139
    v_mfma_f32_32x32x16_bf16 v[96:111], a[208:211], v[144:147], v[96:111]
    v_exp_f32 v140, v140
    v_exp_f32 v141, v141
    v_exp_f32 v142, v142
    v_exp_f32 v143, v143
    v_cvt_pk_bf16_f32 v150, v140, v141
    v_cvt_pk_bf16_f32 v151, v142, v143
    v_mfma_f32_32x32x16_bf16 v[128:143], a[24:27], v[24:27], 0
    buffer_load_dwordx4 a[116:119], v1, s[16:19], s78 offen offset:3072 sc1
    v_exp_f32 v112, v112
    v_exp_f32 v113, v113
    v_exp_f32 v114, v114
    v_exp_f32 v115, v115
    v_cvt_pk_bf16_f32 v144, v112, v113
    v_cvt_pk_bf16_f32 v145, v114, v115
    v_mfma_f32_32x32x16_bf16 v[128:143], a[28:31], v[28:31], v[128:143]
    s_add_u32 s84, s84, 4096
    buffer_load_dwordx4 a[176:179], v1, s[16:19], s80 offen sc1
    v_exp_f32 v116, v116
    v_exp_f32 v117, v117
    v_exp_f32 v118, v118
    v_exp_f32 v119, v119
    v_cvt_pk_bf16_f32 v146, v116, v117
    v_cvt_pk_bf16_f32 v147, v118, v119
    v_mfma_f32_32x32x16_bf16 v[96:111], a[212:215], v[148:151], v[96:111]
    s_and_b32 s84, s84, 0xffff
    buffer_load_dwordx4 a[180:183], v1, s[16:19], s80 offen offset:1024 sc1
    v_exp_f32 v120, v120
    v_exp_f32 v121, v121
    v_exp_f32 v122, v122
    v_exp_f32 v123, v123
    v_cvt_pk_bf16_f32 v148, v120, v121
    v_cvt_pk_bf16_f32 v149, v122, v123
    s_waitcnt vmcnt(29)
    v_mfma_f32_32x32x16_bf16 v[48:63], a[88:91], v[144:147], v[48:63]
    s_add_u32 s78, s93, s84
    buffer_load_dwordx4 a[240:243], v1, s[16:19], s80 offen offset:2048 sc1
    v_exp_f32 v124, v124
    v_exp_f32 v125, v125
    v_exp_f32 v126, v126
    v_exp_f32 v127, v127
    v_cvt_pk_bf16_f32 v150, v124, v125
    v_cvt_pk_bf16_f32 v151, v126, v127
    v_mfma_f32_32x32x16_bf16 v[112:127], a[24:27], v[32:35], 0
    v_exp_f32 v128, v128
    v_exp_f32 v129, v129
    v_exp_f32 v130, v130
    v_exp_f32 v131, v131
    v_cvt_pk_bf16_f32 v144, v128, v129
    v_cvt_pk_bf16_f32 v145, v130, v131
    v_mfma_f32_32x32x16_bf16 v[112:127], a[28:31], v[36:39], v[112:127]
    buffer_load_dwordx4 a[244:247], v1, s[16:19], s80 offen offset:3072 sc1
    v_exp_f32 v132, v132
    v_exp_f32 v133, v133
    v_exp_f32 v134, v134
    v_exp_f32 v135, v135
    v_cvt_pk_bf16_f32 v146, v132, v133
    v_cvt_pk_bf16_f32 v147, v134, v135
    s_waitcnt vmcnt(30)
    v_mfma_f32_32x32x16_bf16 v[48:63], a[92:95], v[148:151], v[48:63]
    s_add_u32 s84, s84, 4096
    buffer_load_dwordx4 a[56:59], v1, s[16:19], s78 offen sc1
    v_exp_f32 v136, v136
    v_exp_f32 v137, v137
    v_exp_f32 v138, v138
    v_exp_f32 v139, v139
    v_cvt_pk_bf16_f32 v148, v136, v137
    v_cvt_pk_bf16_f32 v149, v138, v139
    v_mfma_f32_32x32x16_bf16 v[64:79], a[88:91], v[144:147], v[64:79]
    s_and_b32 s84, s84, 0xffff
    buffer_load_dwordx4 a[60:63], v1, s[16:19], s78 offen offset:1024 sc1
    v_exp_f32 v140, v140
    v_exp_f32 v141, v141
    v_exp_f32 v142, v142
    v_exp_f32 v143, v143
    v_cvt_pk_bf16_f32 v150, v140, v141
    v_cvt_pk_bf16_f32 v151, v142, v143
    v_mfma_f32_32x32x16_bf16 v[128:143], a[24:27], v[40:43], 0
    s_add_u32 s80, s93, s84
    buffer_load_dwordx4 a[120:123], v1, s[16:19], s78 offen offset:2048 sc1
    v_exp_f32 v112, v112
    v_exp_f32 v113, v113
    v_exp_f32 v114, v114
    v_exp_f32 v115, v115
    v_cvt_pk_bf16_f32 v144, v112, v113
    v_cvt_pk_bf16_f32 v145, v114, v115
    v_mfma_f32_32x32x16_bf16 v[128:143], a[28:31], v[44:47], v[128:143]
    v_exp_f32 v116, v116
    v_exp_f32 v117, v117
    v_exp_f32 v118, v118
    v_exp_f32 v119, v119
    v_cvt_pk_bf16_f32 v146, v116, v117
    v_cvt_pk_bf16_f32 v147, v118, v119
    v_mfma_f32_32x32x16_bf16 v[64:79], a[92:95], v[148:151], v[64:79]
    s_cmp_lg_u32 s60, 0
    s_cbranch_scc1 .Lnoarr_10
    s_waitcnt vmcnt(23)
    s_mov_b64 exec, 15
    buffer_atomic_add v225, v14, s[16:19], 0 offen sc1
    s_mov_b64 exec, -1
.Lnoarr_10:
    buffer_load_dwordx4 a[124:127], v1, s[16:19], s78 offen offset:3072 sc1
    v_exp_f32 v120, v120
    v_exp_f32 v121, v121
    v_exp_f32 v122, v122
    v_exp_f32 v123, v123
    v_cvt_pk_bf16_f32 v148, v120, v121
    v_cvt_pk_bf16_f32 v149, v122, v123
    v_mfma_f32_32x32x16_bf16 v[80:95], a[88:91], v[144:147], v[80:95]
    s_waitcnt vmcnt(32)
    buffer_load_dwordx4 a[184:187], v1, s[16:19], s80 offen sc1
    v_exp_f32 v124, v124
    v_exp_f32 v125, v125
    v_exp_f32 v126, v126
    v_exp_f32 v127, v127
    v_cvt_pk_bf16_f32 v150, v124, v125
    v_cvt_pk_bf16_f32 v151, v126, v127
    v_mfma_f32_32x32x16_bf16 v[112:127], a[152:155], v[16:19], 0
    s_add_u32 s84, s84, 4096
    buffer_load_dwordx4 a[188:191], v1, s[16:19], s80 offen offset:1024 sc1
    v_exp_f32 v128, v128
    v_exp_f32 v129, v129
    v_exp_f32 v130, v130
    v_exp_f32 v131, v131
    v_cvt_pk_bf16_f32 v144, v128, v129
    v_cvt_pk_bf16_f32 v145, v130, v131
    v_mfma_f32_32x32x16_bf16 v[112:127], a[156:159], v[20:23], v[112:127]
    s_and_b32 s84, s84, 0xffff
    buffer_load_dwordx4 a[248:251], v1, s[16:19], s80 offen offset:2048 sc1
    v_exp_f32 v132, v132
    v_exp_f32 v133, v133
    v_exp_f32 v134, v134
    v_exp_f32 v135, v135
    v_cvt_pk_bf16_f32 v146, v132, v133
    v_cvt_pk_bf16_f32 v147, v134, v135
    v_mfma_f32_32x32x16_bf16 v[80:95], a[92:95], v[148:151], v[80:95]
    s_add_u32 s78, s93, s84
    v_exp_f32 v136, v136
    v_exp_f32 v137, v137
    v_exp_f32 v138, v138
    v_exp_f32 v139, v139
    v_cvt_pk_bf16_f32 v148, v136, v137
    v_cvt_pk_bf16_f32 v149, v138, v139
    v_mfma_f32_32x32x16_bf16 v[96:111], a[88:91], v[144:147], v[96:111]
    buffer_load_dwordx4 a[252:255], v1, s[16:19], s80 offen offset:3072 sc1
    v_exp_f32 v140, v140
    v_exp_f32 v141, v141
    v_exp_f32 v142, v142
    v_exp_f32 v143, v143
    v_cvt_pk_bf16_f32 v150, v140, v141
    v_cvt_pk_bf16_f32 v151, v142, v143
    v_mfma_f32_32x32x16_bf16 v[128:143], a[152:155], v[24:27], 0
    buffer_load_dwordx4 v[216:219], v239, s[8:11], s47 offen
    v_exp_f32 v112, v112
    v_exp_f32 v113, v113
    v_exp_f32 v114, v114
    v_exp_f32 v115, v115
    v_cvt_pk_bf16_f32 v144, v112, v113
    v_cvt_pk_bf16_f32 v145, v114, v115
    v_mfma_f32_32x32x16_bf16 v[128:143], a[156:159], v[28:31], v[128:143]
    buffer_load_dwordx4 v[220:223], v239, s[8:11], s47 offen offset:64
    v_exp_f32 v116, v116
    v_exp_f32 v117, v117
    v_exp_f32 v118, v118
    v_exp_f32 v119, v119
    v_cvt_pk_bf16_f32 v146, v116, v117
    v_cvt_pk_bf16_f32 v147, v118, v119
    v_mfma_f32_32x32x16_bf16 v[96:111], a[92:95], v[148:151], v[96:111]
    s_waitcnt vmcnt(36)
    buffer_load_ushort v224, v15, s[24:27], s88 offen
    v_exp_f32 v120, v120
    v_exp_f32 v121, v121
    v_exp_f32 v122, v122
    v_exp_f32 v123, v123
    v_cvt_pk_bf16_f32 v148, v120, v121
    v_cvt_pk_bf16_f32 v149, v122, v123
    v_mfma_f32_32x32x16_bf16 v[48:63], a[216:219], v[144:147], v[48:63]
    s_add_u32 m0, s75, 0
    v_exp_f32 v124, v124
    v_exp_f32 v125, v125
    v_exp_f32 v126, v126
    v_exp_f32 v127, v127
    v_cvt_pk_bf16_f32 v150, v124, v125
    v_cvt_pk_bf16_f32 v151, v126, v127
    v_mfma_f32_32x32x16_bf16 v[112:127], a[152:155], v[32:35], 0
    buffer_load_dwordx4 v226, s[20:23], s36 offen lds
    v_exp_f32 v128, v128
    v_exp_f32 v129, v129
    v_exp_f32 v130, v130
    v_exp_f32 v131, v131
    v_cvt_pk_bf16_f32 v144, v128, v129
    v_cvt_pk_bf16_f32 v145, v130, v131
    v_mfma_f32_32x32x16_bf16 v[112:127], a[156:159], v[36:39], v[112:127]
    buffer_load_dwordx4 v227, s[20:23], s36 offen offset:1024 lds
    v_exp_f32 v132, v132
    v_exp_f32 v133, v133
    v_exp_f32 v134, v134
    v_exp_f32 v135, v135
    v_cvt_pk_bf16_f32 v146, v132, v133
    v_cvt_pk_bf16_f32 v147, v134, v135
    v_mfma_f32_32x32x16_bf16 v[48:63], a[220:223], v[148:151], v[48:63]
    buffer_load_dwordx4 v228, s[20:23], s36 offen offset:2048 lds
    v_exp_f32 v136, v136
    v_exp_f32 v137, v137
    v_exp_f32 v138, v138
    v_exp_f32 v139, v139
    v_cvt_pk_bf16_f32 v148, v136, v137
    v_cvt_pk_bf16_f32 v149, v138, v139
    v_mfma_f32_32x32x16_bf16 v[64:79], a[216:219], v[144:147], v[64:79]
    v_exp_f32 v140, v140
    v_exp_f32 v141, v141
    v_exp_f32 v142, v142
    v_exp_f32 v143, v143
    v_cvt_pk_bf16_f32 v150, v140, v141
    v_cvt_pk_bf16_f32 v151, v142, v143
    v_mfma_f32_32x32x16_bf16 v[128:143], a[152:155], v[40:43], 0
    buffer_load_dwordx4 v229, s[20:23], s36 offen offset:3072 lds
    v_exp_f32 v112, v112
    v_exp_f32 v113, v113
    v_exp_f32 v114, v114
    v_exp_f32 v115, v115
    v_cvt_pk_bf16_f32 v144, v112, v113
    v_cvt_pk_bf16_f32 v145, v114, v115
    v_mfma_f32_32x32x16_bf16 v[128:143], a[156:159], v[44:47], v[128:143]
    s_add_u32 m0, s75, 4096
    v_exp_f32 v116, v116
    v_exp_f32 v117, v117
    v_exp_f32 v118, v118
    v_exp_f32 v119, v119
    v_cvt_pk_bf16_f32 v146, v116, v117
    v_cvt_pk_bf16_f32 v147, v118, v119
    v_mfma_f32_32x32x16_bf16 v[64:79], a[220:223], v[148:151], v[64:79]
    buffer_load_dwordx4 v230, s[20:23], s36 offen lds
    v_exp_f32 v120, v120
    v_exp_f32 v121, v121
    v_exp_f32 v122, v122
    v_exp_f32 v123, v123
    v_cvt_pk_bf16_f32 v148, v120, v121
    v_cvt_pk_bf16_f32 v149, v122, v123
    v_mfma_f32_32x32x16_bf16 v[80:95], a[216:219], v[144:147], v[80:95]
    s_waitcnt vmcnt(40)
    buffer_load_dwordx4 v231, s[20:23], s36 offen offset:1024 lds
    v_exp_f32 v124, v124
    v_exp_f32 v125, v125
    v_exp_f32 v126, v126
    v_exp_f32 v127, v127
    v_cvt_pk_bf16_f32 v150, v124, v125
    v_cvt_pk_bf16_f32 v151, v126, v127
    v_mfma_f32_32x32x16_bf16 v[112:127], a[32:35], v[16:19], 0
    buffer_load_dwordx4 v232, s[20:23], s36 offen offset:2048 lds
    v_exp_f32 v128, v128
    v_exp_f32 v129, v129
    v_exp_f32 v130, v130
    v_exp_f32 v131, v131
    v_cvt_pk_bf16_f32 v144, v128, v129
    v_cvt_pk_bf16_f32 v145, v130, v131
    v_mfma_f32_32x32x16_bf16 v[112:127], a[36:39], v[20:23], v[112:127]
    buffer_load_dwordx4 v233, s[20:23], s36 offen offset:3072 lds
    v_exp_f32 v132, v132
    v_exp_f32 v133, v133
    v_exp_f32 v134, v134
    v_exp_f32 v135, v135
    v_cvt_pk_bf16_f32 v146, v132, v133
    v_cvt_pk_bf16_f32 v147, v134, v135
    v_mfma_f32_32x32x16_bf16 v[80:95], a[220:223], v[148:151], v[80:95]
    s_add_u32 m0, s75, 8192
    v_exp_f32 v136, v136
    v_exp_f32 v137, v137
    v_exp_f32 v138, v138
    v_exp_f32 v139, v139
    v_cvt_pk_bf16_f32 v148, v136, v137
    v_cvt_pk_bf16_f32 v149, v138, v139
    v_mfma_f32_32x32x16_bf16 v[96:111], a[216:219], v[144:147], v[96:111]
    buffer_load_dwordx4 v226, s[20:23], s37 offen lds
    v_exp_f32 v140, v140
    v_exp_f32 v141, v141
    v_exp_f32 v142, v142
    v_exp_f32 v143, v143
    v_cvt_pk_bf16_f32 v150, v140, v141
    v_cvt_pk_bf16_f32 v151, v142, v143
    v_mfma_f32_32x32x16_bf16 v[128:143], a[32:35], v[24:27], 0
    buffer_load_dwordx4 v227, s[20:23], s37 offen offset:1024 lds
    v_exp_f32 v112, v112
    v_exp_f32 v113, v113
    v_exp_f32 v114, v114
    v_exp_f32 v115, v115
    v_cvt_pk_bf16_f32 v144, v112, v113
    v_cvt_pk_bf16_f32 v145, v114, v115
    v_mfma_f32_32x32x16_bf16 v[128:143], a[36:39], v[28:31], v[128:143]
    buffer_load_dwordx4 v228, s[20:23], s37 offen offset:2048 lds
    v_exp_f32 v116, v116
    v_exp_f32 v117, v117
    v_exp_f32 v118, v118
    v_exp_f32 v119, v119
    v_cvt_pk_bf16_f32 v146, v116, v117
    v_cvt_pk_bf16_f32 v147, v118, v119
    v_mfma_f32_32x32x16_bf16 v[96:111], a[220:223], v[148:151], v[96:111]
    s_waitcnt vmcnt(44)
    v_exp_f32 v120, v120
    v_exp_f32 v121, v121
    v_exp_f32 v122, v122
    v_exp_f32 v123, v123
    v_cvt_pk_bf16_f32 v148, v120, v121
    v_cvt_pk_bf16_f32 v149, v122, v123
    v_mfma_f32_32x32x16_bf16 v[48:63], a[96:99], v[144:147], v[48:63]
    v_exp_f32 v124, v124
    v_exp_f32 v125, v125
    v_exp_f32 v126, v126
    v_exp_f32 v127, v127
    v_cvt_pk_bf16_f32 v150, v124, v125
    v_cvt_pk_bf16_f32 v151, v126, v127
    v_mfma_f32_32x32x16_bf16 v[112:127], a[32:35], v[32:35], 0
    v_exp_f32 v128, v128
    v_exp_f32 v129, v129
    v_exp_f32 v130, v130
    v_exp_f32 v131, v131
    v_cvt_pk_bf16_f32 v144, v128, v129
    v_cvt_pk_bf16_f32 v145, v130, v131
    v_mfma_f32_32x32x16_bf16 v[112:127], a[36:39], v[36:39], v[112:127]
    v_exp_f32 v132, v132
    v_exp_f32 v133, v133
    v_exp_f32 v134, v134
    v_exp_f32 v135, v135
    v_cvt_pk_bf16_f32 v146, v132, v133
    v_cvt_pk_bf16_f32 v147, v134, v135
    v_mfma_f32_32x32x16_bf16 v[48:63], a[100:103], v[148:151], v[48:63]
    v_exp_f32 v136, v136
    v_exp_f32 v137, v137
    v_exp_f32 v138, v138
    v_exp_f32 v139, v139
    v_cvt_pk_bf16_f32 v148, v136, v137
    v_cvt_pk_bf16_f32 v149, v138, v139
    v_mfma_f32_32x32x16_bf16 v[64:79], a[96:99], v[144:147], v[64:79]
    v_exp_f32 v140, v140
    v_exp_f32 v141, v141
    v_exp_f32 v142, v142
    v_exp_f32 v143, v143
    v_cvt_pk_bf16_f32 v150, v140, v141
    v_cvt_pk_bf16_f32 v151, v142, v143
    v_mfma_f32_32x32x16_bf16 v[128:143], a[32:35], v[40:43], 0
    v_exp_f32 v112, v112
    v_exp_f32 v113, v113
    v_exp_f32 v114, v114
    v_exp_f32 v115, v115
    v_cvt_pk_bf16_f32 v144, v112, v113
    v_cvt_pk_bf16_f32 v145, v114, v115
    v_mfma_f32_32x32x16_bf16 v[128:143], a[36:39], v[44:47], v[128:143]
    v_exp_f32 v116, v116
    v_exp_f32 v117, v117
    v_exp_f32 v118, v118
    v_exp_f32 v119, v119
    v_cvt_pk_bf16_f32 v146, v116, v117
    v_cvt_pk_bf16_f32 v147, v118, v119
    v_mfma_f32_32x32x16_bf16 v[64:79], a[100:103], v[148:151], v[64:79]
    v_exp_f32 v120, v120
    v_exp_f32 v121, v121
    v_exp_f32 v122, v122
    v_exp_f32 v123, v123
    v_cvt_pk_bf16_f32 v148, v120, v121
    v_cvt_pk_bf16_f32 v149, v122, v123
    v_mfma_f32_32x32x16_bf16 v[80:95], a[96:99], v[144:147], v[80:95]
    s_waitcnt vmcnt(40)
    v_exp_f32 v124, v124
    v_exp_f32 v125, v125
    v_exp_f32 v126, v126
    v_exp_f32 v127, v127
    v_cvt_pk_bf16_f32 v150, v124, v125
    v_cvt_pk_bf16_f32 v151, v126, v127
    v_mfma_f32_32x32x16_bf16 v[112:127], a[160:163], v[16:19], 0
    v_exp_f32 v128, v128
    v_exp_f32 v129, v129
    v_exp_f32 v130, v130
    v_exp_f32 v131, v131
    v_cvt_pk_bf16_f32 v144, v128, v129
    v_cvt_pk_bf16_f32 v145, v130, v131
    v_mfma_f32_32x32x16_bf16 v[112:127], a[164:167], v[20:23], v[112:127]
    v_exp_f32 v132, v132
    v_exp_f32 v133, v133
    v_exp_f32 v134, v134
    v_exp_f32 v135, v135
    v_cvt_pk_bf16_f32 v146, v132, v133
    v_cvt_pk_bf16_f32 v147, v134, v135
    v_mfma_f32_32x32x16_bf16 v[80:95], a[100:103], v[148:151], v[80:95]
    v_exp_f32 v136, v136
    v_exp_f32 v137, v137
    v_exp_f32 v138, v138
    v_exp_f32 v139, v139
    v_cvt_pk_bf16_f32 v148, v136, v137
    v_cvt_pk_bf16_f32 v149, v138, v139
    v_mfma_f32_32x32x16_bf16 v[96:111], a[96:99], v[144:147], v[96:111]
    v_exp_f32 v140, v140
    v_exp_f32 v141, v141
    v_exp_f32 v142, v142
    v_exp_f32 v143, v143
    v_cvt_pk_bf16_f32 v150, v140, v141
    v_cvt_pk_bf16_f32 v151, v142, v143
    v_mfma_f32_32x32x16_bf16 v[128:143], a[160:163], v[24:27], 0
    v_exp_f32 v112, v112
    v_exp_f32 v113, v113
    v_exp_f32 v114, v114
    v_exp_f32 v115, v115
    v_cvt_pk_bf16_f32 v144, v112, v113
    v_cvt_pk_bf16_f32 v145, v114, v115
    v_mfma_f32_32x32x16_bf16 v[128:143], a[164:167], v[28:31], v[128:143]
    v_exp_f32 v116, v116
    v_exp_f32 v117, v117
    v_exp_f32 v118, v118
    v_exp_f32 v119, v119
    v_cvt_pk_bf16_f32 v146, v116, v117
    v_cvt_pk_bf16_f32 v147, v118, v119
    v_mfma_f32_32x32x16_bf16 v[96:111], a[100:103], v[148:151], v[96:111]
    s_waitcnt vmcnt(38)
    v_exp_f32 v120, v120
    v_exp_f32 v121, v121
    v_exp_f32 v122, v122
    v_exp_f32 v123, v123
    v_cvt_pk_bf16_f32 v148, v120, v121
    v_cvt_pk_bf16_f32 v149, v122, v123
    v_mfma_f32_32x32x16_bf16 v[48:63], a[224:227], v[144:147], v[48:63]
    v_exp_f32 v124, v124
    v_exp_f32 v125, v125
    v_exp_f32 v126, v126
    v_exp_f32 v127, v127
    v_cvt_pk_bf16_f32 v150, v124, v125
    v_cvt_pk_bf16_f32 v151, v126, v127
    v_mfma_f32_32x32x16_bf16 v[112:127], a[160:163], v[32:35], 0
    v_exp_f32 v128, v128
    v_exp_f32 v129, v129
    v_exp_f32 v130, v130
    v_exp_f32 v131, v131
    v_cvt_pk_bf16_f32 v144, v128, v129
    v_cvt_pk_bf16_f32 v145, v130, v131
    v_mfma_f32_32x32x16_bf16 v[112:127], a[164:167], v[36:39], v[112:127]
    v_exp_f32 v132, v132
    v_exp_f32 v133, v133
    v_exp_f32 v134, v134
    v_exp_f32 v135, v135
    v_cvt_pk_bf16_f32 v146, v132, v133
    v_cvt_pk_bf16_f32 v147, v134, v135
    v_mfma_f32_32x32x16_bf16 v[48:63], a[228:231], v[148:151], v[48:63]
    v_exp_f32 v136, v136
    v_exp_f32 v137, v137
    v_exp_f32 v138, v138
    v_exp_f32 v139, v139
    v_cvt_pk_bf16_f32 v148, v136, v137
    v_cvt_pk_bf16_f32 v149, v138, v139
    v_mfma_f32_32x32x16_bf16 v[64:79], a[224:227], v[144:147], v[64:79]
    v_exp_f32 v140, v140
    v_exp_f32 v141, v141
    v_exp_f32 v142, v142
    v_exp_f32 v143, v143
    v_cvt_pk_bf16_f32 v150, v140, v141
    v_cvt_pk_bf16_f32 v151, v142, v143
    v_mfma_f32_32x32x16_bf16 v[128:143], a[160:163], v[40:43], 0
    v_exp_f32 v112, v112
    v_exp_f32 v113, v113
    v_exp_f32 v114, v114
    v_exp_f32 v115, v115
    v_cvt_pk_bf16_f32 v144, v112, v113
    v_cvt_pk_bf16_f32 v145, v114, v115
    v_mfma_f32_32x32x16_bf16 v[128:143], a[164:167], v[44:47], v[128:143]
    v_exp_f32 v116, v116
    v_exp_f32 v117, v117
    v_exp_f32 v118, v118
    v_exp_f32 v119, v119
    v_cvt_pk_bf16_f32 v146, v116, v117
    v_cvt_pk_bf16_f32 v147, v118, v119
    v_mfma_f32_32x32x16_bf16 v[64:79], a[228:231], v[148:151], v[64:79]
    v_exp_f32 v120, v120
    v_exp_f32 v121, v121
    v_exp_f32 v122, v122
    v_exp_f32 v123, v123
    v_cvt_pk_bf16_f32 v148, v120, v121
    v_cvt_pk_bf16_f32 v149, v122, v123
    v_mfma_f32_32x32x16_bf16 v[80:95], a[224:227], v[144:147], v[80:95]
    s_waitcnt vmcnt(36)
    v_exp_f32 v124, v124
    v_exp_f32 v125, v125
    v_exp_f32 v126, v126
    v_exp_f32 v127, v127
    v_cvt_pk_bf16_f32 v150, v124, v125
    v_cvt_pk_bf16_f32 v151, v126, v127
    v_mfma_f32_32x32x16_bf16 v[112:127], a[40:43], v[16:19], 0
    v_exp_f32 v128, v128
    v_exp_f32 v129, v129
    v_exp_f32 v130, v130
    v_exp_f32 v131, v131
    v_cvt_pk_bf16_f32 v144, v128, v129
    v_cvt_pk_bf16_f32 v145, v130, v131
    v_mfma_f32_32x32x16_bf16 v[112:127], a[44:47], v[20:23], v[112:127]
    v_exp_f32 v132, v132
    v_exp_f32 v133, v133
    v_exp_f32 v134, v134
    v_exp_f32 v135, v135
    v_cvt_pk_bf16_f32 v146, v132, v133
    v_cvt_pk_bf16_f32 v147, v134, v135
    v_mfma_f32_32x32x16_bf16 v[80:95], a[228:231], v[148:151], v[80:95]
    v_exp_f32 v136, v136
    v_exp_f32 v137, v137
    v_exp_f32 v138, v138
    v_exp_f32 v139, v139
    v_cvt_pk_bf16_f32 v148, v136, v137
    v_cvt_pk_bf16_f32 v149, v138, v139
    v_mfma_f32_32x32x16_bf16 v[96:111], a[224:227], v[144:147], v[96:111]
    v_exp_f32 v140, v140
    v_exp_f32 v141, v141
    v_exp_f32 v142, v142
    v_exp_f32 v143, v143
    v_cvt_pk_bf16_f32 v150, v140, v141
    v_cvt_pk_bf16_f32 v151, v142, v143
    v_mfma_f32_32x32x16_bf16 v[128:143], a[40:43], v[24:27], 0
    v_exp_f32 v112, v112
    v_exp_f32 v113, v113
    v_exp_f32 v114, v114
    v_exp_f32 v115, v115
    v_cvt_pk_bf16_f32 v144, v112, v113
    v_cvt_pk_bf16_f32 v145, v114, v115
    v_mfma_f32_32x32x16_bf16 v[128:143], a[44:47], v[28:31], v[128:143]
    v_exp_f32 v116, v116
    v_exp_f32 v117, v117
    v_exp_f32 v118, v118
    v_exp_f32 v119, v119
    v_cvt_pk_bf16_f32 v146, v116, v117
    v_cvt_pk_bf16_f32 v147, v118, v119
    v_mfma_f32_32x32x16_bf16 v[96:111], a[228:231], v[148:151], v[96:111]
    s_waitcnt vmcnt(34)
    v_exp_f32 v120, v120
    v_exp_f32 v121, v121
    v_exp_f32 v122, v122
    v_exp_f32 v123, v123
    v_cvt_pk_bf16_f32 v148, v120, v121
    v_cvt_pk_bf16_f32 v149, v122, v123
    v_mfma_f32_32x32x16_bf16 v[48:63], a[104:107], v[144:147], v[48:63]
    s_add_u32 m0, s75, 8192
    v_exp_f32 v124, v124
    v_exp_f32 v125, v125
    v_exp_f32 v126, v126
    v_exp_f32 v127, v127
    v_cvt_pk_bf16_f32 v150, v124, v125
    v_cvt_pk_bf16_f32 v151, v126, v127
    v_mfma_f32_32x32x16_bf16 v[112:127], a[40:43], v[32:35], 0
    buffer_load_dwordx4 v229, s[20:23], s37 offen offset:3072 lds
    v_exp_f32 v128, v128
    v_exp_f32 v129, v129
    v_exp_f32 v130, v130
    v_exp_f32 v131, v131
    v_cvt_pk_bf16_f32 v144, v128, v129
    v_cvt_pk_bf16_f32 v145, v130, v131
    v_mfma_f32_32x32x16_bf16 v[112:127], a[44:47], v[36:39], v[112:127]
    s_add_u32 m0, s75, 12288
    v_exp_f32 v132, v132
    v_exp_f32 v133, v133
    v_exp_f32 v134, v134
    v_exp_f32 v135, v135
    v_cvt_pk_bf16_f32 v146, v132, v133
    v_cvt_pk_bf16_f32 v147, v134, v135
    v_mfma_f32_32x32x16_bf16 v[48:63], a[108:111], v[148:151], v[48:63]
    buffer_load_dwordx4 v230, s[20:23], s37 offen lds
    v_exp_f32 v136, v136
    v_exp_f32 v137, v137
    v_exp_f32 v138, v138
    v_exp_f32 v139, v139
    v_cvt_pk_bf16_f32 v148, v136, v137
    v_cvt_pk_bf16_f32 v149, v138, v139
    v_mfma_f32_32x32x16_bf16 v[64:79], a[104:107], v[144:147], v[64:79]
    buffer_load_dwordx4 v231, s[20:23], s37 offen offset:1024 lds
    v_exp_f32 v140, v140
    v_exp_f32 v141, v141
    v_exp_f32 v142, v142
    v_exp_f32 v143, v143
    v_cvt_pk_bf16_f32 v150, v140, v141
    v_cvt_pk_bf16_f32 v151, v142, v143
    v_mfma_f32_32x32x16_bf16 v[128:143], a[40:43], v[40:43], 0
    buffer_load_dwordx4 v232, s[20:23], s37 offen offset:2048 lds
    v_exp_f32 v112, v112
    v_exp_f32 v113, v113
    v_exp_f32 v114, v114
    v_exp_f32 v115, v115
    v_cvt_pk_bf16_f32 v144, v112, v113
    v_cvt_pk_bf16_f32 v145, v114, v115
    v_mfma_f32_32x32x16_bf16 v[128:143], a[44:47], v[44:47], v[128:143]
    buffer_load_dwordx4 v233, s[20:23], s37 offen offset:3072 lds
    v_exp_f32 v116, v116
    v_exp_f32 v117, v117
    v_exp_f32 v118, v118
    v_exp_f32 v119, v119
    v_cvt_pk_bf16_f32 v146, v116, v117
    v_cvt_pk_bf16_f32 v147, v118, v119
    v_mfma_f32_32x32x16_bf16 v[64:79], a[108:111], v[148:151], v[64:79]
    v_exp_f32 v120, v120
    v_exp_f32 v121, v121
    v_exp_f32 v122, v122
    v_exp_f32 v123, v123
    v_cvt_pk_bf16_f32 v148, v120, v121
    v_cvt_pk_bf16_f32 v149, v122, v123
    v_mfma_f32_32x32x16_bf16 v[80:95], a[104:107], v[144:147], v[80:95]
    s_waitcnt vmcnt(37)
    v_exp_f32 v124, v124
    v_exp_f32 v125, v125
    v_exp_f32 v126, v126
    v_exp_f32 v127, v127
    v_cvt_pk_bf16_f32 v150, v124, v125
    v_cvt_pk_bf16_f32 v151, v126, v127
    v_mfma_f32_32x32x16_bf16 v[112:127], a[168:171], v[16:19], 0
    v_exp_f32 v128, v128
    v_exp_f32 v129, v129
    v_exp_f32 v130, v130
    v_exp_f32 v131, v131
    v_cvt_pk_bf16_f32 v144, v128, v129
    v_cvt_pk_bf16_f32 v145, v130, v131
    v_mfma_f32_32x32x16_bf16 v[112:127], a[172:175], v[20:23], v[112:127]
    v_exp_f32 v132, v132
    v_exp_f32 v133, v133
    v_exp_f32 v134, v134
    v_exp_f32 v135, v135
    v_cvt_pk_bf16_f32 v146, v132, v133
    v_cvt_pk_bf16_f32 v147, v134, v135
    v_mfma_f32_32x32x16_bf16 v[80:95], a[108:111], v[148:151], v[80:95]
    v_exp_f32 v136, v136
    v_exp_f32 v137, v137
    v_exp_f32 v138, v138
    v_exp_f32 v139, v139
    v_cvt_pk_bf16_f32 v148, v136, v137
    v_cvt_pk_bf16_f32 v149, v138, v139
    v_mfma_f32_32x32x16_bf16 v[96:111], a[104:107], v[144:147], v[96:111]
    v_exp_f32 v140, v140
    v_exp_f32 v141, v141
    v_exp_f32 v142, v142
    v_exp_f32 v143, v143
    v_cvt_pk_bf16_f32 v150, v140, v141
    v_cvt_pk_bf16_f32 v151, v142, v143
    v_mfma_f32_32x32x16_bf16 v[128:143], a[168:171], v[24:27], 0
    v_exp_f32 v112, v112
    v_exp_f32 v113, v113
    v_exp_f32 v114, v114
    v_exp_f32 v115, v115
    v_cvt_pk_bf16_f32 v144, v112, v113
    v_cvt_pk_bf16_f32 v145, v114, v115
    v_mfma_f32_32x32x16_bf16 v[128:143], a[172:175], v[28:31], v[128:143]
    v_exp_f32 v116, v116
    v_exp_f32 v117, v117
    v_exp_f32 v118, v118
    v_exp_f32 v119, v119
    v_cvt_pk_bf16_f32 v146, v116, v117
    v_cvt_pk_bf16_f32 v147, v118, v119
    v_mfma_f32_32x32x16_bf16 v[96:111], a[108:111], v[148:151], v[96:111]
    s_waitcnt vmcnt(35)
    v_exp_f32 v120, v120
    v_exp_f32 v121, v121
    v_exp_f32 v122, v122
    v_exp_f32 v123, v123
    v_cvt_pk_bf16_f32 v148, v120, v121
    v_cvt_pk_bf16_f32 v149, v122, v123
    v_mfma_f32_32x32x16_bf16 v[48:63], a[232:235], v[144:147], v[48:63]
    v_exp_f32 v124, v124
    v_exp_f32 v125, v125
    v_exp_f32 v126, v126
    v_exp_f32 v127, v127
    v_cvt_pk_bf16_f32 v150, v124, v125
    v_cvt_pk_bf16_f32 v151, v126, v127
    v_mfma_f32_32x32x16_bf16 v[112:127], a[168:171], v[32:35], 0
    v_exp_f32 v128, v128
    v_exp_f32 v129, v129
    v_exp_f32 v130, v130
    v_exp_f32 v131, v131
    v_cvt_pk_bf16_f32 v144, v128, v129
    v_cvt_pk_bf16_f32 v145, v130, v131
    v_mfma_f32_32x32x16_bf16 v[112:127], a[172:175], v[36:39], v[112:127]
    v_exp_f32 v132, v132
    v_exp_f32 v133, v133
    v_exp_f32 v134, v134
    v_exp_f32 v135, v135
    v_cvt_pk_bf16_f32 v146, v132, v133
    v_cvt_pk_bf16_f32 v147, v134, v135
    v_mfma_f32_32x32x16_bf16 v[48:63], a[236:239], v[148:151], v[48:63]
    v_exp_f32 v136, v136
    v_exp_f32 v137, v137
    v_exp_f32 v138, v138
    v_exp_f32 v139, v139
    v_cvt_pk_bf16_f32 v148, v136, v137
    v_cvt_pk_bf16_f32 v149, v138, v139
    v_mfma_f32_32x32x16_bf16 v[64:79], a[232:235], v[144:147], v[64:79]
    v_exp_f32 v140, v140
    v_exp_f32 v141, v141
    v_exp_f32 v142, v142
    v_exp_f32 v143, v143
    v_cvt_pk_bf16_f32 v150, v140, v141
    v_cvt_pk_bf16_f32 v151, v142, v143
    v_mfma_f32_32x32x16_bf16 v[128:143], a[168:171], v[40:43], 0
    v_exp_f32 v112, v112
    v_exp_f32 v113, v113
    v_exp_f32 v114, v114
    v_exp_f32 v115, v115
    v_cvt_pk_bf16_f32 v144, v112, v113
    v_cvt_pk_bf16_f32 v145, v114, v115
    v_mfma_f32_32x32x16_bf16 v[128:143], a[172:175], v[44:47], v[128:143]
    v_exp_f32 v116, v116
    v_exp_f32 v117, v117
    v_exp_f32 v118, v118
    v_exp_f32 v119, v119
    v_cvt_pk_bf16_f32 v146, v116, v117
    v_cvt_pk_bf16_f32 v147, v118, v119
    v_mfma_f32_32x32x16_bf16 v[64:79], a[236:239], v[148:151], v[64:79]
    v_exp_f32 v120, v120
    v_exp_f32 v121, v121
    v_exp_f32 v122, v122
    v_exp_f32 v123, v123
    v_cvt_pk_bf16_f32 v148, v120, v121
    v_cvt_pk_bf16_f32 v149, v122, v123
    v_mfma_f32_32x32x16_bf16 v[80:95], a[232:235], v[144:147], v[80:95]
    s_waitcnt vmcnt(33)
    v_exp_f32 v124, v124
    v_exp_f32 v125, v125
    v_exp_f32 v126, v126
    v_exp_f32 v127, v127
    v_cvt_pk_bf16_f32 v150, v124, v125
    v_cvt_pk_bf16_f32 v151, v126, v127
    v_mfma_f32_32x32x16_bf16 v[112:127], a[48:51], v[16:19], 0
    s_waitcnt vmcnt(8)
    ds_read_b128 a[0:3], v234
    buffer_load_dwordx4 v[152:155], v1, s[16:19], s78 offen sc1
    v_exp_f32 v128, v128
    v_exp_f32 v129, v129
    v_exp_f32 v130, v130
    v_exp_f32 v131, v131
    v_cvt_pk_bf16_f32 v144, v128, v129
    v_cvt_pk_bf16_f32 v145, v130, v131
    v_mfma_f32_32x32x16_bf16 v[112:127], a[52:55], v[20:23], v[112:127]
    s_add_u32 s84, s84, 4096
    ds_read_b128 a[4:7], v235
    buffer_load_dwordx4 v[156:159], v1, s[16:19], s78 offen offset:1024 sc1
    v_exp_f32 v132, v132
    v_exp_f32 v133, v133
    v_exp_f32 v134, v134
    v_exp_f32 v135, v135
    v_cvt_pk_bf16_f32 v146, v132, v133
    v_cvt_pk_bf16_f32 v147, v134, v135
    v_mfma_f32_32x32x16_bf16 v[80:95], a[236:239], v[148:151], v[80:95]
    s_and_b32 s84, s84, 0xffff
    ds_read_b128 a[64:67], v234 offset:2048
    buffer_load_dwordx4 v[160:163], v1, s[16:19], s78 offen offset:2048 sc1
    v_exp_f32 v136, v136
    v_exp_f32 v137, v137
    v_exp_f32 v138, v138
    v_exp_f32 v139, v139
    v_cvt_pk_bf16_f32 v148, v136, v137
    v_cvt_pk_bf16_f32 v149, v138, v139
    v_mfma_f32_32x32x16_bf16 v[96:111], a[232:235], v[144:147], v[96:111]
    s_add_u32 s80, s93, s84
    ds_read_b128 a[68:71], v235 offset:2048
    v_exp_f32 v140, v140
    v_exp_f32 v141, v141
    v_exp_f32 v142, v142
    v_exp_f32 v143, v143
    v_cvt_pk_bf16_f32 v150, v140, v141
    v_cvt_pk_bf16_f32 v151, v142, v143
    v_mfma_f32_32x32x16_bf16 v[128:143], a[48:51], v[24:27], 0
    ds_read_b128 a[128:131], v234 offset:4096
    buffer_load_dwordx4 v[164:167], v1, s[16:19], s78 offen offset:3072 sc1
    v_exp_f32 v112, v112
    v_exp_f32 v113, v113
    v_exp_f32 v114, v114
    v_exp_f32 v115, v115
    v_cvt_pk_bf16_f32 v144, v112, v113
    v_cvt_pk_bf16_f32 v145, v114, v115
    v_mfma_f32_32x32x16_bf16 v[128:143], a[52:55], v[28:31], v[128:143]
    s_add_u32 m0, s76, 0
    ds_read_b128 a[132:135], v235 offset:4096
    v_exp_f32 v116, v116
    v_exp_f32 v117, v117
    v_exp_f32 v118, v118
    v_exp_f32 v119, v119
    v_cvt_pk_bf16_f32 v146, v116, v117
    v_cvt_pk_bf16_f32 v147, v118, v119
    v_mfma_f32_32x32x16_bf16 v[96:111], a[236:239], v[148:151], v[96:111]
    ds_read_b128 a[192:195], v234 offset:6144
    buffer_load_dwordx4 v226, s[20:23], s38 offen lds
    v_exp_f32 v120, v120
    v_exp_f32 v121, v121
    v_exp_f32 v122, v122
    v_exp_f32 v123, v123
    v_cvt_pk_bf16_f32 v148, v120, v121
    v_cvt_pk_bf16_f32 v149, v122, v123
    v_mfma_f32_32x32x16_bf16 v[48:63], a[112:115], v[144:147], v[48:63]
    ds_read_b128 a[196:199], v235 offset:6144
    buffer_load_dwordx4 v227, s[20:23], s38 offen offset:1024 lds
    v_exp_f32 v124, v124
    v_exp_f32 v125, v125
    v_exp_f32 v126, v126
    v_exp_f32 v127, v127
    v_cvt_pk_bf16_f32 v150, v124, v125
    v_cvt_pk_bf16_f32 v151, v126, v127
    v_mfma_f32_32x32x16_bf16 v[112:127], a[48:51], v[32:35], 0
    s_waitcnt vmcnt(6)
    ds_read_b128 a[8:11], v234 offset:8192
    buffer_load_dwordx4 v228, s[20:23], s38 offen offset:2048 lds
    v_exp_f32 v128, v128
    v_exp_f32 v129, v129
    v_exp_f32 v130, v130
    v_exp_f32 v131, v131
    v_cvt_pk_bf16_f32 v144, v128, v129
    v_cvt_pk_bf16_f32 v145, v130, v131
    v_mfma_f32_32x32x16_bf16 v[112:127], a[52:55], v[36:39], v[112:127]
    ds_read_b128 a[12:15], v235 offset:8192
    buffer_load_dwordx4 v229, s[20:23], s38 offen offset:3072 lds
    v_exp_f32 v132, v132
    v_exp_f32 v133, v133
    v_exp_f32 v134, v134
    v_exp_f32 v135, v135
    v_cvt_pk_bf16_f32 v146, v132, v133
    v_cvt_pk_bf16_f32 v147, v134, v135
    v_mfma_f32_32x32x16_bf16 v[48:63], a[116:119], v[148:151], v[48:63]
    s_add_u32 m0, s76, 4096
    ds_read_b128 a[72:75], v234 offset:10240
    v_exp_f32 v136, v136
    v_exp_f32 v137, v137
    v_exp_f32 v138, v138
    v_exp_f32 v139, v139
    v_cvt_pk_bf16_f32 v148, v136, v137
    v_cvt_pk_bf16_f32 v149, v138, v139
    v_mfma_f32_32x32x16_bf16 v[64:79], a[112:115], v[144:147], v[64:79]
    ds_read_b128 a[76:79], v235 offset:10240
    buffer_load_dwordx4 v230, s[20:23], s38 offen lds
    v_exp_f32 v140, v140
    v_exp_f32 v141, v141
    v_exp_f32 v142, v142
    v_exp_f32 v143, v143
    v_cvt_pk_bf16_f32 v150, v140, v141
    v_cvt_pk_bf16_f32 v151, v142, v143
    v_mfma_f32_32x32x16_bf16 v[128:143], a[48:51], v[40:43], 0
    ds_read_b128 a[136:139], v234 offset:12288
    buffer_load_dwordx4 v231, s[20:23], s38 offen offset:1024 lds
    v_exp_f32 v112, v112
    v_exp_f32 v113, v113
    v_exp_f32 v114, v114
    v_exp_f32 v115, v115
    v_cvt_pk_bf16_f32 v144, v112, v113
    v_cvt_pk_bf16_f32 v145, v114, v115
    v_mfma_f32_32x32x16_bf16 v[128:143], a[52:55], v[44:47], v[128:143]
    ds_read_b128 a[140:143], v235 offset:12288
    buffer_load_dwordx4 v232, s[20:23], s38 offen offset:2048 lds
    v_exp_f32 v116, v116
    v_exp_f32 v117, v117
    v_exp_f32 v118, v118
    v_exp_f32 v119, v119
    v_cvt_pk_bf16_f32 v146, v116, v117
    v_cvt_pk_bf16_f32 v147, v118, v119
    v_mfma_f32_32x32x16_bf16 v[64:79], a[116:119], v[148:151], v[64:79]
    ds_read_b128 a[200:203], v234 offset:14336
    buffer_load_dwordx4 v233, s[20:23], s38 offen offset:3072 lds
    v_exp_f32 v120, v120
    v_exp_f32 v121, v121
    v_exp_f32 v122, v122
    v_exp_f32 v123, v123
    v_cvt_pk_bf16_f32 v148, v120, v121
    v_cvt_pk_bf16_f32 v149, v122, v123
    v_mfma_f32_32x32x16_bf16 v[80:95], a[112:115], v[144:147], v[80:95]
    ds_read_b128 a[204:207], v235 offset:14336
    buffer_load_dwordx4 v[168:171], v1, s[16:19], s80 offen sc1
    v_exp_f32 v124, v124
    v_exp_f32 v125, v125
    v_exp_f32 v126, v126
    v_exp_f32 v127, v127
    v_cvt_pk_bf16_f32 v150, v124, v125
    v_cvt_pk_bf16_f32 v151, v126, v127
    v_mfma_f32_32x32x16_bf16 v[112:127], a[176:179], v[16:19], 0
    s_add_u32 s84, s84, 4096
    buffer_load_dwordx4 v[172:175], v1, s[16:19], s80 offen offset:1024 sc1
    v_exp_f32 v128, v128
    v_exp_f32 v129, v129
    v_exp_f32 v130, v130
    v_exp_f32 v131, v131
    v_cvt_pk_bf16_f32 v144, v128, v129
    v_cvt_pk_bf16_f32 v145, v130, v131
    v_mfma_f32_32x32x16_bf16 v[112:127], a[180:183], v[20:23], v[112:127]
    s_and_b32 s84, s84, 0xffff
    buffer_load_dwordx4 v[176:179], v1, s[16:19], s80 offen offset:2048 sc1
    v_exp_f32 v132, v132
    v_exp_f32 v133, v133
    v_exp_f32 v134, v134
    v_exp_f32 v135, v135
    v_cvt_pk_bf16_f32 v146, v132, v133
    v_cvt_pk_bf16_f32 v147, v134, v135
    v_mfma_f32_32x32x16_bf16 v[80:95], a[116:119], v[148:151], v[80:95]
    s_add_u32 s78, s93, s84
    v_exp_f32 v136, v136
    v_exp_f32 v137, v137
    v_exp_f32 v138, v138
    v_exp_f32 v139, v139
    v_cvt_pk_bf16_f32 v148, v136, v137
    v_cvt_pk_bf16_f32 v149, v138, v139
    v_mfma_f32_32x32x16_bf16 v[96:111], a[112:115], v[144:147], v[96:111]
    buffer_load_dwordx4 v[180:183], v1, s[16:19], s80 offen offset:3072 sc1
    v_exp_f32 v140, v140
    v_exp_f32 v141, v141
    v_exp_f32 v142, v142
    v_exp_f32 v143, v143
    v_cvt_pk_bf16_f32 v150, v140, v141
    v_cvt_pk_bf16_f32 v151, v142, v143
    v_mfma_f32_32x32x16_bf16 v[128:143], a[176:179], v[24:27], 0
    s_add_u32 m0, s77, 0
    v_exp_f32 v112, v112
    v_exp_f32 v113, v113
    v_exp_f32 v114, v114
    v_exp_f32 v115, v115
    v_cvt_pk_bf16_f32 v144, v112, v113
    v_cvt_pk_bf16_f32 v145, v114, v115
    v_mfma_f32_32x32x16_bf16 v[128:143], a[180:183], v[28:31], v[128:143]
    buffer_load_dwordx4 v226, s[20:23], s39 offen lds
    v_exp_f32 v116, v116
    v_exp_f32 v117, v117
    v_exp_f32 v118, v118
    v_exp_f32 v119, v119
    v_cvt_pk_bf16_f32 v146, v116, v117
    v_cvt_pk_bf16_f32 v147, v118, v119
    v_mfma_f32_32x32x16_bf16 v[96:111], a[116:119], v[148:151], v[96:111]
    buffer_load_dwordx4 v227, s[20:23], s39 offen offset:1024 lds
    v_exp_f32 v120, v120
    v_exp_f32 v121, v121
    v_exp_f32 v122, v122
    v_exp_f32 v123, v123
    v_cvt_pk_bf16_f32 v148, v120, v121
    v_cvt_pk_bf16_f32 v149, v122, v123
    v_mfma_f32_32x32x16_bf16 v[48:63], a[240:243], v[144:147], v[48:63]
    buffer_load_dwordx4 v228, s[20:23], s39 offen offset:2048 lds
    v_exp_f32 v124, v124
    v_exp_f32 v125, v125
    v_exp_f32 v126, v126
    v_exp_f32 v127, v127
    v_cvt_pk_bf16_f32 v150, v124, v125
    v_cvt_pk_bf16_f32 v151, v126, v127
    v_mfma_f32_32x32x16_bf16 v[112:127], a[176:179], v[32:35], 0
    buffer_load_dwordx4 v229, s[20:23], s39 offen offset:3072 lds
    v_exp_f32 v128, v128
    v_exp_f32 v129, v129
    v_exp_f32 v130, v130
    v_exp_f32 v131, v131
    v_cvt_pk_bf16_f32 v144, v128, v129
    v_cvt_pk_bf16_f32 v145, v130, v131
    v_mfma_f32_32x32x16_bf16 v[112:127], a[180:183], v[36:39], v[112:127]
    s_waitcnt vmcnt(8)
    ds_read_b128 a[16:19], v236
    buffer_load_dword v10, v9, s[16:19], 0 offen sc1
    v_exp_f32 v132, v132
    v_exp_f32 v133, v133
    v_exp_f32 v134, v134
    v_exp_f32 v135, v135
    v_cvt_pk_bf16_f32 v146, v132, v133
    v_cvt_pk_bf16_f32 v147, v134, v135
    v_mfma_f32_32x32x16_bf16 v[48:63], a[244:247], v[148:151], v[48:63]
    s_add_u32 m0, s77, 4096
    ds_read_b128 a[20:23], v237
    v_exp_f32 v136, v136
    v_exp_f32 v137, v137
    v_exp_f32 v138, v138
    v_exp_f32 v139, v139
    v_cvt_pk_bf16_f32 v148, v136, v137
    v_cvt_pk_bf16_f32 v149, v138, v139
    v_mfma_f32_32x32x16_bf16 v[64:79], a[240:243], v[144:147], v[64:79]
    ds_read_b128 a[80:83], v236 offset:2048
    buffer_load_dwordx4 v230, s[20:23], s39 offen lds
    v_exp_f32 v140, v140
    v_exp_f32 v141, v141
    v_exp_f32 v142, v142
    v_exp_f32 v143, v143
    v_cvt_pk_bf16_f32 v150, v140, v141
    v_cvt_pk_bf16_f32 v151, v142, v143
    v_mfma_f32_32x32x16_bf16 v[128:143], a[176:179], v[40:43], 0
    ds_read_b128 a[84:87], v237 offset:2048
    buffer_load_dwordx4 v231, s[20:23], s39 offen offset:1024 lds
    v_exp_f32 v112, v112
    v_exp_f32 v113, v113
    v_exp_f32 v114, v114
    v_exp_f32 v115, v115
    v_cvt_pk_bf16_f32 v144, v112, v113
    v_cvt_pk_bf16_f32 v145, v114, v115
    v_mfma_f32_32x32x16_bf16 v[128:143], a[180:183], v[44:47], v[128:143]
    ds_read_b128 a[144:147], v236 offset:4096
    buffer_load_dwordx4 v232, s[20:23], s39 offen offset:2048 lds
    v_exp_f32 v116, v116
    v_exp_f32 v117, v117
    v_exp_f32 v118, v118
    v_exp_f32 v119, v119
    v_cvt_pk_bf16_f32 v146, v116, v117
    v_cvt_pk_bf16_f32 v147, v118, v119
    v_mfma_f32_32x32x16_bf16 v[64:79], a[244:247], v[148:151], v[64:79]
    ds_read_b128 a[148:151], v237 offset:4096
    buffer_load_dwordx4 v233, s[20:23], s39 offen offset:3072 lds
    v_exp_f32 v120, v120
    v_exp_f32 v121, v121
    v_exp_f32 v122, v122
    v_exp_f32 v123, v123
    v_cvt_pk_bf16_f32 v148, v120, v121
    v_cvt_pk_bf16_f32 v149, v122, v123
    v_mfma_f32_32x32x16_bf16 v[80:95], a[240:243], v[144:147], v[80:95]
    ds_read_b128 a[208:211], v236 offset:6144
    buffer_load_dwordx4 v[184:187], v1, s[16:19], s78 offen sc1
    v_exp_f32 v124, v124
    v_exp_f32 v125, v125
    v_exp_f32 v126, v126
    v_exp_f32 v127, v127
    v_cvt_pk_bf16_f32 v150, v124, v125
    v_cvt_pk_bf16_f32 v151, v126, v127
    v_mfma_f32_32x32x16_bf16 v[112:127], a[56:59], v[16:19], 0
    s_add_u32 s84, s84, 4096
    ds_read_b128 a[212:215], v237 offset:6144
    buffer_load_dwordx4 v[188:191], v1, s[16:19], s78 offen offset:1024 sc1
    v_exp_f32 v128, v128
    v_exp_f32 v129, v129
    v_exp_f32 v130, v130
    v_exp_f32 v131, v131
    v_cvt_pk_bf16_f32 v144, v128, v129
    v_cvt_pk_bf16_f32 v145, v130, v131
    v_mfma_f32_32x32x16_bf16 v[112:127], a[60:63], v[20:23], v[112:127]
    s_and_b32 s84, s84, 0xffff
    buffer_load_dwordx4 v[192:195], v1, s[16:19], s78 offen offset:2048 sc1
    v_exp_f32 v132, v132
    v_exp_f32 v133, v133
    v_exp_f32 v134, v134
    v_exp_f32 v135, v135
    v_cvt_pk_bf16_f32 v146, v132, v133
    v_cvt_pk_bf16_f32 v147, v134, v135
    v_mfma_f32_32x32x16_bf16 v[80:95], a[244:247], v[148:151], v[80:95]
    s_add_u32 s80, s93, s84
    v_exp_f32 v136, v136
    v_exp_f32 v137, v137
    v_exp_f32 v138, v138
    v_exp_f32 v139, v139
    v_cvt_pk_bf16_f32 v148, v136, v137
    v_cvt_pk_bf16_f32 v149, v138, v139
    v_mfma_f32_32x32x16_bf16 v[96:111], a[240:243], v[144:147], v[96:111]
    buffer_load_dwordx4 v[196:199], v1, s[16:19], s78 offen offset:3072 sc1
    v_exp_f32 v140, v140
    v_exp_f32 v141, v141
    v_exp_f32 v142, v142
    v_exp_f32 v143, v143
    v_cvt_pk_bf16_f32 v150, v140, v141
    v_cvt_pk_bf16_f32 v151, v142, v143
    v_mfma_f32_32x32x16_bf16 v[128:143], a[56:59], v[24:27], 0
    s_waitcnt lgkmcnt(0)
    v_exp_f32 v112, v112
    v_exp_f32 v113, v113
    v_exp_f32 v114, v114
    v_exp_f32 v115, v115
    v_cvt_pk_bf16_f32 v144, v112, v113
    v_cvt_pk_bf16_f32 v145, v114, v115
    v_mfma_f32_32x32x16_bf16 v[128:143], a[60:63], v[28:31], v[128:143]
    s_add_u32 m0, s76, 0
    v_exp_f32 v116, v116
    v_exp_f32 v117, v117
    v_exp_f32 v118, v118
    v_exp_f32 v119, v119
    v_cvt_pk_bf16_f32 v146, v116, v117
    v_cvt_pk_bf16_f32 v147, v118, v119
    v_mfma_f32_32x32x16_bf16 v[96:111], a[244:247], v[148:151], v[96:111]
    buffer_load_dwordx4 v226, s[20:23], s40 offen lds
    v_exp_f32 v120, v120
    v_exp_f32 v121, v121
    v_exp_f32 v122, v122
    v_exp_f32 v123, v123
    v_cvt_pk_bf16_f32 v148, v120, v121
    v_cvt_pk_bf16_f32 v149, v122, v123
    v_mfma_f32_32x32x16_bf16 v[48:63], a[120:123], v[144:147], v[48:63]
    buffer_load_dwordx4 v227, s[20:23], s40 offen offset:1024 lds
    v_exp_f32 v124, v124
    v_exp_f32 v125, v125
    v_exp_f32 v126, v126
    v_exp_f32 v127, v127
    v_cvt_pk_bf16_f32 v150, v124, v125
    v_cvt_pk_bf16_f32 v151, v126, v127
    v_mfma_f32_32x32x16_bf16 v[112:127], a[56:59], v[32:35], 0
    buffer_load_dwordx4 v228, s[20:23], s40 offen offset:2048 lds
    v_exp_f32 v128, v128
    v_exp_f32 v129, v129
    v_exp_f32 v130, v130
    v_exp_f32 v131, v131
    v_cvt_pk_bf16_f32 v144, v128, v129
    v_cvt_pk_bf16_f32 v145, v130, v131
    v_mfma_f32_32x32x16_bf16 v[112:127], a[60:63], v[36:39], v[112:127]
    s_waitcnt vmcnt(7)
    ds_read_b128 a[24:27], v250
    buffer_load_dwordx4 v229, s[20:23], s40 offen offset:3072 lds
    v_exp_f32 v132, v132
    v_exp_f32 v133, v133
    v_exp_f32 v134, v134
    v_exp_f32 v135, v135
    v_cvt_pk_bf16_f32 v146, v132, v133
    v_cvt_pk_bf16_f32 v147, v134, v135
    v_mfma_f32_32x32x16_bf16 v[48:63], a[124:127], v[148:151], v[48:63]
    s_add_u32 m0, s76, 4096
    ds_read_b128 a[28:31], v251
    v_exp_f32 v136, v136
    v_exp_f32 v137, v137
    v_exp_f32 v138, v138
    v_exp_f32 v139, v139
    v_cvt_pk_bf16_f32 v148, v136, v137
    v_cvt_pk_bf16_f32 v149, v138, v139
    v_mfma_f32_32x32x16_bf16 v[64:79], a[120:123], v[144:147], v[64:79]
    ds_read_b128 a[88:91], v250 offset:2048
    buffer_load_dwordx4 v230, s[20:23], s40 offen lds
    v_exp_f32 v140, v140
    v_exp_f32 v141, v141
    v_exp_f32 v142, v142
    v_exp_f32 v143, v143
    v_cvt_pk_bf16_f32 v150, v140, v141
    v_cvt_pk_bf16_f32 v151, v142, v143
    v_mfma_f32_32x32x16_bf16 v[128:143], a[56:59], v[40:43], 0
    ds_read_b128 a[92:95], v251 offset:2048
    buffer_load_dwordx4 v231, s[20:23], s40 offen offset:1024 lds
    v_exp_f32 v112, v112
    v_exp_f32 v113, v113
    v_exp_f32 v114, v114
    v_exp_f32 v115, v115
    v_cvt_pk_bf16_f32 v144, v112, v113
    v_cvt_pk_bf16_f32 v145, v114, v115
    v_mfma_f32_32x32x16_bf16 v[128:143], a[60:63], v[44:47], v[128:143]
    ds_read_b128 a[152:155], v250 offset:4096
    buffer_load_dwordx4 v232, s[20:23], s40 offen offset:2048 lds
    v_exp_f32 v116, v116
    v_exp_f32 v117, v117
    v_exp_f32 v118, v118
    v_exp_f32 v119, v119
    v_cvt_pk_bf16_f32 v146, v116, v117
    v_cvt_pk_bf16_f32 v147, v118, v119
    v_mfma_f32_32x32x16_bf16 v[64:79], a[124:127], v[148:151], v[64:79]
    ds_read_b128 a[156:159], v251 offset:4096
    buffer_load_dwordx4 v233, s[20:23], s40 offen offset:3072 lds
    v_exp_f32 v120, v120
    v_exp_f32 v121, v121
    v_exp_f32 v122, v122
    v_exp_f32 v123, v123
    v_cvt_pk_bf16_f32 v148, v120, v121
    v_cvt_pk_bf16_f32 v149, v122, v123
    v_mfma_f32_32x32x16_bf16 v[80:95], a[120:123], v[144:147], v[80:95]
    ds_read_b128 a[216:219], v250 offset:6144
    buffer_load_dwordx4 v[200:203], v1, s[16:19], s80 offen sc1
    v_exp_f32 v124, v124
    v_exp_f32 v125, v125
    v_exp_f32 v126, v126
    v_exp_f32 v127, v127
    v_cvt_pk_bf16_f32 v150, v124, v125
    v_cvt_pk_bf16_f32 v151, v126, v127
    v_mfma_f32_32x32x16_bf16 v[112:127], a[184:187], v[16:19], 0
    ds_read_b128 a[220:223], v251 offset:6144
    buffer_load_dwordx4 v[204:207], v1, s[16:19], s80 offen offset:1024 sc1
    v_exp_f32 v128, v128
    v_exp_f32 v129, v129
    v_exp_f32 v130, v130
    v_exp_f32 v131, v131
    v_cvt_pk_bf16_f32 v144, v128, v129
    v_cvt_pk_bf16_f32 v145, v130, v131
    v_mfma_f32_32x32x16_bf16 v[112:127], a[188:191], v[20:23], v[112:127]
    buffer_load_dwordx4 v[208:211], v1, s[16:19], s80 offen offset:2048 sc1
    v_exp_f32 v132, v132
    v_exp_f32 v133, v133
    v_exp_f32 v134, v134
    v_exp_f32 v135, v135
    v_cvt_pk_bf16_f32 v146, v132, v133
    v_cvt_pk_bf16_f32 v147, v134, v135
    v_mfma_f32_32x32x16_bf16 v[80:95], a[124:127], v[148:151], v[80:95]
    v_exp_f32 v136, v136
    v_exp_f32 v137, v137
    v_exp_f32 v138, v138
    v_exp_f32 v139, v139
    v_cvt_pk_bf16_f32 v148, v136, v137
    v_cvt_pk_bf16_f32 v149, v138, v139
    v_mfma_f32_32x32x16_bf16 v[96:111], a[120:123], v[144:147], v[96:111]
    buffer_load_dwordx4 v[212:215], v1, s[16:19], s80 offen offset:3072 sc1
    v_exp_f32 v140, v140
    v_exp_f32 v141, v141
    v_exp_f32 v142, v142
    v_exp_f32 v143, v143
    v_cvt_pk_bf16_f32 v150, v140, v141
    v_cvt_pk_bf16_f32 v151, v142, v143
    v_mfma_f32_32x32x16_bf16 v[128:143], a[184:187], v[24:27], 0
    v_cmp_gt_u32 vcc, 160, v10
    s_cbranch_vccz .Lok_11
.Lpoll_12:
    buffer_load_dword v10, v9, s[16:19], 0 offen sc1
    s_waitcnt vmcnt(0)
    v_cmp_gt_u32 vcc, 160, v10
    s_cbranch_vccz .Lgot_13
    s_sub_u32 s59, s59, 1
    s_cmp_lg_u32 s59, 0
    s_cbranch_scc1 .Lpoll_12
    s_branch .Lexit
.Lgot_13:
.Lok_11:
    v_exp_f32 v112, v112
    v_exp_f32 v113, v113
    v_exp_f32 v114, v114
    v_exp_f32 v115, v115
    v_cvt_pk_bf16_f32 v144, v112, v113
    v_cvt_pk_bf16_f32 v145, v114, v115
    v_mfma_f32_32x32x16_bf16 v[128:143], a[188:191], v[28:31], v[128:143]
    s_waitcnt lgkmcnt(0)
    v_exp_f32 v116, v116
    v_exp_f32 v117, v117
    v_exp_f32 v118, v118
    v_exp_f32 v119, v119
    v_cvt_pk_bf16_f32 v146, v116, v117
    v_cvt_pk_bf16_f32 v147, v118, v119
    v_mfma_f32_32x32x16_bf16 v[96:111], a[124:127], v[148:151], v[96:111]
    v_exp_f32 v120, v120
    v_exp_f32 v121, v121
    v_exp_f32 v122, v122
    v_exp_f32 v123, v123
    v_cvt_pk_bf16_f32 v148, v120, v121
    v_cvt_pk_bf16_f32 v149, v122, v123
    v_mfma_f32_32x32x16_bf16 v[48:63], a[248:251], v[144:147], v[48:63]
    s_add_u32 m0, s77, 0
    v_exp_f32 v124, v124
    v_exp_f32 v125, v125
    v_exp_f32 v126, v126
    v_exp_f32 v127, v127
    v_cvt_pk_bf16_f32 v150, v124, v125
    v_cvt_pk_bf16_f32 v151, v126, v127
    v_mfma_f32_32x32x16_bf16 v[112:127], a[184:187], v[32:35], 0
    buffer_load_dwordx4 v226, s[20:23], s41 offen lds
    v_exp_f32 v128, v128
    v_exp_f32 v129, v129
    v_exp_f32 v130, v130
    v_exp_f32 v131, v131
    v_cvt_pk_bf16_f32 v144, v128, v129
    v_cvt_pk_bf16_f32 v145, v130, v131
    v_mfma_f32_32x32x16_bf16 v[112:127], a[188:191], v[36:39], v[112:127]
    s_waitcnt vmcnt(5)
    ds_read_b128 a[32:35], v236
    buffer_load_dwordx4 v227, s[20:23], s41 offen offset:1024 lds
    v_exp_f32 v132, v132
    v_exp_f32 v133, v133
    v_exp_f32 v134, v134
    v_exp_f32 v135, v135
    v_cvt_pk_bf16_f32 v146, v132, v133
    v_cvt_pk_bf16_f32 v147, v134, v135
    v_mfma_f32_32x32x16_bf16 v[48:63], a[252:255], v[148:151], v[48:63]
    ds_read_b128 a[36:39], v237
    buffer_load_dwordx4 v228, s[20:23], s41 offen offset:2048 lds
    v_exp_f32 v136, v136
    v_exp_f32 v137, v137
    v_exp_f32 v138, v138
    v_exp_f32 v139, v139
    v_cvt_pk_bf16_f32 v148, v136, v137
    v_cvt_pk_bf16_f32 v149, v138, v139
    v_mfma_f32_32x32x16_bf16 v[64:79], a[248:251], v[144:147], v[64:79]
    ds_read_b128 a[96:99], v236 offset:2048
    buffer_load_dwordx4 v229, s[20:23], s41 offen offset:3072 lds
    v_exp_f32 v140, v140
    v_exp_f32 v141, v141
    v_exp_f32 v142, v142
    v_exp_f32 v143, v143
    v_cvt_pk_bf16_f32 v150, v140, v141
    v_cvt_pk_bf16_f32 v151, v142, v143
    v_mfma_f32_32x32x16_bf16 v[128:143], a[184:187], v[40:43], 0
    s_add_u32 m0, s77, 4096
    ds_read_b128 a[100:103], v237 offset:2048
    v_exp_f32 v112, v112
    v_exp_f32 v113, v113
    v_exp_f32 v114, v114
    v_exp_f32 v115, v115
    v_cvt_pk_bf16_f32 v144, v112, v113
    v_cvt_pk_bf16_f32 v145, v114, v115
    v_mfma_f32_32x32x16_bf16 v[128:143], a[188:191], v[44:47], v[128:143]
    ds_read_b128 a[160:163], v236 offset:4096
    buffer_load_dwordx4 v230, s[20:23], s41 offen lds
    v_exp_f32 v116, v116
    v_exp_f32 v117, v117
    v_exp_f32 v118, v118
    v_exp_f32 v119, v119
    v_cvt_pk_bf16_f32 v146, v116, v117
    v_cvt_pk_bf16_f32 v147, v118, v119
    v_mfma_f32_32x32x16_bf16 v[64:79], a[252:255], v[148:151], v[64:79]
    ds_read_b128 a[164:167], v237 offset:4096
    buffer_load_dwordx4 v231, s[20:23], s41 offen offset:1024 lds
    v_exp_f32 v120, v120
    v_exp_f32 v121, v121
    v_exp_f32 v122, v122
    v_exp_f32 v123, v123
    v_cvt_pk_bf16_f32 v148, v120, v121
    v_cvt_pk_bf16_f32 v149, v122, v123
    v_mfma_f32_32x32x16_bf16 v[80:95], a[248:251], v[144:147], v[80:95]
    ds_read_b128 a[224:227], v236 offset:6144
    buffer_load_dwordx4 v232, s[20:23], s41 offen offset:2048 lds
    v_exp_f32 v124, v124
    v_exp_f32 v125, v125
    v_exp_f32 v126, v126
    v_exp_f32 v127, v127
    v_cvt_pk_bf16_f32 v150, v124, v125
    v_cvt_pk_bf16_f32 v151, v126, v127
    v_mfma_f32_32x32x16_bf16 v[112:127], v[152:155], v[16:19], 0
    ds_read_b128 a[228:231], v237 offset:6144
    buffer_load_dwordx4 v233, s[20:23], s41 offen offset:3072 lds
    v_exp_f32 v128, v128
    v_exp_f32 v129, v129
    v_exp_f32 v130, v130
    v_exp_f32 v131, v131
    v_cvt_pk_bf16_f32 v144, v128, v129
    v_cvt_pk_bf16_f32 v145, v130, v131
    v_mfma_f32_32x32x16_bf16 v[112:127], v[156:159], v[20:23], v[112:127]
    s_waitcnt lgkmcnt(0)
    v_exp_f32 v132, v132
    v_exp_f32 v133, v133
    v_exp_f32 v134, v134
    v_exp_f32 v135, v135
    v_cvt_pk_bf16_f32 v146, v132, v133
    v_cvt_pk_bf16_f32 v147, v134, v135
    v_mfma_f32_32x32x16_bf16 v[80:95], a[252:255], v[148:151], v[80:95]
    s_add_u32 m0, s76, 0
    v_exp_f32 v136, v136
    v_exp_f32 v137, v137
    v_exp_f32 v138, v138
    v_exp_f32 v139, v139
    v_cvt_pk_bf16_f32 v148, v136, v137
    v_cvt_pk_bf16_f32 v149, v138, v139
    v_mfma_f32_32x32x16_bf16 v[96:111], a[248:251], v[144:147], v[96:111]
    buffer_load_dwordx4 v226, s[20:23], s42 offen lds
    v_exp_f32 v140, v140
    v_exp_f32 v141, v141
    v_exp_f32 v142, v142
    v_exp_f32 v143, v143
    v_cvt_pk_bf16_f32 v150, v140, v141
    v_cvt_pk_bf16_f32 v151, v142, v143
    v_mfma_f32_32x32x16_bf16 v[128:143], v[152:155], v[24:27], 0
    buffer_load_dwordx4 v227, s[20:23], s42 offen offset:1024 lds
    v_exp_f32 v112, v112
    v_exp_f32 v113, v113
    v_exp_f32 v114, v114
    v_exp_f32 v115, v115
    v_cvt_pk_bf16_f32 v144, v112, v113
    v_cvt_pk_bf16_f32 v145, v114, v115
    v_mfma_f32_32x32x16_bf16 v[128:143], v[156:159], v[28:31], v[128:143]
    buffer_load_dwordx4 v228, s[20:23], s42 offen offset:2048 lds
    v_exp_f32 v116, v116
    v_exp_f32 v117, v117
    v_exp_f32 v118, v118
    v_exp_f32 v119, v119
    v_cvt_pk_bf16_f32 v146, v116, v117
    v_cvt_pk_bf16_f32 v147, v118, v119
    v_mfma_f32_32x32x16_bf16 v[96:111], a[252:255], v[148:151], v[96:111]
    buffer_load_dwordx4 v229, s[20:23], s42 offen offset:3072 lds
    v_exp_f32 v120, v120
    v_exp_f32 v121, v121
    v_exp_f32 v122, v122
    v_exp_f32 v123, v123
    v_cvt_pk_bf16_f32 v148, v120, v121
    v_cvt_pk_bf16_f32 v149, v122, v123
    v_mfma_f32_32x32x16_bf16 v[48:63], v[160:163], v[144:147], v[48:63]
    s_add_u32 m0, s76, 4096
    v_exp_f32 v124, v124
    v_exp_f32 v125, v125
    v_exp_f32 v126, v126
    v_exp_f32 v127, v127
    v_cvt_pk_bf16_f32 v150, v124, v125
    v_cvt_pk_bf16_f32 v151, v126, v127
    v_mfma_f32_32x32x16_bf16 v[112:127], v[152:155], v[32:35], 0
    buffer_load_dwordx4 v230, s[20:23], s42 offen lds
    v_exp_f32 v128, v128
    v_exp_f32 v129, v129
    v_exp_f32 v130, v130
    v_exp_f32 v131, v131
    v_cvt_pk_bf16_f32 v144, v128, v129
    v_cvt_pk_bf16_f32 v145, v130, v131
    v_mfma_f32_32x32x16_bf16 v[112:127], v[156:159], v[36:39], v[112:127]
    buffer_load_dwordx4 v231, s[20:23], s42 offen offset:1024 lds
    v_exp_f32 v132, v132
    v_exp_f32 v133, v133
    v_exp_f32 v134, v134
    v_exp_f32 v135, v135
    v_cvt_pk_bf16_f32 v146, v132, v133
    v_cvt_pk_bf16_f32 v147, v134, v135
    v_mfma_f32_32x32x16_bf16 v[48:63], v[164:167], v[148:151], v[48:63]
    buffer_load_dwordx4 v232, s[20:23], s42 offen offset:2048 lds
    v_exp_f32 v136, v136
    v_exp_f32 v137, v137
    v_exp_f32 v138, v138
    v_exp_f32 v139, v139
    v_cvt_pk_bf16_f32 v148, v136, v137
    v_cvt_pk_bf16_f32 v149, v138, v139
    v_mfma_f32_32x32x16_bf16 v[64:79], v[160:163], v[144:147], v[64:79]
    s_waitcnt vmcnt(7)
    ds_read_b128 a[40:43], v250
    buffer_load_dwordx4 v233, s[20:23], s42 offen offset:3072 lds
    v_exp_f32 v140, v140
    v_exp_f32 v141, v141
    v_exp_f32 v142, v142
    v_exp_f32 v143, v143
    v_cvt_pk_bf16_f32 v150, v140, v141
    v_cvt_pk_bf16_f32 v151, v142, v143
    v_mfma_f32_32x32x16_bf16 v[128:143], v[152:155], v[40:43], 0
    ds_read_b128 a[44:47], v251
    v_exp_f32 v112, v112
    v_exp_f32 v113, v113
    v_exp_f32 v114, v114
    v_exp_f32 v115, v115
    v_cvt_pk_bf16_f32 v144, v112, v113
    v_cvt_pk_bf16_f32 v145, v114, v115
    v_mfma_f32_32x32x16_bf16 v[128:143], v[156:159], v[44:47], v[128:143]
    s_add_u32 s79, s46, 0
    ds_read_b128 a[104:107], v250 offset:2048
    v_exp_f32 v116, v116
    v_exp_f32 v117, v117
    v_exp_f32 v118, v118
    v_exp_f32 v119, v119
    v_cvt_pk_bf16_f32 v146, v116, v117
    v_cvt_pk_bf16_f32 v147, v118, v119
    v_mfma_f32_32x32x16_bf16 v[64:79], v[164:167], v[148:151], v[64:79]
    s_add_u32 m0, s75, 0
    ds_read_b128 a[108:111], v251 offset:2048
    v_exp_f32 v120, v120
    v_exp_f32 v121, v121
    v_exp_f32 v122, v122
    v_exp_f32 v123, v123
    v_cvt_pk_bf16_f32 v148, v120, v121
    v_cvt_pk_bf16_f32 v149, v122, v123
    v_mfma_f32_32x32x16_bf16 v[80:95], v[160:163], v[144:147], v[80:95]
    ds_read_b128 a[168:171], v250 offset:4096
    buffer_load_dwordx4 v1, s[16:19], s79 offen sc1 lds
    v_exp_f32 v124, v124
    v_exp_f32 v125, v125
    v_exp_f32 v126, v126
    v_exp_f32 v127, v127
    v_cvt_pk_bf16_f32 v150, v124, v125
    v_cvt_pk_bf16_f32 v151, v126, v127
    v_mfma_f32_32x32x16_bf16 v[112:127], v[168:171], v[16:19], 0
    ds_read_b128 a[172:175], v251 offset:4096
    buffer_load_dwordx4 v1, s[16:19], s79 offen offset:1024 sc1 lds
    v_exp_f32 v128, v128
    v_exp_f32 v129, v129
    v_exp_f32 v130, v130
    v_exp_f32 v131, v131
    v_cvt_pk_bf16_f32 v144, v128, v129
    v_cvt_pk_bf16_f32 v145, v130, v131
    v_mfma_f32_32x32x16_bf16 v[112:127], v[172:175], v[20:23], v[112:127]
    ds_read_b128 a[232:235], v250 offset:6144
    buffer_load_dwordx4 v1, s[16:19], s79 offen offset:2048 sc1 lds
    v_exp_f32 v132, v132
    v_exp_f32 v133, v133
    v_exp_f32 v134, v134
    v_exp_f32 v135, v135
    v_cvt_pk_bf16_f32 v146, v132, v133
    v_cvt_pk_bf16_f32 v147, v134, v135
    v_mfma_f32_32x32x16_bf16 v[80:95], v[164:167], v[148:151], v[80:95]
    ds_read_b128 a[236:239], v251 offset:6144
    buffer_load_dwordx4 v1, s[16:19], s79 offen offset:3072 sc1 lds
    v_exp_f32 v136, v136
    v_exp_f32 v137, v137
    v_exp_f32 v138, v138
    v_exp_f32 v139, v139
    v_cvt_pk_bf16_f32 v148, v136, v137
    v_cvt_pk_bf16_f32 v149, v138, v139
    v_mfma_f32_32x32x16_bf16 v[96:111], v[160:163], v[144:147], v[96:111]
    s_waitcnt lgkmcnt(0)
    v_exp_f32 v140, v140
    v_exp_f32 v141, v141
    v_exp_f32 v142, v142
    v_exp_f32 v143, v143
    v_cvt_pk_bf16_f32 v150, v140, v141
    v_cvt_pk_bf16_f32 v151, v142, v143
    v_mfma_f32_32x32x16_bf16 v[128:143], v[168:171], v[24:27], 0
    s_add_u32 m0, s77, 0
    v_exp_f32 v112, v112
    v_exp_f32 v113, v113
    v_exp_f32 v114, v114
    v_exp_f32 v115, v115
    v_cvt_pk_bf16_f32 v144, v112, v113
    v_cvt_pk_bf16_f32 v145, v114, v115
    v_mfma_f32_32x32x16_bf16 v[128:143], v[172:175], v[28:31], v[128:143]
    buffer_load_dwordx4 v226, s[20:23], s43 offen lds
    v_exp_f32 v116, v116
    v_exp_f32 v117, v117
    v_exp_f32 v118, v118
    v_exp_f32 v119, v119
    v_cvt_pk_bf16_f32 v146, v116, v117
    v_cvt_pk_bf16_f32 v147, v118, v119
    v_mfma_f32_32x32x16_bf16 v[96:111], v[164:167], v[148:151], v[96:111]
    buffer_load_dwordx4 v227, s[20:23], s43 offen offset:1024 lds
    v_exp_f32 v120, v120
    v_exp_f32 v121, v121
    v_exp_f32 v122, v122
    v_exp_f32 v123, v123
    v_cvt_pk_bf16_f32 v148, v120, v121
    v_cvt_pk_bf16_f32 v149, v122, v123
    v_mfma_f32_32x32x16_bf16 v[48:63], v[176:179], v[144:147], v[48:63]
    s_waitcnt vmcnt(6)
    ds_read_b128 a[48:51], v236
    buffer_load_dwordx4 v228, s[20:23], s43 offen offset:2048 lds
    v_exp_f32 v124, v124
    v_exp_f32 v125, v125
    v_exp_f32 v126, v126
    v_exp_f32 v127, v127
    v_cvt_pk_bf16_f32 v150, v124, v125
    v_cvt_pk_bf16_f32 v151, v126, v127
    v_mfma_f32_32x32x16_bf16 v[112:127], v[168:171], v[32:35], 0
    ds_read_b128 a[52:55], v237
    buffer_load_dwordx4 v229, s[20:23], s43 offen offset:3072 lds
    v_exp_f32 v128, v128
    v_exp_f32 v129, v129
    v_exp_f32 v130, v130
    v_exp_f32 v131, v131
    v_cvt_pk_bf16_f32 v144, v128, v129
    v_cvt_pk_bf16_f32 v145, v130, v131
    v_mfma_f32_32x32x16_bf16 v[112:127], v[172:175], v[36:39], v[112:127]
    s_add_u32 m0, s77, 4096
    ds_read_b128 a[112:115], v236 offset:2048
    v_exp_f32 v132, v132
    v_exp_f32 v133, v133
    v_exp_f32 v134, v134
    v_exp_f32 v135, v135
    v_cvt_pk_bf16_f32 v146, v132, v133
    v_cvt_pk_bf16_f32 v147, v134, v135
    v_mfma_f32_32x32x16_bf16 v[48:63], v[180:183], v[148:151], v[48:63]
    ds_read_b128 a[116:119], v237 offset:2048
    buffer_load_dwordx4 v230, s[20:23], s43 offen lds
    v_exp_f32 v136, v136
    v_exp_f32 v137, v137
    v_exp_f32 v138, v138
    v_exp_f32 v139, v139
    v_cvt_pk_bf16_f32 v148, v136, v137
    v_cvt_pk_bf16_f32 v149, v138, v139
    v_mfma_f32_32x32x16_bf16 v[64:79], v[176:179], v[144:147], v[64:79]
    ds_read_b128 a[176:179], v236 offset:4096
    buffer_load_dwordx4 v231, s[20:23], s43 offen offset:1024 lds
    v_exp_f32 v140, v140
    v_exp_f32 v141, v141
    v_exp_f32 v142, v142
    v_exp_f32 v143, v143
    v_cvt_pk_bf16_f32 v150, v140, v141
    v_cvt_pk_bf16_f32 v151, v142, v143
    v_mfma_f32_32x32x16_bf16 v[128:143], v[168:171], v[40:43], 0
    ds_read_b128 a[180:183], v237 offset:4096
    buffer_load_dwordx4 v232, s[20:23], s43 offen offset:2048 lds
    v_exp_f32 v112, v112
    v_exp_f32 v113, v113
    v_exp_f32 v114, v114
    v_exp_f32 v115, v115
    v_cvt_pk_bf16_f32 v144, v112, v113
    v_cvt_pk_bf16_f32 v145, v114, v115
    v_mfma_f32_32x32x16_bf16 v[128:143], v[172:175], v[44:47], v[128:143]
    ds_read_b128 a[240:243], v236 offset:6144
    buffer_load_dwordx4 v233, s[20:23], s43 offen offset:3072 lds
    v_exp_f32 v116, v116
    v_exp_f32 v117, v117
    v_exp_f32 v118, v118
    v_exp_f32 v119, v119
    v_cvt_pk_bf16_f32 v146, v116, v117
    v_cvt_pk_bf16_f32 v147, v118, v119
    v_mfma_f32_32x32x16_bf16 v[64:79], v[180:183], v[148:151], v[64:79]
    s_add_u32 s79, s46, 4096
    ds_read_b128 a[244:247], v237 offset:6144
    v_exp_f32 v120, v120
    v_exp_f32 v121, v121
    v_exp_f32 v122, v122
    v_exp_f32 v123, v123
    v_cvt_pk_bf16_f32 v148, v120, v121
    v_cvt_pk_bf16_f32 v149, v122, v123
    v_mfma_f32_32x32x16_bf16 v[80:95], v[176:179], v[144:147], v[80:95]
    v_exp_f32 v124, v124
    v_exp_f32 v125, v125
    v_exp_f32 v126, v126
    v_exp_f32 v127, v127
    v_cvt_pk_bf16_f32 v150, v124, v125
    v_cvt_pk_bf16_f32 v151, v126, v127
    v_mfma_f32_32x32x16_bf16 v[112:127], v[184:187], v[16:19], 0
    s_add_u32 m0, s75, 4096
    v_exp_f32 v128, v128
    v_exp_f32 v129, v129
    v_exp_f32 v130, v130
    v_exp_f32 v131, v131
    v_cvt_pk_bf16_f32 v144, v128, v129
    v_cvt_pk_bf16_f32 v145, v130, v131
    v_mfma_f32_32x32x16_bf16 v[112:127], v[188:191], v[20:23], v[112:127]
    buffer_load_dwordx4 v1, s[16:19], s79 offen sc1 lds
    v_exp_f32 v132, v132
    v_exp_f32 v133, v133
    v_exp_f32 v134, v134
    v_exp_f32 v135, v135
    v_cvt_pk_bf16_f32 v146, v132, v133
    v_cvt_pk_bf16_f32 v147, v134, v135
    v_mfma_f32_32x32x16_bf16 v[80:95], v[180:183], v[148:151], v[80:95]
    buffer_load_dwordx4 v1, s[16:19], s79 offen offset:1024 sc1 lds
    v_exp_f32 v136, v136
    v_exp_f32 v137, v137
    v_exp_f32 v138, v138
    v_exp_f32 v139, v139
    v_cvt_pk_bf16_f32 v148, v136, v137
    v_cvt_pk_bf16_f32 v149, v138, v139
    v_mfma_f32_32x32x16_bf16 v[96:111], v[176:179], v[144:147], v[96:111]
    buffer_load_dwordx4 v1, s[16:19], s79 offen offset:2048 sc1 lds
    v_exp_f32 v140, v140
    v_exp_f32 v141, v141
    v_exp_f32 v142, v142
    v_exp_f32 v143, v143
    v_cvt_pk_bf16_f32 v150, v140, v141
    v_cvt_pk_bf16_f32 v151, v142, v143
    v_mfma_f32_32x32x16_bf16 v[128:143], v[184:187], v[24:27], 0
    buffer_load_dwordx4 v1, s[16:19], s79 offen offset:3072 sc1 lds
    v_exp_f32 v112, v112
    v_exp_f32 v113, v113
    v_exp_f32 v114, v114
    v_exp_f32 v115, v115
    v_cvt_pk_bf16_f32 v144, v112, v113
    v_cvt_pk_bf16_f32 v145, v114, v115
    v_mfma_f32_32x32x16_bf16 v[128:143], v[188:191], v[28:31], v[128:143]
    s_add_u32 s79, s46, 8192
    v_exp_f32 v116, v116
    v_exp_f32 v117, v117
    v_exp_f32 v118, v118
    v_exp_f32 v119, v119
    v_cvt_pk_bf16_f32 v146, v116, v117
    v_cvt_pk_bf16_f32 v147, v118, v119
    v_mfma_f32_32x32x16_bf16 v[96:111], v[180:183], v[148:151], v[96:111]
    v_exp_f32 v120, v120
    v_exp_f32 v121, v121
    v_exp_f32 v122, v122
    v_exp_f32 v123, v123
    v_cvt_pk_bf16_f32 v148, v120, v121
    v_cvt_pk_bf16_f32 v149, v122, v123
    v_mfma_f32_32x32x16_bf16 v[48:63], v[192:195], v[144:147], v[48:63]
    s_add_u32 m0, s75, 8192
    v_exp_f32 v124, v124
    v_exp_f32 v125, v125
    v_exp_f32 v126, v126
    v_exp_f32 v127, v127
    v_cvt_pk_bf16_f32 v150, v124, v125
    v_cvt_pk_bf16_f32 v151, v126, v127
    v_mfma_f32_32x32x16_bf16 v[112:127], v[184:187], v[32:35], 0
    s_waitcnt vmcnt(4)
    ds_read_b128 a[56:59], v250
    buffer_load_dwordx4 v1, s[16:19], s79 offen sc1 lds
    v_exp_f32 v128, v128
    v_exp_f32 v129, v129
    v_exp_f32 v130, v130
    v_exp_f32 v131, v131
    v_cvt_pk_bf16_f32 v144, v128, v129
    v_cvt_pk_bf16_f32 v145, v130, v131
    v_mfma_f32_32x32x16_bf16 v[112:127], v[188:191], v[36:39], v[112:127]
    ds_read_b128 a[60:63], v251
    buffer_load_dwordx4 v1, s[16:19], s79 offen offset:1024 sc1 lds
    v_exp_f32 v132, v132
    v_exp_f32 v133, v133
    v_exp_f32 v134, v134
    v_exp_f32 v135, v135
    v_cvt_pk_bf16_f32 v146, v132, v133
    v_cvt_pk_bf16_f32 v147, v134, v135
    v_mfma_f32_32x32x16_bf16 v[48:63], v[196:199], v[148:151], v[48:63]
    ds_read_b128 a[120:123], v250 offset:2048
    buffer_load_dwordx4 v1, s[16:19], s79 offen offset:2048 sc1 lds
    v_exp_f32 v136, v136
    v_exp_f32 v137, v137
    v_exp_f32 v138, v138
    v_exp_f32 v139, v139
    v_cvt_pk_bf16_f32 v148, v136, v137
    v_cvt_pk_bf16_f32 v149, v138, v139
    v_mfma_f32_32x32x16_bf16 v[64:79], v[192:195], v[144:147], v[64:79]
    ds_read_b128 a[124:127], v251 offset:2048
    buffer_load_dwordx4 v1, s[16:19], s79 offen offset:3072 sc1 lds
    v_exp_f32 v140, v140
    v_exp_f32 v141, v141
    v_exp_f32 v142, v142
    v_exp_f32 v143, v143
    v_cvt_pk_bf16_f32 v150, v140, v141
    v_cvt_pk_bf16_f32 v151, v142, v143
    v_mfma_f32_32x32x16_bf16 v[128:143], v[184:187], v[40:43], 0
    s_add_u32 s79, s46, 12288
    ds_read_b128 a[184:187], v250 offset:4096
    v_exp_f32 v112, v112
    v_exp_f32 v113, v113
    v_exp_f32 v114, v114
    v_exp_f32 v115, v115
    v_cvt_pk_bf16_f32 v144, v112, v113
    v_cvt_pk_bf16_f32 v145, v114, v115
    v_mfma_f32_32x32x16_bf16 v[128:143], v[188:191], v[44:47], v[128:143]
    s_add_u32 m0, s75, 12288
    ds_read_b128 a[188:191], v251 offset:4096
    v_exp_f32 v116, v116
    v_exp_f32 v117, v117
    v_exp_f32 v118, v118
    v_exp_f32 v119, v119
    v_cvt_pk_bf16_f32 v146, v116, v117
    v_cvt_pk_bf16_f32 v147, v118, v119
    v_mfma_f32_32x32x16_bf16 v[64:79], v[196:199], v[148:151], v[64:79]
    ds_read_b128 a[248:251], v250 offset:6144
    buffer_load_dwordx4 v1, s[16:19], s79 offen sc1 lds
    v_exp_f32 v120, v120
    v_exp_f32 v121, v121
    v_exp_f32 v122, v122
    v_exp_f32 v123, v123
    v_cvt_pk_bf16_f32 v148, v120, v121
    v_cvt_pk_bf16_f32 v149, v122, v123
    v_mfma_f32_32x32x16_bf16 v[80:95], v[192:195], v[144:147], v[80:95]
    ds_read_b128 a[252:255], v251 offset:6144
    buffer_load_dwordx4 v1, s[16:19], s79 offen offset:1024 sc1 lds
    v_exp_f32 v124, v124
    v_exp_f32 v125, v125
    v_exp_f32 v126, v126
    v_exp_f32 v127, v127
    v_cvt_pk_bf16_f32 v150, v124, v125
    v_cvt_pk_bf16_f32 v151, v126, v127
    v_mfma_f32_32x32x16_bf16 v[112:127], v[200:203], v[16:19], 0
    buffer_load_dwordx4 v1, s[16:19], s79 offen offset:2048 sc1 lds
    v_exp_f32 v128, v128
    v_exp_f32 v129, v129
    v_exp_f32 v130, v130
    v_exp_f32 v131, v131
    v_cvt_pk_bf16_f32 v144, v128, v129
    v_cvt_pk_bf16_f32 v145, v130, v131
    v_mfma_f32_32x32x16_bf16 v[112:127], v[204:207], v[20:23], v[112:127]
    buffer_load_dwordx4 v1, s[16:19], s79 offen offset:3072 sc1 lds
    v_exp_f32 v132, v132
    v_exp_f32 v133, v133
    v_exp_f32 v134, v134
    v_exp_f32 v135, v135
    v_cvt_pk_bf16_f32 v146, v132, v133
    v_cvt_pk_bf16_f32 v147, v134, v135
    v_mfma_f32_32x32x16_bf16 v[80:95], v[196:199], v[148:151], v[80:95]
    v_exp_f32 v136, v136
    v_exp_f32 v137, v137
    v_exp_f32 v138, v138
    v_exp_f32 v139, v139
    v_cvt_pk_bf16_f32 v148, v136, v137
    v_cvt_pk_bf16_f32 v149, v138, v139
    v_mfma_f32_32x32x16_bf16 v[96:111], v[192:195], v[144:147], v[96:111]
    v_exp_f32 v140, v140
    v_exp_f32 v141, v141
    v_exp_f32 v142, v142
    v_exp_f32 v143, v143
    v_cvt_pk_bf16_f32 v150, v140, v141
    v_cvt_pk_bf16_f32 v151, v142, v143
    v_mfma_f32_32x32x16_bf16 v[128:143], v[200:203], v[24:27], 0
    v_exp_f32 v112, v112
    v_exp_f32 v113, v113
    v_exp_f32 v114, v114
    v_exp_f32 v115, v115
    v_cvt_pk_bf16_f32 v144, v112, v113
    v_cvt_pk_bf16_f32 v145, v114, v115
    v_mfma_f32_32x32x16_bf16 v[128:143], v[204:207], v[28:31], v[128:143]
    v_exp_f32 v116, v116
    v_exp_f32 v117, v117
    v_exp_f32 v118, v118
    v_exp_f32 v119, v119
    v_cvt_pk_bf16_f32 v146, v116, v117
    v_cvt_pk_bf16_f32 v147, v118, v119
    v_mfma_f32_32x32x16_bf16 v[96:111], v[196:199], v[148:151], v[96:111]
    v_exp_f32 v120, v120
    v_exp_f32 v121, v121
    v_exp_f32 v122, v122
    v_exp_f32 v123, v123
    v_cvt_pk_bf16_f32 v148, v120, v121
    v_cvt_pk_bf16_f32 v149, v122, v123
    v_mfma_f32_32x32x16_bf16 v[48:63], v[208:211], v[144:147], v[48:63]
    v_exp_f32 v124, v124
    v_exp_f32 v125, v125
    v_exp_f32 v126, v126
    v_exp_f32 v127, v127
    v_cvt_pk_bf16_f32 v150, v124, v125
    v_cvt_pk_bf16_f32 v151, v126, v127
    v_mfma_f32_32x32x16_bf16 v[112:127], v[200:203], v[32:35], 0
    v_exp_f32 v128, v128
    v_exp_f32 v129, v129
    v_exp_f32 v130, v130
    v_exp_f32 v131, v131
    v_cvt_pk_bf16_f32 v144, v128, v129
    v_cvt_pk_bf16_f32 v145, v130, v131
    v_mfma_f32_32x32x16_bf16 v[112:127], v[204:207], v[36:39], v[112:127]
    v_exp_f32 v132, v132
    v_exp_f32 v133, v133
    v_exp_f32 v134, v134
    v_exp_f32 v135, v135
    v_cvt_pk_bf16_f32 v146, v132, v133
    v_cvt_pk_bf16_f32 v147, v134, v135
    v_mfma_f32_32x32x16_bf16 v[48:63], v[212:215], v[148:151], v[48:63]
    v_exp_f32 v136, v136
    v_exp_f32 v137, v137
    v_exp_f32 v138, v138
    v_exp_f32 v139, v139
    v_cvt_pk_bf16_f32 v148, v136, v137
    v_cvt_pk_bf16_f32 v149, v138, v139
    v_mfma_f32_32x32x16_bf16 v[64:79], v[208:211], v[144:147], v[64:79]
    v_exp_f32 v140, v140
    v_exp_f32 v141, v141
    v_exp_f32 v142, v142
    v_exp_f32 v143, v143
    v_cvt_pk_bf16_f32 v150, v140, v141
    v_cvt_pk_bf16_f32 v151, v142, v143
    v_mfma_f32_32x32x16_bf16 v[128:143], v[200:203], v[40:43], 0
    ds_write_b128 v8, v[48:51]
    v_exp_f32 v112, v112
    v_exp_f32 v113, v113
    v_exp_f32 v114, v114
    v_exp_f32 v115, v115
    v_cvt_pk_bf16_f32 v144, v112, v113
    v_cvt_pk_bf16_f32 v145, v114, v115
    v_mfma_f32_32x32x16_bf16 v[128:143], v[204:207], v[44:47], v[128:143]
    ds_write_b128 v8, v[52:55] offset:1024
    v_exp_f32 v116, v116
    v_exp_f32 v117, v117
    v_exp_f32 v118, v118
    v_exp_f32 v119, v119
    v_cvt_pk_bf16_f32 v146, v116, v117
    v_cvt_pk_bf16_f32 v147, v118, v119
    v_mfma_f32_32x32x16_bf16 v[64:79], v[212:215], v[148:151], v[64:79]
    ds_write_b128 v8, v[56:59] offset:2048
    v_exp_f32 v120, v120
    v_exp_f32 v121, v121
    v_exp_f32 v122, v122
    v_exp_f32 v123, v123
    v_cvt_pk_bf16_f32 v148, v120, v121
    v_cvt_pk_bf16_f32 v149, v122, v123
    v_mfma_f32_32x32x16_bf16 v[80:95], v[208:211], v[144:147], v[80:95]
    ds_write_b128 v8, v[60:63] offset:3072
    v_exp_f32 v124, v124
    v_exp_f32 v125, v125
    v_exp_f32 v126, v126
    v_exp_f32 v127, v127
    v_cvt_pk_bf16_f32 v150, v124, v125
    v_cvt_pk_bf16_f32 v151, v126, v127
    ds_write_b128 v8, v[64:67] offset:4096
    v_exp_f32 v128, v128
    v_exp_f32 v129, v129
    v_exp_f32 v130, v130
    v_exp_f32 v131, v131
    v_cvt_pk_bf16_f32 v144, v128, v129
    v_cvt_pk_bf16_f32 v145, v130, v131
    ds_write_b128 v8, v[68:71] offset:5120
    v_exp_f32 v132, v132
    v_exp_f32 v133, v133
    v_exp_f32 v134, v134
    v_exp_f32 v135, v135
    v_cvt_pk_bf16_f32 v146, v132, v133
    v_cvt_pk_bf16_f32 v147, v134, v135
    v_mfma_f32_32x32x16_bf16 v[80:95], v[212:215], v[148:151], v[80:95]
    ds_write_b128 v8, v[72:75] offset:6144
    v_exp_f32 v136, v136
    v_exp_f32 v137, v137
    v_exp_f32 v138, v138
    v_exp_f32 v139, v139
    v_cvt_pk_bf16_f32 v148, v136, v137
    v_cvt_pk_bf16_f32 v149, v138, v139
    v_mfma_f32_32x32x16_bf16 v[96:111], v[208:211], v[144:147], v[96:111]
    ds_write_b128 v8, v[76:79] offset:7168
    v_exp_f32 v140, v140
    v_exp_f32 v141, v141
    v_exp_f32 v142, v142
    v_exp_f32 v143, v143
    v_cvt_pk_bf16_f32 v150, v140, v141
    v_cvt_pk_bf16_f32 v151, v142, v143
    s_nop 1
    v_mfma_f32_32x32x16_bf16 v[96:111], v[212:215], v[148:151], v[96:111]
    ds_write_b128 v8, v[80:83] offset:8192
    ds_write_b128 v8, v[84:87] offset:9216
    ds_write_b128 v8, v[88:91] offset:10240
    ds_write_b128 v8, v[92:95] offset:11264
    v_max3_f32 v244, abs(v60), abs(v76), abs(v92)
    v_add_f32 v245, v60, v76
    v_add_f32 v245, v245, v92
    s_nop 4
    v_add_f32 v245, v245, v108
    v_max3_f32 v244, v244, abs(v108), abs(v108)
    v_cmp_nge_f32 vcc, 0x5d800000, v244
    v_cmp_u_f32 s[68:69], v245, v245
    s_or_b64 vcc, vcc, s[68:69]
    s_cmp_lg_u64 vcc, 0
    s_cselect_b32 s62, 1, 0
    s_lshl_b32 s63, s48, 2
    s_add_u32 s63, s63, 158720
    v_mov_b32 v244, s62
    v_mov_b32 v245, s63
    ds_write_b32 v245, v244
    v_mov_b32 v245, 158720
    s_waitcnt vmcnt(0) lgkmcnt(0)
    s_barrier
    ds_read_b128 v[248:251], v245
    ds_read_b128 v[112:115], v11
    ds_read_b128 v[116:119], v11 offset:1024
    ds_read_b128 v[120:123], v11 offset:2048
    ds_read_b128 v[124:127], v11 offset:3072
    ds_read_b128 v[128:131], v12
    ds_read_b128 v[132:135], v12 offset:1024
    ds_read_b128 v[136:139], v12 offset:2048
    ds_read_b128 v[140:143], v12 offset:3072
    ds_read_b128 v[144:147], v13
    ds_read_b128 v[148:151], v13 offset:1024
    ds_read_b128 v[152:155], v13 offset:2048
    ds_read_b128 v[156:159], v13 offset:3072
    s_waitcnt lgkmcnt(12)
    v_or_b32 v248, v248, v249
    v_or3_b32 v248, v248, v250, v251
    s_nop 0
    v_readfirstlane_b32 s62, v248
    s_andn2_b32 s62, s62, s60
    s_cmp_lg_u32 s62, 0
    s_cbranch_scc1 .Ltruemax
    s_waitcnt lgkmcnt(11)
    v_pk_add_f32 v[96:97], v[96:97], v[112:113]
    v_pk_add_f32 v[98:99], v[98:99], v[114:115]
    s_waitcnt lgkmcnt(10)
    v_pk_add_f32 v[100:101], v[100:101], v[116:117]
    v_pk_add_f32 v[102:103], v[102:103], v[118:119]
    s_waitcnt lgkmcnt(9)
    v_pk_add_f32 v[104:105], v[104:105], v[120:121]
    v_pk_add_f32 v[106:107], v[106:107], v[122:123]
    s_waitcnt lgkmcnt(8)
    v_pk_add_f32 v[108:109], v[108:109], v[124:125]
    v_pk_add_f32 v[110:111], v[110:111], v[126:127]
    s_waitcnt lgkmcnt(7)
    v_pk_add_f32 v[96:97], v[96:97], v[128:129]
    v_pk_add_f32 v[98:99], v[98:99], v[130:131]
    s_waitcnt lgkmcnt(6)
    v_pk_add_f32 v[100:101], v[100:101], v[132:133]
    v_pk_add_f32 v[102:103], v[102:103], v[134:135]
    s_waitcnt lgkmcnt(5)
    v_pk_add_f32 v[104:105], v[104:105], v[136:137]
    v_pk_add_f32 v[106:107], v[106:107], v[138:139]
    s_waitcnt lgkmcnt(4)
    v_pk_add_f32 v[108:109], v[108:109], v[140:141]
    v_pk_add_f32 v[110:111], v[110:111], v[142:143]
    s_waitcnt lgkmcnt(3)
    v_pk_add_f32 v[96:97], v[96:97], v[144:145]
    v_pk_add_f32 v[98:99], v[98:99], v[146:147]
    s_waitcnt lgkmcnt(2)
    v_pk_add_f32 v[100:101], v[100:101], v[148:149]
    v_pk_add_f32 v[102:103], v[102:103], v[150:151]
    s_waitcnt lgkmcnt(1)
    v_pk_add_f32 v[104:105], v[104:105], v[152:153]
    v_pk_add_f32 v[106:107], v[106:107], v[154:155]
    s_waitcnt lgkmcnt(0)
    v_pk_add_f32 v[108:109], v[108:109], v[156:157]
    v_pk_add_f32 v[110:111], v[110:111], v[158:159]
    v_mov_b32 v244, v108
    v_mov_b32 v246, v108
    s_nop 1
    v_permlane32_swap_b32 v244, v246
    v_rcp_f32 v244, v246
    s_nop 0
    v_mov_b32 v245, v244
    v_cndmask_b32 v246, v244, 0, s[72:73]
    v_mov_b32 v247, v246
    v_pk_mul_f32 v[96:97], v[96:97], v[244:245]
    v_pk_mul_f32 v[98:99], v[98:99], v[244:245]
    v_pk_mul_f32 v[100:101], v[100:101], v[244:245]
    v_pk_mul_f32 v[102:103], v[102:103], v[244:245]
    v_pk_mul_f32 v[104:105], v[104:105], v[244:245]
    v_pk_mul_f32 v[106:107], v[106:107], v[244:245]
    v_pk_mul_f32 v[108:109], v[108:109], v[246:247]
    v_pk_mul_f32 v[110:111], v[110:111], v[246:247]
    v_cvt_pk_bf16_f32 v48, v96, v97
    v_cvt_pk_bf16_f32 v49, v98, v99
    v_cvt_pk_bf16_f32 v50, v100, v101
    v_cvt_pk_bf16_f32 v51, v102, v103
    v_min_u32 v48, -2, v48
    buffer_store_dwordx4 v[48:51], v7, s[16:19], s91 offen sc1
    v_cvt_pk_bf16_f32 v52, v104, v105
    v_cvt_pk_bf16_f32 v53, v106, v107
    v_cvt_pk_bf16_f32 v54, v108, v109
    v_cvt_pk_bf16_f32 v55, v110, v111
    v_min_u32 v52, -2, v52
    buffer_store_dwordx4 v[52:55], v7, s[16:19], s91 offen offset:512 sc1
    s_add_u32 s79, s44, 0
    s_add_u32 m0, s45, 0
    s_nop 0
    buffer_load_dwordx4 v1, s[16:19], s79 offen sc1 lds
    buffer_load_dwordx4 v1, s[16:19], s79 offen offset:1024 sc1 lds
    buffer_load_dwordx4 v1, s[16:19], s79 offen offset:2048 sc1 lds
    buffer_load_dwordx4 v1, s[16:19], s79 offen offset:3072 sc1 lds
    s_add_u32 s79, s44, 4096
    s_add_u32 m0, s45, 4096
    s_nop 0
    buffer_load_dwordx4 v1, s[16:19], s79 offen sc1 lds
    buffer_load_dwordx4 v1, s[16:19], s79 offen offset:1024 sc1 lds
    buffer_load_dwordx4 v1, s[16:19], s79 offen offset:2048 sc1 lds
    buffer_load_dwordx4 v1, s[16:19], s79 offen offset:3072 sc1 lds
    s_add_u32 s79, s44, 8192
    s_add_u32 m0, s45, 8192
    s_nop 0
    buffer_load_dwordx4 v1, s[16:19], s79 offen sc1 lds
    buffer_load_dwordx4 v1, s[16:19], s79 offen offset:1024 sc1 lds
    buffer_load_dwordx4 v1, s[16:19], s79 offen offset:2048 sc1 lds
    s_lshl_b32 s62, s61, 10
    s_add_u32 s62, s62, 1048576
    s_mov_b32 s64, 0
    s_and_b32 s64, s64, 3
    s_lshl_b32 s64, s64, 19
    s_add_u32 s74, s64, s62
    s_mov_b32 s64, 1
    s_and_b32 s64, s64, 3
    s_lshl_b32 s64, s64, 19
    s_add_u32 s75, s64, s62
    s_mov_b32 s64, 2
    s_and_b32 s64, s64, 3
    s_lshl_b32 s64, s64, 19
    s_add_u32 s76, s64, s62
    s_mov_b32 s64, 3
    s_and_b32 s64, s64, 3
    s_lshl_b32 s64, s64, 19
    s_add_u32 s77, s64, s62
    v_add_u32 v144, 131072, v1
    v_add_u32 v145, 262144, v1
    v_add_u32 v146, 393216, v1
    s_mul_i32 s66, s61, 14336
    s_mul_i32 s64, s50, 1792
    s_add_u32 s66, s66, s64
    s_add_u32 s66, s66, 9437184
    v_cmp_eq_u32 vcc, 3, v3
    v_mov_b32 v8, 2130706432
    s_nop 0
    v_cndmask_b32 v8, v1, v8, vcc
    v_lshlrev_b32 v128, 16, v216
    v_and_b32 v129, 0xffff0000, v216
    v_lshlrev_b32 v130, 16, v217
    v_and_b32 v131, 0xffff0000, v217
    v_lshlrev_b32 v132, 16, v218
    v_and_b32 v133, 0xffff0000, v218
    v_lshlrev_b32 v134, 16, v219
    v_and_b32 v135, 0xffff0000, v219
    v_lshlrev_b32 v136, 16, v220
    v_and_b32 v137, 0xffff0000, v220
    v_lshlrev_b32 v138, 16, v221
    v_and_b32 v139, 0xffff0000, v221
    v_lshlrev_b32 v140, 16, v222
    v_and_b32 v141, 0xffff0000, v222
    v_lshlrev_b32 v142, 16, v223
    v_and_b32 v143, 0xffff0000, v223
    buffer_load_dwordx4 v[16:19], v1, s[16:19], s74 offen sc1
    buffer_load_dwordx4 v[20:23], v144, s[16:19], s74 offen sc1
    buffer_load_dwordx4 v[24:27], v145, s[16:19], s74 offen sc1
    buffer_load_dwordx4 v[28:31], v146, s[16:19], s74 offen sc1
    buffer_load_dwordx4 v[32:35], v1, s[16:19], s75 offen sc1
    buffer_load_dwordx4 v[36:39], v144, s[16:19], s75 offen sc1
    buffer_load_dwordx4 v[40:43], v145, s[16:19], s75 offen sc1
    buffer_load_dwordx4 v[44:47], v146, s[16:19], s75 offen sc1
    ds_read_b128 v[80:83], v1
    ds_read_b128 v[84:87], v1 offset:1024
    ds_read_b128 v[88:91], v1 offset:2048
    ds_read_b128 v[92:95], v1 offset:3072
    ds_read_b128 v[96:99], v1 offset:4096
    ds_read_b128 v[100:103], v1 offset:5120
    s_waitcnt vmcnt(5)
    v_max3_u32 v10, v16, v20, v24
    s_waitcnt vmcnt(4)
    v_max_u32 v10, v10, v28
    v_cmp_eq_u32 vcc, -1, v10
    s_cbranch_vccnz .Lagain_14
.Lback_15:
    s_waitcnt lgkmcnt(5)
    v_mfma_f32_16x16x32_bf16 v[112:115], v[80:83], v[16:19], v[128:131]
    ds_read_b128 v[104:107], v1 offset:6144
    buffer_load_dwordx4 v[48:51], v1, s[16:19], s76 offen sc1
    s_waitcnt lgkmcnt(5)
    v_mfma_f32_16x16x32_bf16 v[116:119], v[84:87], v[16:19], v[132:135]
    ds_read_b128 v[108:111], v1 offset:7168
    s_waitcnt lgkmcnt(5)
    v_mfma_f32_16x16x32_bf16 v[120:123], v[88:91], v[16:19], v[136:139]
    ds_read_b128 v[80:83], v1 offset:8192
    s_waitcnt lgkmcnt(5)
    v_mfma_f32_16x16x32_bf16 v[124:127], v[92:95], v[16:19], v[140:143]
    ds_read_b128 v[84:87], v1 offset:9216
    s_waitcnt lgkmcnt(5)
    v_mfma_f32_16x16x32_bf16 v[112:115], v[96:99], v[20:23], v[112:115]
    ds_read_b128 v[88:91], v1 offset:10240
    buffer_load_dwordx4 v[52:55], v144, s[16:19], s76 offen sc1
    s_waitcnt lgkmcnt(5)
    v_mfma_f32_16x16x32_bf16 v[116:119], v[100:103], v[20:23], v[116:119]
    ds_read_b128 v[92:95], v1 offset:11264
    s_waitcnt lgkmcnt(5)
    v_mfma_f32_16x16x32_bf16 v[120:123], v[104:107], v[20:23], v[120:123]
    ds_read_b128 v[96:99], v1 offset:12288
    s_waitcnt lgkmcnt(5)
    v_mfma_f32_16x16x32_bf16 v[124:127], v[108:111], v[20:23], v[124:127]
    ds_read_b128 v[100:103], v1 offset:13312
    s_waitcnt lgkmcnt(5)
    v_mfma_f32_16x16x32_bf16 v[112:115], v[80:83], v[24:27], v[112:115]
    ds_read_b128 v[104:107], v1 offset:14336
    buffer_load_dwordx4 v[56:59], v145, s[16:19], s76 offen sc1
    s_waitcnt lgkmcnt(5)
    v_mfma_f32_16x16x32_bf16 v[116:119], v[84:87], v[24:27], v[116:119]
    ds_read_b128 v[108:111], v1 offset:15360
    s_waitcnt lgkmcnt(5)
    v_mfma_f32_16x16x32_bf16 v[120:123], v[88:91], v[24:27], v[120:123]
    ds_read_b128 v[80:83], v1 offset:16384
    s_waitcnt lgkmcnt(5)
    v_mfma_f32_16x16x32_bf16 v[124:127], v[92:95], v[24:27], v[124:127]
    ds_read_b128 v[84:87], v1 offset:17408
    s_waitcnt lgkmcnt(5)
    v_mfma_f32_16x16x32_bf16 v[112:115], v[96:99], v[28:31], v[112:115]
    ds_read_b128 v[88:91], v1 offset:18432
    buffer_load_dwordx4 v[60:63], v146, s[16:19], s76 offen sc1
    s_waitcnt lgkmcnt(5)
    v_mfma_f32_16x16x32_bf16 v[116:119], v[100:103], v[28:31], v[116:119]
    ds_read_b128 v[92:95], v1 offset:19456
    s_waitcnt vmcnt(5)
    v_max3_u32 v10, v32, v36, v40
    s_waitcnt lgkmcnt(5)
    v_mfma_f32_16x16x32_bf16 v[120:123], v[104:107], v[28:31], v[120:123]
    ds_read_b128 v[96:99], v1 offset:20480
    s_waitcnt vmcnt(4)
    v_max_u32 v10, v10, v44
    s_waitcnt lgkmcnt(5)
    v_mfma_f32_16x16x32_bf16 v[124:127], v[108:111], v[28:31], v[124:127]
    ds_read_b128 v[100:103], v1 offset:21504
    v_cmp_eq_u32 vcc, -1, v10
    s_cbranch_vccnz .Lagain_16
.Lback_17:
    s_waitcnt lgkmcnt(5)
    v_mfma_f32_16x16x32_bf16 v[112:115], v[80:83], v[32:35], v[112:115]
    ds_read_b128 v[104:107], v1 offset:22528
    buffer_load_dwordx4 v[64:67], v1, s[16:19], s77 offen sc1
    s_waitcnt lgkmcnt(5)
    v_mfma_f32_16x16x32_bf16 v[116:119], v[84:87], v[32:35], v[116:119]
    ds_read_b128 v[108:111], v1 offset:23552
    s_waitcnt lgkmcnt(5)
    v_mfma_f32_16x16x32_bf16 v[120:123], v[88:91], v[32:35], v[120:123]
    ds_read_b128 v[80:83], v1 offset:24576
    s_waitcnt lgkmcnt(5)
    v_mfma_f32_16x16x32_bf16 v[124:127], v[92:95], v[32:35], v[124:127]
    ds_read_b128 v[84:87], v1 offset:25600
    s_waitcnt lgkmcnt(5)
    v_mfma_f32_16x16x32_bf16 v[112:115], v[96:99], v[36:39], v[112:115]
    ds_read_b128 v[88:91], v1 offset:26624
    buffer_load_dwordx4 v[68:71], v144, s[16:19], s77 offen sc1
    s_waitcnt lgkmcnt(5)
    v_mfma_f32_16x16x32_bf16 v[116:119], v[100:103], v[36:39], v[116:119]
    ds_read_b128 v[92:95], v1 offset:27648
    s_waitcnt lgkmcnt(5)
    v_mfma_f32_16x16x32_bf16 v[120:123], v[104:107], v[36:39], v[120:123]
    ds_read_b128 v[96:99], v1 offset:28672
    s_waitcnt lgkmcnt(5)
    v_mfma_f32_16x16x32_bf16 v[124:127], v[108:111], v[36:39], v[124:127]
    ds_read_b128 v[100:103], v1 offset:29696
    s_waitcnt lgkmcnt(5)
    v_mfma_f32_16x16x32_bf16 v[112:115], v[80:83], v[40:43], v[112:115]
    ds_read_b128 v[104:107], v1 offset:30720
    buffer_load_dwordx4 v[72:75], v145, s[16:19], s77 offen sc1
    s_waitcnt lgkmcnt(5)
    v_mfma_f32_16x16x32_bf16 v[116:119], v[84:87], v[40:43], v[116:119]
    ds_read_b128 v[108:111], v1 offset:31744
    s_waitcnt lgkmcnt(5)
    v_mfma_f32_16x16x32_bf16 v[120:123], v[88:91], v[40:43], v[120:123]
    ds_read_b128 v[80:83], v1 offset:32768
    s_waitcnt lgkmcnt(5)
    v_mfma_f32_16x16x32_bf16 v[124:127], v[92:95], v[40:43], v[124:127]
    ds_read_b128 v[84:87], v1 offset:33792
    s_waitcnt lgkmcnt(5)
    v_mfma_f32_16x16x32_bf16 v[112:115], v[96:99], v[44:47], v[112:115]
    ds_read_b128 v[88:91], v1 offset:34816
    buffer_load_dwordx4 v[76:79], v146, s[16:19], s77 offen sc1
    s_waitcnt lgkmcnt(5)
    v_mfma_f32_16x16x32_bf16 v[116:119], v[100:103], v[44:47], v[116:119]
    ds_read_b128 v[92:95], v1 offset:35840
    s_waitcnt vmcnt(5)
    v_max3_u32 v10, v48, v52, v56
    s_waitcnt lgkmcnt(5)
    v_mfma_f32_16x16x32_bf16 v[120:123], v[104:107], v[44:47], v[120:123]
    ds_read_b128 v[96:99], v1 offset:36864
    s_waitcnt vmcnt(4)
    v_max_u32 v10, v10, v60
    s_waitcnt lgkmcnt(5)
    v_mfma_f32_16x16x32_bf16 v[124:127], v[108:111], v[44:47], v[124:127]
    ds_read_b128 v[100:103], v1 offset:37888
    v_cmp_eq_u32 vcc, -1, v10
    s_cbranch_vccnz .Lagain_18
.Lback_19:
    s_waitcnt lgkmcnt(5)
    v_mfma_f32_16x16x32_bf16 v[112:115], v[80:83], v[48:51], v[112:115]
    ds_read_b128 v[104:107], v1 offset:38912
    s_waitcnt lgkmcnt(5)
    v_mfma_f32_16x16x32_bf16 v[116:119], v[84:87], v[48:51], v[116:119]
    ds_read_b128 v[108:111], v1 offset:39936
    s_waitcnt lgkmcnt(5)
    v_mfma_f32_16x16x32_bf16 v[120:123], v[88:91], v[48:51], v[120:123]
    ds_read_b128 v[80:83], v1 offset:40960
    s_waitcnt lgkmcnt(5)
    v_mfma_f32_16x16x32_bf16 v[124:127], v[92:95], v[48:51], v[124:127]
    ds_read_b128 v[84:87], v1 offset:41984
    s_waitcnt lgkmcnt(5)
    v_mfma_f32_16x16x32_bf16 v[112:115], v[96:99], v[52:55], v[112:115]
    ds_read_b128 v[88:91], v1 offset:43008
    s_waitcnt lgkmcnt(5)
    v_mfma_f32_16x16x32_bf16 v[116:119], v[100:103], v[52:55], v[116:119]
    ds_read_b128 v[92:95], v1 offset:44032
    s_waitcnt lgkmcnt(5)
    v_mfma_f32_16x16x32_bf16 v[120:123], v[104:107], v[52:55], v[120:123]
    ds_read_b128 v[96:99], v1 offset:45056
    s_waitcnt lgkmcnt(5)
    v_mfma_f32_16x16x32_bf16 v[124:127], v[108:111], v[52:55], v[124:127]
    ds_read_b128 v[100:103], v1 offset:46080
    s_waitcnt lgkmcnt(5)
    v_mfma_f32_16x16x32_bf16 v[112:115], v[80:83], v[56:59], v[112:115]
    ds_read_b128 v[104:107], v1 offset:47104
    s_waitcnt lgkmcnt(5)
    v_mfma_f32_16x16x32_bf16 v[116:119], v[84:87], v[56:59], v[116:119]
    ds_read_b128 v[108:111], v1 offset:48128
    s_waitcnt lgkmcnt(5)
    v_mfma_f32_16x16x32_bf16 v[120:123], v[88:91], v[56:59], v[120:123]
    ds_read_b128 v[80:83], v1 offset:49152
    s_waitcnt lgkmcnt(5)
    v_mfma_f32_16x16x32_bf16 v[124:127], v[92:95], v[56:59], v[124:127]
    ds_read_b128 v[84:87], v1 offset:50176
    s_waitcnt lgkmcnt(5)
    v_mfma_f32_16x16x32_bf16 v[112:115], v[96:99], v[60:63], v[112:115]
    ds_read_b128 v[88:91], v1 offset:51200
    s_waitcnt lgkmcnt(5)
    v_mfma_f32_16x16x32_bf16 v[116:119], v[100:103], v[60:63], v[116:119]
    ds_read_b128 v[92:95], v1 offset:52224
    s_waitcnt vmcnt(1)
    v_max3_u32 v10, v64, v68, v72
    s_waitcnt lgkmcnt(5)
    v_mfma_f32_16x16x32_bf16 v[120:123], v[104:107], v[60:63], v[120:123]
    ds_read_b128 v[96:99], v1 offset:53248
    s_waitcnt vmcnt(0)
    v_max_u32 v10, v10, v76
    s_waitcnt lgkmcnt(5)
    v_mfma_f32_16x16x32_bf16 v[124:127], v[108:111], v[60:63], v[124:127]
    ds_read_b128 v[100:103], v1 offset:54272
    v_cmp_eq_u32 vcc, -1, v10
    s_cbranch_vccnz .Lagain_20
.Lback_21:
    s_waitcnt lgkmcnt(5)
    v_mfma_f32_16x16x32_bf16 v[112:115], v[80:83], v[64:67], v[112:115]
    ds_read_b128 v[104:107], v1 offset:55296
    s_waitcnt lgkmcnt(5)
    v_mfma_f32_16x16x32_bf16 v[116:119], v[84:87], v[64:67], v[116:119]
    ds_read_b128 v[108:111], v1 offset:56320
    s_waitcnt lgkmcnt(5)
    v_mfma_f32_16x16x32_bf16 v[120:123], v[88:91], v[64:67], v[120:123]
    ds_read_b128 v[80:83], v1 offset:57344
    s_waitcnt lgkmcnt(5)
    v_mfma_f32_16x16x32_bf16 v[124:127], v[92:95], v[64:67], v[124:127]
    ds_read_b128 v[84:87], v1 offset:58368
    s_waitcnt lgkmcnt(5)
    v_mfma_f32_16x16x32_bf16 v[112:115], v[96:99], v[68:71], v[112:115]
    ds_read_b128 v[88:91], v1 offset:59392
    s_waitcnt lgkmcnt(5)
    v_mfma_f32_16x16x32_bf16 v[116:119], v[100:103], v[68:71], v[116:119]
    ds_read_b128 v[92:95], v1 offset:60416
    s_waitcnt lgkmcnt(5)
    v_mfma_f32_16x16x32_bf16 v[120:123], v[104:107], v[68:71], v[120:123]
    ds_read_b128 v[96:99], v1 offset:61440
    s_waitcnt lgkmcnt(5)
    v_mfma_f32_16x16x32_bf16 v[124:127], v[108:111], v[68:71], v[124:127]
    ds_read_b128 v[100:103], v1 offset:62464
    s_waitcnt lgkmcnt(5)
    v_mfma_f32_16x16x32_bf16 v[112:115], v[80:83], v[72:75], v[112:115]
    ds_read_b128 v[104:107], v1 offset:63488
    s_waitcnt lgkmcnt(5)
    v_mfma_f32_16x16x32_bf16 v[116:119], v[84:87], v[72:75], v[116:119]
    ds_read_b128 v[108:111], v1 offset:64512
    s_waitcnt lgkmcnt(5)
    v_mfma_f32_16x16x32_bf16 v[120:123], v[88:91], v[72:75], v[120:123]
    s_waitcnt lgkmcnt(4)
    v_mfma_f32_16x16x32_bf16 v[124:127], v[92:95], v[72:75], v[124:127]
    s_waitcnt lgkmcnt(3)
    v_mfma_f32_16x16x32_bf16 v[112:115], v[96:99], v[76:79], v[112:115]
    s_waitcnt lgkmcnt(2)
    v_mfma_f32_16x16x32_bf16 v[116:119], v[100:103], v[76:79], v[116:119]
    s_waitcnt lgkmcnt(1)
    v_mfma_f32_16x16x32_bf16 v[120:123], v[104:107], v[76:79], v[120:123]
    s_waitcnt lgkmcnt(0)
    v_mfma_f32_16x16x32_bf16 v[124:127], v[108:111], v[76:79], v[124:127]
    s_nop 1
    v_cvt_pk_bf16_f32 v216, v112, v113
    v_min_u32 v216, -2, v216
    v_cvt_pk_bf16_f32 v217, v114, v115
    v_cvt_pk_bf16_f32 v218, v116, v117
    v_cvt_pk_bf16_f32 v219, v118, v119
    buffer_store_dwordx4 v[216:219], v1, s[16:19], s66 offen sc1
    v_cvt_pk_bf16_f32 v220, v120, v121
    v_min_u32 v220, -2, v220
    v_cvt_pk_bf16_f32 v221, v122, v123
    v_cvt_pk_bf16_f32 v222, v124, v125
    v_cvt_pk_bf16_f32 v223, v126, v127
    buffer_store_dwordx4 v[220:223], v8, s[16:19], s66 offen offset:1024 sc1
    s_mul_i32 s63, s50, 215040
    s_add_u32 s67, s48, 3
    s_and_b32 s67, s67, 3
    s_mul_i32 s67, s67, 12288
    s_add_u32 s67, s67, 0
    s_add_u32 s79, s63, s67
    s_add_u32 m0, s67, 108544
    s_add_u32 s79, s79, 21014528
    buffer_load_dwordx4 v1, s[16:19], s79 offen sc1 lds
    buffer_load_dwordx4 v1, s[16:19], s79 offen offset:1024 sc1 lds
    buffer_load_dwordx4 v1, s[16:19], s79 offen offset:2048 sc1 lds
    buffer_load_dwordx4 v1, s[16:19], s79 offen offset:3072 sc1 lds
    s_add_u32 s67, s48, 2
    s_and_b32 s67, s67, 3
    s_mul_i32 s67, s67, 12288
    s_add_u32 s67, s67, 4096
    s_add_u32 s79, s63, s67
    s_add_u32 m0, s67, 108544
    s_add_u32 s79, s79, 21014528
    buffer_load_dwordx4 v1, s[16:19], s79 offen sc1 lds
    buffer_load_dwordx4 v1, s[16:19], s79 offen offset:1024 sc1 lds
    buffer_load_dwordx4 v1, s[16:19], s79 offen offset:2048 sc1 lds
    buffer_load_dwordx4 v1, s[16:19], s79 offen offset:3072 sc1 lds
    s_add_u32 s67, s48, 1
    s_and_b32 s67, s67, 3
    s_mul_i32 s67, s67, 12288
    s_add_u32 s67, s67, 8192
    s_add_u32 s79, s63, s67
    s_add_u32 m0, s67, 108544
    s_add_u32 s79, s79, 21014528
    buffer_load_dwordx4 v1, s[16:19], s79 offen sc1 lds
    buffer_load_dwordx4 v1, s[16:19], s79 offen offset:1024 sc1 lds
    buffer_load_dwordx4 v1, s[16:19], s79 offen offset:2048 sc1 lds
    buffer_load_dwordx4 v1, s[16:19], s79 offen offset:3072 sc1 lds
    s_mov_b32 s67, 49152
    s_add_u32 s79, s63, s67
    s_add_u32 m0, s67, 108544
    s_add_u32 s79, s79, 21014528
    buffer_load_dwordx4 v1, s[16:19], s79 offen sc1 lds
    s_barrier
    s_mul_i32 s62, s61, 14336
    s_add_u32 s62, s62, 9437184
    s_add_u32 s74, s62, 0
    s_add_u32 s75, s62, 4096
    s_add_u32 s76, s62, 8192
    s_add_u32 s77, s62, 12288
    v_mov_b32 v172, 0x3f803f80
    v_mov_b32 v173, 0x3f803f80
    v_mov_b32 v174, 0x3f803f80
    v_mov_b32 v175, 0x3f803f80
    v_mov_b32 v168, 0xbdd2d3e8
    v_mov_b32 v169, 0xbdd2d3e8
    v_mov_b32 v170, 0xc0135761
    v_mov_b32 v171, 0xc0135761
    v_mov_b32 v74, 0
    v_mov_b32 v75, 0
    v_lshlrev_b32 v14, 4, v3
    v_and_b32 v6, 1, v2
    v_cmp_ne_u32 s[68:69], 0, v6
    v_and_b32 v6, 2, v2
    v_cmp_ne_u32 s[70:71], 0, v6
    v_lshrrev_b32 v6, 2, v2
    v_lshl_add_u32 v6, v6, 4, v2
    v_lshlrev_b32 v8, 2, v6
    v_lshlrev_b32 v9, 5, v3
    v_lshl_add_u32 v7, v2, 4, v9
    v_and_b32 v10, 7, v2
    v_lshl_add_u32 v9, v10, 7, v9
    v_lshrrev_b32 v10, 3, v2
    v_lshl_add_u32 v9, v10, 4, v9
    s_lshl_b32 s88, s61, 10
    s_add_u32 s88, s88, 131072
    s_lshl_b32 s89, s50, 7
    s_add_u32 s89, s89, s88
    s_lshl_b32 s90, s50, 6
    s_lshr_b32 s65, s61, 1
    s_add_u32 s90, s90, s65
    s_mul_i32 s90, s90, 7168
    s_and_b32 s65, s48, 1
    s_lshl_b32 s65, s65, 9
    s_add_u32 s90, s90, s65
    s_add_u32 s90, s90, 11534336
    s_add_u32 s91, s90, 4096
    v_and_b32 v10, 1, v3
    v_cmp_ne_u32 vcc, 0, v10
    v_lshlrev_b32 v12, 10, v10
    v_lshrrev_b32 v10, 1, v3
    v_lshl_add_u32 v12, v10, 8, v12
    v_lshl_add_u32 v12, v2, 4, v12
    v_mov_b32 v15, 2130706432
    v_cndmask_b32 v15, v12, v15, vcc
    s_mul_i32 s93, s61, 28672
    s_mul_i32 s65, s50, 3584
    s_add_u32 s93, s93, s65
    s_add_u32 s93, s93, 15728640
    v_lshlrev_b32 v211, 8, v10
    v_lshl_add_u32 v211, v2, 4, v211
    v_mov_b32 v10, 2130706432
    v_cndmask_b32 v211, v211, v10, vcc
    v_mov_b32 v204, -1
    v_mov_b32 v205, -1
    v_mov_b32 v206, -1
    v_mov_b32 v207, -1
    s_lshl_b32 s62, s50, 2
    s_lshr_b32 s65, s49, 3
    s_add_u32 s65, s65, s62
    s_lshl_b32 s65, s65, 9
    s_add_u32 s65, s65, 110592
    v_lshlrev_b32 v208, 7, v0
    v_add_u32 v208, s65, v208
    s_add_u32 s62, s62, s48
    s_lshl_b32 s65, s62, 2
    s_add_u32 s65, s65, s57
    s_lshl_b32 s65, s65, 7
    s_add_u32 s65, s65, 110592
    v_mov_b32 v209, s65
    s_mul_i32 s92, s62, 114688
    s_add_u32 s92, s92, 11534336
    s_mul_i32 s64, s50, 114688
    s_add_u32 s64, s64, 23068672
    buffer_load_dwordx4 v[16:19], v1, s[16:19], s74 offen sc1
    buffer_load_dwordx4 v[20:23], v1, s[16:19], s74 offen offset:1024 sc1
    buffer_load_dwordx4 v[24:27], v1, s[16:19], s74 offen offset:2048 sc1
    buffer_load_dwordx4 v[28:31], v1, s[16:19], s74 offen offset:3072 sc1
    buffer_load_dwordx4 v[32:35], v1, s[16:19], s75 offen sc1
    buffer_load_dwordx4 v[36:39], v1, s[16:19], s75 offen offset:1024 sc1
    buffer_load_dwordx4 v[40:43], v1, s[16:19], s75 offen offset:2048 sc1
    buffer_load_dwordx4 v[44:47], v1, s[16:19], s75 offen offset:3072 sc1
    ds_read_b128 v[80:83], v4
    ds_read_b128 v[84:87], v4 offset:1024
    ds_read_b128 v[88:91], v4 offset:2048
    ds_read_b128 v[92:95], v4 offset:3072
    ds_read_b128 v[96:99], v4 offset:4096
    ds_read_b128 v[100:103], v4 offset:5120
    s_waitcnt vmcnt(5)
    v_max3_u32 v210, v16, v20, v24
    s_waitcnt vmcnt(4)
    v_max_u32 v210, v210, v28
    v_cmp_eq_u32 vcc, -1, v210
    s_cbranch_vccnz .Lagain_22
.Lback_23:
    v_mfma_f32_16x16x32_bf16 v[192:195], v[172:175], v[16:19], 0
    v_mfma_f32_16x16x32_bf16 v[196:199], v[16:19], v[16:19], 0
    v_mfma_f32_16x16x32_bf16 v[192:195], v[172:175], v[20:23], v[192:195]
    v_mfma_f32_16x16x32_bf16 v[196:199], v[20:23], v[20:23], v[196:199]
    s_waitcnt lgkmcnt(5)
    v_mfma_f32_16x16x32_bf16 v[112:115], v[16:19], v[80:83], 0
    ds_read_b128 v[104:107], v4 offset:6144
    buffer_load_dwordx4 v[48:51], v1, s[16:19], s76 offen sc1
    s_waitcnt lgkmcnt(5)
    v_mfma_f32_16x16x32_bf16 v[116:119], v[16:19], v[84:87], 0
    ds_read_b128 v[108:111], v4 offset:7168
    s_waitcnt lgkmcnt(5)
    v_mfma_f32_16x16x32_bf16 v[120:123], v[16:19], v[88:91], 0
    ds_read_b128 v[80:83], v4 offset:8192
    s_waitcnt lgkmcnt(5)
    v_mfma_f32_16x16x32_bf16 v[124:127], v[16:19], v[92:95], 0
    ds_read_b128 v[84:87], v4 offset:9216
    buffer_load_dwordx4 v[52:55], v1, s[16:19], s76 offen offset:1024 sc1
    s_waitcnt lgkmcnt(5)
    v_mfma_f32_16x16x32_bf16 v[128:131], v[16:19], v[96:99], 0
    ds_read_b128 v[88:91], v4 offset:10240
    s_waitcnt lgkmcnt(5)
    v_mfma_f32_16x16x32_bf16 v[132:135], v[16:19], v[100:103], 0
    ds_read_b128 v[92:95], v4 offset:11264
    s_waitcnt lgkmcnt(5)
    v_mfma_f32_16x16x32_bf16 v[136:139], v[16:19], v[104:107], 0
    ds_read_b128 v[96:99], v4 offset:12288
    buffer_load_dwordx4 v[56:59], v1, s[16:19], s76 offen offset:2048 sc1
    v_mfma_f32_16x16x32_bf16 v[192:195], v[172:175], v[24:27], v[192:195]
    v_mfma_f32_16x16x32_bf16 v[196:199], v[24:27], v[24:27], v[196:199]
    v_mfma_f32_16x16x32_bf16 v[192:195], v[172:175], v[28:31], v[192:195]
    v_mfma_f32_16x16x32_bf16 v[196:199], v[28:31], v[28:31], v[196:199]
    s_waitcnt lgkmcnt(5)
    v_mfma_f32_16x16x32_bf16 v[112:115], v[20:23], v[108:111], v[112:115]
    ds_read_b128 v[100:103], v4 offset:13312
    s_waitcnt lgkmcnt(5)
    v_mfma_f32_16x16x32_bf16 v[116:119], v[20:23], v[80:83], v[116:119]
    ds_read_b128 v[104:107], v4 offset:14336
    s_waitcnt lgkmcnt(5)
    v_mfma_f32_16x16x32_bf16 v[120:123], v[20:23], v[84:87], v[120:123]
    ds_read_b128 v[108:111], v4 offset:15360
    buffer_load_dwordx4 v[60:63], v1, s[16:19], s76 offen offset:3072 sc1
    s_waitcnt lgkmcnt(5)
    v_mfma_f32_16x16x32_bf16 v[124:127], v[20:23], v[88:91], v[124:127]
    ds_read_b128 v[80:83], v4 offset:16384
    s_waitcnt lgkmcnt(5)
    v_mfma_f32_16x16x32_bf16 v[128:131], v[20:23], v[92:95], v[128:131]
    ds_read_b128 v[84:87], v4 offset:17408
    s_waitcnt vmcnt(5)
    v_max3_u32 v210, v32, v36, v40
    s_waitcnt lgkmcnt(5)
    v_mfma_f32_16x16x32_bf16 v[132:135], v[20:23], v[96:99], v[132:135]
    ds_read_b128 v[88:91], v4 offset:18432
    buffer_load_dwordx4 v[64:67], v1, s[16:19], s77 offen sc1
    s_waitcnt vmcnt(5)
    v_max_u32 v210, v210, v44
    s_waitcnt lgkmcnt(5)
    v_mfma_f32_16x16x32_bf16 v[136:139], v[20:23], v[100:103], v[136:139]
    ds_read_b128 v[92:95], v4 offset:19456
    v_cmp_eq_u32 vcc, -1, v210
    s_cbranch_vccnz .Lagain_24
.Lback_25:
    v_mfma_f32_16x16x32_bf16 v[192:195], v[172:175], v[32:35], v[192:195]
    v_mfma_f32_16x16x32_bf16 v[196:199], v[32:35], v[32:35], v[196:199]
    v_mfma_f32_16x16x32_bf16 v[192:195], v[172:175], v[36:39], v[192:195]
    v_mfma_f32_16x16x32_bf16 v[196:199], v[36:39], v[36:39], v[196:199]
    s_waitcnt lgkmcnt(5)
    v_mfma_f32_16x16x32_bf16 v[112:115], v[24:27], v[104:107], v[112:115]
    ds_read_b128 v[96:99], v4 offset:20480
    s_waitcnt lgkmcnt(5)
    v_mfma_f32_16x16x32_bf16 v[116:119], v[24:27], v[108:111], v[116:119]
    ds_read_b128 v[100:103], v4 offset:21504
    buffer_load_dwordx4 v[68:71], v1, s[16:19], s77 offen offset:1024 sc1
    s_waitcnt lgkmcnt(5)
    v_mfma_f32_16x16x32_bf16 v[120:123], v[24:27], v[80:83], v[120:123]
    ds_read_b128 v[104:107], v4 offset:22528
    s_waitcnt lgkmcnt(5)
    v_mfma_f32_16x16x32_bf16 v[124:127], v[24:27], v[84:87], v[124:127]
    ds_read_b128 v[108:111], v4 offset:23552
    s_waitcnt lgkmcnt(5)
    v_mfma_f32_16x16x32_bf16 v[128:131], v[24:27], v[88:91], v[128:131]
    ds_read_b128 v[80:83], v4 offset:24576
    s_waitcnt lgkmcnt(5)
    v_mfma_f32_16x16x32_bf16 v[132:135], v[24:27], v[92:95], v[132:135]
    ds_read_b128 v[84:87], v4 offset:25600
    s_waitcnt lgkmcnt(5)
    v_mfma_f32_16x16x32_bf16 v[136:139], v[24:27], v[96:99], v[136:139]
    ds_read_b128 v[88:91], v4 offset:26624
    s_mul_i32 s67, s48, 16384
    s_min_u32 s67, s67, 48128
    s_add_u32 s79, s63, s67
    s_add_u32 s80, s67, 0
    s_add_u32 s79, s79, 21064704
    v_mfma_f32_16x16x32_bf16 v[192:195], v[172:175], v[40:43], v[192:195]
    v_mfma_f32_16x16x32_bf16 v[196:199], v[40:43], v[40:43], v[196:199]
    v_mfma_f32_16x16x32_bf16 v[192:195], v[172:175], v[44:47], v[192:195]
    v_mfma_f32_16x16x32_bf16 v[196:199], v[44:47], v[44:47], v[196:199]
    s_waitcnt lgkmcnt(5)
    v_mfma_f32_16x16x32_bf16 v[112:115], v[28:31], v[100:103], v[112:115]
    ds_read_b128 v[92:95], v4 offset:27648
    s_waitcnt lgkmcnt(5)
    v_mfma_f32_16x16x32_bf16 v[116:119], v[28:31], v[104:107], v[116:119]
    ds_read_b128 v[96:99], v4 offset:28672
    s_mov_b32 m0, s80
    s_waitcnt lgkmcnt(5)
    v_mfma_f32_16x16x32_bf16 v[120:123], v[28:31], v[108:111], v[120:123]
    ds_read_b128 v[100:103], v4 offset:29696
    s_waitcnt lgkmcnt(5)
    v_mfma_f32_16x16x32_bf16 v[124:127], v[28:31], v[80:83], v[124:127]
    ds_read_b128 v[104:107], v4 offset:30720
    buffer_load_dwordx4 v1, s[16:19], s79 offen sc1 lds
    s_waitcnt lgkmcnt(5)
    v_mfma_f32_16x16x32_bf16 v[128:131], v[28:31], v[84:87], v[128:131]
    ds_read_b128 v[108:111], v4 offset:31744
    s_waitcnt vmcnt(4)
    v_max3_u32 v210, v48, v52, v56
    s_waitcnt lgkmcnt(5)
    v_mfma_f32_16x16x32_bf16 v[132:135], v[28:31], v[88:91], v[132:135]
    ds_read_b128 v[80:83], v4 offset:32768
    buffer_load_dwordx4 v1, s[16:19], s79 offen offset:1024 sc1 lds
    s_waitcnt vmcnt(4)
    v_max_u32 v210, v210, v60
    s_waitcnt lgkmcnt(5)
    v_mfma_f32_16x16x32_bf16 v[136:139], v[28:31], v[92:95], v[136:139]
    ds_read_b128 v[84:87], v4 offset:33792
    v_cmp_eq_u32 vcc, -1, v210
    s_cbranch_vccnz .Lagain_26
.Lback_27:
    v_mfma_f32_16x16x32_bf16 v[192:195], v[172:175], v[48:51], v[192:195]
    v_mfma_f32_16x16x32_bf16 v[196:199], v[48:51], v[48:51], v[196:199]
    v_mfma_f32_16x16x32_bf16 v[192:195], v[172:175], v[52:55], v[192:195]
    v_mfma_f32_16x16x32_bf16 v[196:199], v[52:55], v[52:55], v[196:199]
    s_waitcnt lgkmcnt(5)
    v_mfma_f32_16x16x32_bf16 v[112:115], v[32:35], v[96:99], v[112:115]
    ds_read_b128 v[88:91], v4 offset:34816
    buffer_load_dwordx4 v1, s[16:19], s79 offen offset:2048 sc1 lds
    s_waitcnt lgkmcnt(5)
    v_mfma_f32_16x16x32_bf16 v[116:119], v[32:35], v[100:103], v[116:119]
    ds_read_b128 v[92:95], v4 offset:35840
    s_waitcnt lgkmcnt(5)
    v_mfma_f32_16x16x32_bf16 v[120:123], v[32:35], v[104:107], v[120:123]
    ds_read_b128 v[96:99], v4 offset:36864
    buffer_load_dwordx4 v1, s[16:19], s79 offen offset:3072 sc1 lds
    s_waitcnt lgkmcnt(5)
    v_mfma_f32_16x16x32_bf16 v[124:127], v[32:35], v[108:111], v[124:127]
    ds_read_b128 v[100:103], v4 offset:37888
    s_waitcnt lgkmcnt(5)
    v_mfma_f32_16x16x32_bf16 v[128:131], v[32:35], v[80:83], v[128:131]
    ds_read_b128 v[104:107], v4 offset:38912
    s_add_u32 s79, s79, 4096
    s_add_u32 s80, s80, 4096
    s_mov_b32 m0, s80
    s_waitcnt lgkmcnt(5)
    v_mfma_f32_16x16x32_bf16 v[132:135], v[32:35], v[84:87], v[132:135]
    ds_read_b128 v[108:111], v4 offset:39936
    s_waitcnt lgkmcnt(5)
    v_mfma_f32_16x16x32_bf16 v[136:139], v[32:35], v[88:91], v[136:139]
    ds_read_b128 v[80:83], v4 offset:40960
    buffer_load_dwordx4 v1, s[16:19], s79 offen sc1 lds
    v_mfma_f32_16x16x32_bf16 v[192:195], v[172:175], v[56:59], v[192:195]
    v_mfma_f32_16x16x32_bf16 v[196:199], v[56:59], v[56:59], v[196:199]
    v_mfma_f32_16x16x32_bf16 v[192:195], v[172:175], v[60:63], v[192:195]
    v_mfma_f32_16x16x32_bf16 v[196:199], v[60:63], v[60:63], v[196:199]
    s_waitcnt lgkmcnt(5)
    v_mfma_f32_16x16x32_bf16 v[112:115], v[36:39], v[92:95], v[112:115]
    ds_read_b128 v[84:87], v4 offset:41984
    s_waitcnt lgkmcnt(5)
    v_mfma_f32_16x16x32_bf16 v[116:119], v[36:39], v[96:99], v[116:119]
    s_barrier
    ds_read_b128 v[88:91], v4 offset:43008
    buffer_load_dwordx4 v1, s[16:19], s79 offen offset:1024 sc1 lds
    s_waitcnt lgkmcnt(5)
    v_mfma_f32_16x16x32_bf16 v[120:123], v[36:39], v[100:103], v[120:123]
    ds_read_b128 v[92:95], v4 offset:44032
    s_waitcnt lgkmcnt(5)
    v_mfma_f32_16x16x32_bf16 v[124:127], v[36:39], v[104:107], v[124:127]
    ds_read_b128 v[96:99], v4 offset:45056
    buffer_load_dwordx4 v1, s[16:19], s79 offen offset:2048 sc1 lds
    s_waitcnt lgkmcnt(5)
    v_mfma_f32_16x16x32_bf16 v[128:131], v[36:39], v[108:111], v[128:131]
    ds_read_b128 v[100:103], v4 offset:46080
    s_waitcnt vmcnt(5)
    v_max_u32 v210, v64, v68
    s_waitcnt lgkmcnt(5)
    v_mfma_f32_16x16x32_bf16 v[132:135], v[36:39], v[80:83], v[132:135]
    ds_read_b128 v[104:107], v4 offset:47104
    buffer_load_dwordx4 v1, s[16:19], s79 offen offset:3072 sc1 lds
    v_cmp_eq_u32 vcc, -1, v210
    s_waitcnt lgkmcnt(5)
    v_mfma_f32_16x16x32_bf16 v[136:139], v[36:39], v[84:87], v[136:139]
    ds_read_b128 v[108:111], v4 offset:48128
    s_cbranch_vccnz .Lagain_28
.Lback_29:
    v_mfma_f32_16x16x32_bf16 v[192:195], v[172:175], v[64:67], v[192:195]
    v_mfma_f32_16x16x32_bf16 v[196:199], v[64:67], v[64:67], v[196:199]
    v_mfma_f32_16x16x32_bf16 v[192:195], v[172:175], v[68:71], v[192:195]
    v_mfma_f32_16x16x32_bf16 v[196:199], v[68:71], v[68:71], v[196:199]
    s_waitcnt lgkmcnt(5)
    v_mfma_f32_16x16x32_bf16 v[112:115], v[40:43], v[88:91], v[112:115]
    ds_read_b128 v[80:83], v4 offset:49152
    s_add_u32 s79, s79, 4096
    s_add_u32 s80, s80, 4096
    s_mov_b32 m0, s80
    s_waitcnt lgkmcnt(5)
    v_mfma_f32_16x16x32_bf16 v[116:119], v[40:43], v[92:95], v[116:119]
    ds_read_b128 v[84:87], v4 offset:50176
    s_waitcnt lgkmcnt(5)
    v_mfma_f32_16x16x32_bf16 v[120:123], v[40:43], v[96:99], v[120:123]
    ds_read_b128 v[88:91], v4 offset:51200
    buffer_load_dwordx4 v1, s[16:19], s79 offen sc1 lds
    s_waitcnt lgkmcnt(5)
    v_mfma_f32_16x16x32_bf16 v[124:127], v[40:43], v[100:103], v[124:127]
    ds_read_b128 v[92:95], v4 offset:52224
    s_waitcnt lgkmcnt(5)
    v_mfma_f32_16x16x32_bf16 v[128:131], v[40:43], v[104:107], v[128:131]
    ds_read_b128 v[96:99], v4 offset:53248
    buffer_load_dwordx4 v1, s[16:19], s79 offen offset:1024 sc1 lds
    s_waitcnt lgkmcnt(5)
    v_mfma_f32_16x16x32_bf16 v[132:135], v[40:43], v[108:111], v[132:135]
    ds_read_b128 v[100:103], v4 offset:54272
    s_waitcnt lgkmcnt(5)
    v_mfma_f32_16x16x32_bf16 v[136:139], v[40:43], v[80:83], v[136:139]
    ds_read_b128 v[104:107], v4 offset:55296
    buffer_load_dwordx4 v1, s[16:19], s79 offen offset:2048 sc1 lds
    s_waitcnt lgkmcnt(5)
    v_mfma_f32_16x16x32_bf16 v[112:115], v[44:47], v[84:87], v[112:115]
    ds_read_b128 v[108:111], v4 offset:56320
    s_waitcnt lgkmcnt(5)
    v_mfma_f32_16x16x32_bf16 v[116:119], v[44:47], v[88:91], v[116:119]
    ds_read_b128 v[80:83], v4 offset:57344
    buffer_load_dwordx4 v1, s[16:19], s79 offen offset:3072 sc1 lds
    s_waitcnt lgkmcnt(5)
    v_mfma_f32_16x16x32_bf16 v[120:123], v[44:47], v[92:95], v[120:123]
    ds_read_b128 v[84:87], v4 offset:58368
    s_waitcnt lgkmcnt(5)
    v_mfma_f32_16x16x32_bf16 v[124:127], v[44:47], v[96:99], v[124:127]
    ds_read_b128 v[88:91], v4 offset:59392
    s_add_u32 s79, s79, 4096
    s_add_u32 s80, s80, 4096
    s_mov_b32 m0, s80
    s_waitcnt lgkmcnt(5)
    v_mfma_f32_16x16x32_bf16 v[128:131], v[44:47], v[100:103], v[128:131]
    ds_read_b128 v[92:95], v4 offset:60416
    v_cndmask_b32 v10, v196, v197, s[68:69]
    s_waitcnt lgkmcnt(5)
    v_mfma_f32_16x16x32_bf16 v[132:135], v[44:47], v[104:107], v[132:135]
    ds_read_b128 v[96:99], v4 offset:61440
    buffer_load_dwordx4 v1, s[16:19], s79 offen sc1 lds
    s_waitcnt lgkmcnt(5)
    v_mfma_f32_16x16x32_bf16 v[136:139], v[44:47], v[108:111], v[136:139]
    ds_read_b128 v[100:103], v4 offset:62464
    v_cndmask_b32 v11, v198, v199, s[68:69]
    s_waitcnt lgkmcnt(5)
    v_mfma_f32_16x16x32_bf16 v[112:115], v[48:51], v[80:83], v[112:115]
    ds_read_b128 v[104:107], v4 offset:63488
    buffer_load_dwordx4 v1, s[16:19], s79 offen offset:1024 sc1 lds
    s_waitcnt lgkmcnt(5)
    v_mfma_f32_16x16x32_bf16 v[116:119], v[48:51], v[84:87], v[116:119]
    ds_read_b128 v[108:111], v4 offset:64512
    v_cndmask_b32 v10, v10, v11, s[70:71]
    s_waitcnt lgkmcnt(5)
    v_mfma_f32_16x16x32_bf16 v[120:123], v[48:51], v[88:91], v[120:123]
    ds_read_b128 v[80:83], v5
    buffer_load_dwordx4 v1, s[16:19], s79 offen offset:2048 sc1 lds
    s_waitcnt lgkmcnt(5)
    v_mfma_f32_16x16x32_bf16 v[124:127], v[48:51], v[92:95], v[124:127]
    ds_read_b128 v[84:87], v5 offset:1024
    ds_bpermute_b32 v10, v8, v10
    s_waitcnt lgkmcnt(6)
    v_mfma_f32_16x16x32_bf16 v[128:131], v[48:51], v[96:99], v[128:131]
    ds_read_b128 v[88:91], v5 offset:2048
    buffer_load_dwordx4 v1, s[16:19], s79 offen offset:3072 sc1 lds
    s_waitcnt lgkmcnt(6)
    v_mfma_f32_16x16x32_bf16 v[132:135], v[48:51], v[100:103], v[132:135]
    ds_read_b128 v[92:95], v5 offset:3072
    v_mul_f32 v177, 0xbb124925, v192
    s_waitcnt lgkmcnt(6)
    v_mfma_f32_16x16x32_bf16 v[136:139], v[48:51], v[104:107], v[136:139]
    ds_read_b128 v[96:99], v5 offset:4096
    buffer_store_dwordx4 v[204:207], v1, s[16:19], s93 offen sc1
    s_waitcnt lgkmcnt(6)
    v_mfma_f32_16x16x32_bf16 v[112:115], v[52:55], v[108:111], v[112:115]
    ds_read_b128 v[100:103], v5 offset:5120
    v_mul_f32 v11, v177, v177
    s_waitcnt lgkmcnt(6)
    v_mfma_f32_16x16x32_bf16 v[116:119], v[52:55], v[80:83], v[116:119]
    ds_read_b128 v[104:107], v5 offset:6144
    buffer_store_dwordx4 v[204:207], v1, s[16:19], s93 offen offset:1024 sc1
    s_waitcnt lgkmcnt(6)
    v_mfma_f32_16x16x32_bf16 v[120:123], v[52:55], v[84:87], v[120:123]
    ds_read_b128 v[108:111], v5 offset:7168
    v_sub_f32 v11, 0x3727c5ac, v11
    s_waitcnt lgkmcnt(5)
    v_mfma_f32_16x16x32_bf16 v[124:127], v[52:55], v[88:91], v[124:127]
    ds_read_b128 v[80:83], v5 offset:8192
    buffer_store_dwordx4 v[204:207], v1, s[16:19], s93 offen offset:2048 sc1
    s_waitcnt lgkmcnt(5)
    v_mfma_f32_16x16x32_bf16 v[128:131], v[52:55], v[92:95], v[128:131]
    ds_read_b128 v[84:87], v5 offset:9216
    v_fmac_f32 v11, 0x3b124925, v10
    s_waitcnt lgkmcnt(5)
    v_mfma_f32_16x16x32_bf16 v[132:135], v[52:55], v[96:99], v[132:135]
    ds_read_b128 v[88:91], v5 offset:10240
    buffer_store_dwordx4 v[204:207], v211, s[16:19], s93 offen offset:3072 sc1
    s_waitcnt lgkmcnt(5)
    v_mfma_f32_16x16x32_bf16 v[136:139], v[52:55], v[100:103], v[136:139]
    ds_read_b128 v[92:95], v5 offset:11264
    v_max_f32 v11, 0x3727c5ac, v11
    s_waitcnt lgkmcnt(5)
    v_mfma_f32_16x16x32_bf16 v[112:115], v[56:59], v[104:107], v[112:115]
    ds_read_b128 v[96:99], v5 offset:12288
    s_waitcnt lgkmcnt(5)
    v_mfma_f32_16x16x32_bf16 v[116:119], v[56:59], v[108:111], v[116:119]
    ds_read_b128 v[100:103], v5 offset:13312
    v_rsq_f32 v176, v11
    s_waitcnt lgkmcnt(5)
    v_mfma_f32_16x16x32_bf16 v[120:123], v[56:59], v[80:83], v[120:123]
    ds_read_b128 v[104:107], v5 offset:14336
    s_waitcnt lgkmcnt(5)
    v_mfma_f32_16x16x32_bf16 v[124:127], v[56:59], v[84:87], v[124:127]
    ds_read_b128 v[108:111], v5 offset:15360
    v_cvt_pk_bf16_f32 v72, v177, v177
    s_waitcnt lgkmcnt(5)
    v_mfma_f32_16x16x32_bf16 v[128:131], v[56:59], v[88:91], v[128:131]
    ds_read_b128 v[80:83], v5 offset:16384
    s_waitcnt lgkmcnt(5)
    v_mfma_f32_16x16x32_bf16 v[132:135], v[56:59], v[92:95], v[132:135]
    ds_read_b128 v[84:87], v5 offset:17408
    v_and_b32 v10, 0xffff0000, v72
    s_waitcnt lgkmcnt(5)
    v_mfma_f32_16x16x32_bf16 v[136:139], v[56:59], v[96:99], v[136:139]
    ds_read_b128 v[88:91], v5 offset:18432
    s_waitcnt lgkmcnt(5)
    v_mfma_f32_16x16x32_bf16 v[112:115], v[60:63], v[100:103], v[112:115]
    ds_read_b128 v[92:95], v5 offset:19456
    v_sub_f32 v10, v177, v10
    s_waitcnt lgkmcnt(5)
    v_mfma_f32_16x16x32_bf16 v[116:119], v[60:63], v[104:107], v[116:119]
    ds_read_b128 v[96:99], v5 offset:20480
    s_waitcnt lgkmcnt(5)
    v_mfma_f32_16x16x32_bf16 v[120:123], v[60:63], v[108:111], v[120:123]
    ds_read_b128 v[100:103], v5 offset:21504
    v_cvt_pk_bf16_f32 v72, v177, v10
    s_waitcnt lgkmcnt(5)
    v_mfma_f32_16x16x32_bf16 v[124:127], v[60:63], v[80:83], v[124:127]
    ds_read_b128 v[104:107], v5 offset:22528
    s_waitcnt lgkmcnt(5)
    v_mfma_f32_16x16x32_bf16 v[128:131], v[60:63], v[84:87], v[128:131]
    ds_read_b128 v[108:111], v5 offset:23552
    v_mov_b32 v73, v72
    s_waitcnt lgkmcnt(5)
    v_mfma_f32_16x16x32_bf16 v[132:135], v[60:63], v[88:91], v[132:135]
    ds_read_b128 v[80:83], v5 offset:24576
    s_waitcnt lgkmcnt(5)
    v_mfma_f32_16x16x32_bf16 v[136:139], v[60:63], v[92:95], v[136:139]
    ds_read_b128 v[84:87], v5 offset:25600
    ds_bpermute_b32 v200, v14, v176
    s_waitcnt lgkmcnt(6)
    v_mfma_f32_16x16x32_bf16 v[112:115], v[64:67], v[96:99], v[112:115]
    ds_read_b128 v[88:91], v5 offset:26624
    s_waitcnt lgkmcnt(6)
    v_mfma_f32_16x16x32_bf16 v[116:119], v[64:67], v[100:103], v[116:119]
    s_waitcnt vmcnt(4)
    s_barrier
    ds_read_b128 v[92:95], v1
    ds_bpermute_b32 v201, v14, v176 offset:4
    s_waitcnt lgkmcnt(7)
    v_mfma_f32_16x16x32_bf16 v[120:123], v[64:67], v[104:107], v[120:123]
    ds_read_b128 v[96:99], v1 offset:1024
    s_waitcnt lgkmcnt(7)
    v_mfma_f32_16x16x32_bf16 v[124:127], v[64:67], v[108:111], v[124:127]
    ds_read_b128 v[100:103], v1 offset:2048
    ds_bpermute_b32 v202, v14, v176 offset:8
    s_waitcnt lgkmcnt(8)
    v_mfma_f32_16x16x32_bf16 v[128:131], v[64:67], v[80:83], v[128:131]
    ds_read_b128 v[104:107], v1 offset:3072
    s_waitcnt lgkmcnt(8)
    v_mfma_f32_16x16x32_bf16 v[132:135], v[64:67], v[84:87], v[132:135]
    ds_read_b128 v[108:111], v1 offset:4096
    ds_bpermute_b32 v203, v14, v176 offset:12
    s_waitcnt lgkmcnt(8)
    v_mfma_f32_16x16x32_bf16 v[136:139], v[64:67], v[88:91], v[136:139]
    ds_read_b128 v[80:83], v1 offset:5120
    s_waitcnt lgkmcnt(8)
    v_mfma_f32_16x16x32_bf16 v[112:115], v[68:71], v[92:95], v[112:115]
    ds_read_b128 v[84:87], v1 offset:6144
    s_waitcnt lgkmcnt(7)
    v_mfma_f32_16x16x32_bf16 v[116:119], v[68:71], v[96:99], v[116:119]
    ds_read_b128 v[88:91], v1 offset:7168
    s_waitcnt lgkmcnt(7)
    v_mfma_f32_16x16x32_bf16 v[120:123], v[68:71], v[100:103], v[120:123]
    ds_read_b128 v[92:95], v1 offset:8192
    s_waitcnt lgkmcnt(6)
    v_mfma_f32_16x16x32_bf16 v[124:127], v[68:71], v[104:107], v[124:127]
    ds_read_b128 v[96:99], v1 offset:9216
    s_waitcnt lgkmcnt(6)
    v_mfma_f32_16x16x32_bf16 v[128:131], v[68:71], v[108:111], v[128:131]
    ds_read_b128 v[100:103], v1 offset:10240
    s_waitcnt lgkmcnt(5)
    v_mfma_f32_16x16x32_bf16 v[132:135], v[68:71], v[80:83], v[132:135]
    ds_read_b128 v[104:107], v1 offset:11264
    s_waitcnt lgkmcnt(5)
    v_mfma_f32_16x16x32_bf16 v[136:139], v[68:71], v[84:87], v[136:139]
    ds_read_b128 v[108:111], v1 offset:12288
    s_waitcnt lgkmcnt(5)
    v_mfma_f32_16x16x32_bf16 v[112:115], v[72:75], v[88:91], v[112:115]
    ds_read_b128 v[80:83], v1 offset:13312
    s_waitcnt lgkmcnt(5)
    v_mfma_f32_16x16x32_bf16 v[116:119], v[72:75], v[92:95], v[116:119]
    s_waitcnt lgkmcnt(4)
    v_mfma_f32_16x16x32_bf16 v[120:123], v[72:75], v[96:99], v[120:123]
    s_waitcnt lgkmcnt(3)
    v_mfma_f32_16x16x32_bf16 v[124:127], v[72:75], v[100:103], v[124:127]
    s_waitcnt lgkmcnt(2)
    v_mfma_f32_16x16x32_bf16 v[128:131], v[72:75], v[104:107], v[128:131]
    s_waitcnt lgkmcnt(1)
    v_mfma_f32_16x16x32_bf16 v[132:135], v[72:75], v[108:111], v[132:135]
    s_waitcnt lgkmcnt(0)
    v_mfma_f32_16x16x32_bf16 v[136:139], v[72:75], v[80:83], v[136:139]
    s_barrier
    v_pk_mul_f32 v[112:113], v[112:113], v[200:201]
    v_pk_mul_f32 v[114:115], v[114:115], v[202:203]
    v_pk_mul_f32 v[180:181], v[112:113], v[112:113]
    v_pk_mul_f32 v[182:183], v[114:115], v[114:115]
    v_pk_fma_f32 v[180:181], v[180:181], v[168:169], v[170:171]
    v_pk_fma_f32 v[182:183], v[182:183], v[168:169], v[170:171]
    v_pk_mul_f32 v[180:181], v[180:181], v[112:113]
    s_mul_i32 s67, s48, 14336
    s_min_u32 s67, s67, 43008
    s_add_u32 s79, s63, s67
    s_add_u32 s80, s67, 65536
    s_add_u32 s79, s79, 21129216
    v_pk_mul_f32 v[182:183], v[182:183], v[114:115]
    v_exp_f32 v180, v180
    v_exp_f32 v182, v182
    v_exp_f32 v181, v181
    v_exp_f32 v183, v183
    v_pk_add_f32 v[180:181], v[180:181], 1.0 op_sel_hi:[1,0]
    s_mov_b32 m0, s80
    v_pk_add_f32 v[182:183], v[182:183], 1.0 op_sel_hi:[1,0]
    v_rcp_f32 v180, v180
    v_rcp_f32 v182, v182
    v_rcp_f32 v181, v181
    v_rcp_f32 v183, v183
    v_pk_mul_f32 v[112:113], v[112:113], v[180:181]
    buffer_load_dwordx4 v1, s[16:19], s79 offen sc1 lds
    v_pk_mul_f32 v[114:115], v[114:115], v[182:183]
    v_pk_mul_f32 v[116:117], v[116:117], v[200:201]
    v_pk_mul_f32 v[118:119], v[118:119], v[202:203]
    v_pk_mul_f32 v[184:185], v[116:117], v[116:117]
    v_pk_mul_f32 v[186:187], v[118:119], v[118:119]
    v_pk_fma_f32 v[184:185], v[184:185], v[168:169], v[170:171]
    buffer_load_dwordx4 v1, s[16:19], s79 offen offset:1024 sc1 lds
    v_pk_fma_f32 v[186:187], v[186:187], v[168:169], v[170:171]
    v_pk_mul_f32 v[184:185], v[184:185], v[116:117]
    v_pk_mul_f32 v[186:187], v[186:187], v[118:119]
    v_exp_f32 v184, v184
    v_exp_f32 v186, v186
    v_exp_f32 v185, v185
    buffer_load_dwordx4 v1, s[16:19], s79 offen offset:2048 sc1 lds
    v_exp_f32 v187, v187
    v_pk_add_f32 v[184:185], v[184:185], 1.0 op_sel_hi:[1,0]
    v_pk_add_f32 v[186:187], v[186:187], 1.0 op_sel_hi:[1,0]
    v_rcp_f32 v184, v184
    v_rcp_f32 v186, v186
    v_rcp_f32 v185, v185
    buffer_load_dwordx4 v1, s[16:19], s79 offen offset:3072 sc1 lds
    v_rcp_f32 v187, v187
    v_pk_mul_f32 v[116:117], v[116:117], v[184:185]
    v_pk_mul_f32 v[118:119], v[118:119], v[186:187]
    v_pk_mul_f32 v[120:121], v[120:121], v[200:201]
    v_pk_mul_f32 v[122:123], v[122:123], v[202:203]
    v_pk_mul_f32 v[180:181], v[120:121], v[120:121]
    s_add_u32 s79, s79, 4096
    s_add_u32 s80, s80, 4096
    s_mov_b32 m0, s80
    v_pk_mul_f32 v[182:183], v[122:123], v[122:123]
    v_pk_fma_f32 v[180:181], v[180:181], v[168:169], v[170:171]
    v_pk_fma_f32 v[182:183], v[182:183], v[168:169], v[170:171]
    v_pk_mul_f32 v[180:181], v[180:181], v[120:121]
    v_pk_mul_f32 v[182:183], v[182:183], v[122:123]
    v_exp_f32 v180, v180
    buffer_load_dwordx4 v1, s[16:19], s79 offen sc1 lds
    v_exp_f32 v182, v182
    v_exp_f32 v181, v181
    v_exp_f32 v183, v183
    v_pk_add_f32 v[180:181], v[180:181], 1.0 op_sel_hi:[1,0]
    v_pk_add_f32 v[182:183], v[182:183], 1.0 op_sel_hi:[1,0]
    v_rcp_f32 v180, v180
    buffer_load_dwordx4 v1, s[16:19], s79 offen offset:1024 sc1 lds
    v_rcp_f32 v182, v182
    v_rcp_f32 v181, v181
    v_rcp_f32 v183, v183
    v_pk_mul_f32 v[120:121], v[120:121], v[180:181]
    v_pk_mul_f32 v[122:123], v[122:123], v[182:183]
    v_pk_mul_f32 v[124:125], v[124:125], v[200:201]
    buffer_load_dwordx4 v1, s[16:19], s79 offen offset:2048 sc1 lds
    v_pk_mul_f32 v[126:127], v[126:127], v[202:203]
    v_pk_mul_f32 v[184:185], v[124:125], v[124:125]
    v_pk_mul_f32 v[186:187], v[126:127], v[126:127]
    v_pk_fma_f32 v[184:185], v[184:185], v[168:169], v[170:171]
    v_pk_fma_f32 v[186:187], v[186:187], v[168:169], v[170:171]
    v_pk_mul_f32 v[184:185], v[184:185], v[124:125]
    buffer_load_dwordx4 v1, s[16:19], s79 offen offset:3072 sc1 lds
    v_pk_mul_f32 v[186:187], v[186:187], v[126:127]
    v_exp_f32 v184, v184
    v_exp_f32 v186, v186
    v_exp_f32 v185, v185
    v_exp_f32 v187, v187
    v_pk_add_f32 v[184:185], v[184:185], 1.0 op_sel_hi:[1,0]
    s_add_u32 s79, s79, 4096
    s_add_u32 s80, s80, 4096
    s_mov_b32 m0, s80
    v_pk_add_f32 v[186:187], v[186:187], 1.0 op_sel_hi:[1,0]
    v_rcp_f32 v184, v184
    v_rcp_f32 v186, v186
    v_rcp_f32 v185, v185
    v_rcp_f32 v187, v187
    v_pk_mul_f32 v[124:125], v[124:125], v[184:185]
    buffer_load_dwordx4 v1, s[16:19], s79 offen sc1 lds
    v_pk_mul_f32 v[126:127], v[126:127], v[186:187]
    v_pk_mul_f32 v[128:129], v[128:129], v[200:201]
    v_pk_mul_f32 v[130:131], v[130:131], v[202:203]
    v_pk_mul_f32 v[180:181], v[128:129], v[128:129]
    v_pk_mul_f32 v[182:183], v[130:131], v[130:131]
    v_pk_fma_f32 v[180:181], v[180:181], v[168:169], v[170:171]
    buffer_load_dwordx4 v1, s[16:19], s79 offen offset:1024 sc1 lds
    v_pk_fma_f32 v[182:183], v[182:183], v[168:169], v[170:171]
    v_pk_mul_f32 v[180:181], v[180:181], v[128:129]
    v_pk_mul_f32 v[182:183], v[182:183], v[130:131]
    v_exp_f32 v180, v180
    v_exp_f32 v182, v182
    v_exp_f32 v181, v181
    buffer_load_dwordx4 v1, s[16:19], s79 offen offset:2048 sc1 lds
    v_exp_f32 v183, v183
    v_pk_add_f32 v[180:181], v[180:181], 1.0 op_sel_hi:[1,0]
    v_pk_add_f32 v[182:183], v[182:183], 1.0 op_sel_hi:[1,0]
    v_rcp_f32 v180, v180
    v_rcp_f32 v182, v182
    v_rcp_f32 v181, v181
    buffer_load_dwordx4 v1, s[16:19], s79 offen offset:3072 sc1 lds
    v_rcp_f32 v183, v183
    v_pk_mul_f32 v[128:129], v[128:129], v[180:181]
    v_pk_mul_f32 v[130:131], v[130:131], v[182:183]
    v_pk_mul_f32 v[132:133], v[132:133], v[200:201]
    v_pk_mul_f32 v[134:135], v[134:135], v[202:203]
    v_pk_mul_f32 v[184:185], v[132:133], v[132:133]
    s_add_u32 s79, s79, 4096
    s_add_u32 s80, s80, 4096
    s_mov_b32 m0, s80
    v_pk_mul_f32 v[186:187], v[134:135], v[134:135]
    v_pk_fma_f32 v[184:185], v[184:185], v[168:169], v[170:171]
    v_pk_fma_f32 v[186:187], v[186:187], v[168:169], v[170:171]
    v_pk_mul_f32 v[184:185], v[184:185], v[132:133]
    v_pk_mul_f32 v[186:187], v[186:187], v[134:135]
    v_exp_f32 v184, v184
    buffer_load_dwordx4 v1, s[16:19], s79 offen sc1 lds
    v_exp_f32 v186, v186
    v_exp_f32 v185, v185
    v_exp_f32 v187, v187
    v_pk_add_f32 v[184:185], v[184:185], 1.0 op_sel_hi:[1,0]
    v_pk_add_f32 v[186:187], v[186:187], 1.0 op_sel_hi:[1,0]
    v_rcp_f32 v184, v184
    buffer_load_dwordx4 v1, s[16:19], s79 offen offset:1024 sc1 lds
    v_rcp_f32 v186, v186
    v_rcp_f32 v185, v185
    v_rcp_f32 v187, v187
    v_pk_mul_f32 v[132:133], v[132:133], v[184:185]
    v_pk_mul_f32 v[134:135], v[134:135], v[186:187]
    v_pk_mul_f32 v[136:137], v[136:137], v[200:201]
    v_pk_mul_f32 v[138:139], v[138:139], v[202:203]
    v_pk_mul_f32 v[180:181], v[136:137], v[136:137]
    v_pk_mul_f32 v[182:183], v[138:139], v[138:139]
    v_pk_fma_f32 v[180:181], v[180:181], v[168:169], v[170:171]
    v_pk_fma_f32 v[182:183], v[182:183], v[168:169], v[170:171]
    v_pk_mul_f32 v[180:181], v[180:181], v[136:137]
    v_pk_mul_f32 v[182:183], v[182:183], v[138:139]
    v_exp_f32 v180, v180
    v_exp_f32 v182, v182
    v_exp_f32 v181, v181
    v_exp_f32 v183, v183
    v_pk_add_f32 v[180:181], v[180:181], 1.0 op_sel_hi:[1,0]
    v_pk_add_f32 v[182:183], v[182:183], 1.0 op_sel_hi:[1,0]
    v_rcp_f32 v180, v180
    v_rcp_f32 v182, v182
    v_rcp_f32 v181, v181
    v_rcp_f32 v183, v183
    v_pk_mul_f32 v[136:137], v[136:137], v[180:181]
    v_pk_mul_f32 v[138:139], v[138:139], v[182:183]
    v_pk_mul_f32 v[184:185], v[112:113], v[112:113]
    v_pk_mul_f32 v[186:187], v[114:115], v[114:115]
    v_pk_fma_f32 v[184:185], v[116:117], v[116:117], v[184:185]
    v_pk_add_f32 v[180:181], v[116:117], v[112:113]
    v_pk_fma_f32 v[186:187], v[118:119], v[118:119], v[186:187]
    v_pk_add_f32 v[182:183], v[118:119], v[114:115]
    v_pk_fma_f32 v[184:185], v[120:121], v[120:121], v[184:185]
    v_pk_add_f32 v[180:181], v[120:121], v[180:181]
    v_pk_fma_f32 v[186:187], v[122:123], v[122:123], v[186:187]
    v_pk_add_f32 v[182:183], v[122:123], v[182:183]
    v_pk_fma_f32 v[184:185], v[124:125], v[124:125], v[184:185]
    v_pk_add_f32 v[180:181], v[124:125], v[180:181]
    v_pk_fma_f32 v[186:187], v[126:127], v[126:127], v[186:187]
    v_pk_add_f32 v[182:183], v[126:127], v[182:183]
    v_pk_fma_f32 v[184:185], v[128:129], v[128:129], v[184:185]
    v_pk_add_f32 v[180:181], v[128:129], v[180:181]
    v_pk_fma_f32 v[186:187], v[130:131], v[130:131], v[186:187]
    v_pk_add_f32 v[182:183], v[130:131], v[182:183]
    v_pk_fma_f32 v[184:185], v[132:133], v[132:133], v[184:185]
    v_pk_add_f32 v[180:181], v[132:133], v[180:181]
    v_pk_fma_f32 v[186:187], v[134:135], v[134:135], v[186:187]
    v_pk_add_f32 v[182:183], v[134:135], v[182:183]
    v_pk_fma_f32 v[184:185], v[136:137], v[136:137], v[184:185]
    v_pk_add_f32 v[180:181], v[136:137], v[180:181]
    v_pk_fma_f32 v[186:187], v[138:139], v[138:139], v[186:187]
    v_pk_add_f32 v[182:183], v[138:139], v[182:183]
    v_add_f32_dpp v180, v180, v180 row_ror:8 row_mask:0xf bank_mask:0xf
    v_add_f32_dpp v181, v181, v181 row_ror:8 row_mask:0xf bank_mask:0xf
    v_add_f32_dpp v182, v182, v182 row_ror:8 row_mask:0xf bank_mask:0xf
    v_add_f32_dpp v183, v183, v183 row_ror:8 row_mask:0xf bank_mask:0xf
    v_add_f32_dpp v184, v184, v184 row_ror:8 row_mask:0xf bank_mask:0xf
    v_add_f32_dpp v185, v185, v185 row_ror:8 row_mask:0xf bank_mask:0xf
    v_add_f32_dpp v186, v186, v186 row_ror:8 row_mask:0xf bank_mask:0xf
    v_add_f32_dpp v187, v187, v187 row_ror:8 row_mask:0xf bank_mask:0xf
    v_add_f32_dpp v180, v180, v180 row_ror:4 row_mask:0xf bank_mask:0xf
    v_add_f32_dpp v181, v181, v181 row_ror:4 row_mask:0xf bank_mask:0xf
    v_add_f32_dpp v182, v182, v182 row_ror:4 row_mask:0xf bank_mask:0xf
    v_add_f32_dpp v183, v183, v183 row_ror:4 row_mask:0xf bank_mask:0xf
    v_add_f32_dpp v184, v184, v184 row_ror:4 row_mask:0xf bank_mask:0xf
    v_add_f32_dpp v185, v185, v185 row_ror:4 row_mask:0xf bank_mask:0xf
    v_add_f32_dpp v186, v186, v186 row_ror:4 row_mask:0xf bank_mask:0xf
    v_add_f32_dpp v187, v187, v187 row_ror:4 row_mask:0xf bank_mask:0xf
    v_add_f32_dpp v180, v180, v180 row_ror:2 row_mask:0xf bank_mask:0xf
    v_add_f32_dpp v181, v181, v181 row_ror:2 row_mask:0xf bank_mask:0xf
    v_add_f32_dpp v182, v182, v182 row_ror:2 row_mask:0xf bank_mask:0xf
    v_add_f32_dpp v183, v183, v183 row_ror:2 row_mask:0xf bank_mask:0xf
    v_add_f32_dpp v184, v184, v184 row_ror:2 row_mask:0xf bank_mask:0xf
    v_add_f32_dpp v185, v185, v185 row_ror:2 row_mask:0xf bank_mask:0xf
    v_add_f32_dpp v186, v186, v186 row_ror:2 row_mask:0xf bank_mask:0xf
    v_add_f32_dpp v187, v187, v187 row_ror:2 row_mask:0xf bank_mask:0xf
    v_add_f32_dpp v180, v180, v180 row_ror:1 row_mask:0xf bank_mask:0xf
    v_add_f32_dpp v181, v181, v181 row_ror:1 row_mask:0xf bank_mask:0xf
    v_add_f32_dpp v182, v182, v182 row_ror:1 row_mask:0xf bank_mask:0xf
    v_add_f32_dpp v183, v183, v183 row_ror:1 row_mask:0xf bank_mask:0xf
    v_add_f32_dpp v184, v184, v184 row_ror:1 row_mask:0xf bank_mask:0xf
    v_add_f32_dpp v185, v185, v185 row_ror:1 row_mask:0xf bank_mask:0xf
    v_add_f32_dpp v186, v186, v186 row_ror:1 row_mask:0xf bank_mask:0xf
    v_add_f32_dpp v187, v187, v187 row_ror:1 row_mask:0xf bank_mask:0xf
    v_cndmask_b32 v188, v180, v182, s[68:69]
    v_cndmask_b32 v189, v184, v186, s[68:69]
    v_cndmask_b32 v190, v181, v183, s[68:69]
    v_cndmask_b32 v191, v185, v187, s[68:69]
    v_min_u32 v188, -2, v188
    v_min_u32 v189, -2, v189
    v_min_u32 v190, -2, v190
    v_min_u32 v191, -2, v191
    s_waitcnt vmcnt(14)
    s_mov_b32 exec_lo, 0x00030003
    s_mov_b32 exec_hi, 0x00030003
    buffer_store_dwordx4 v[188:191], v7, s[16:19], s89 offen sc1
    s_mov_b64 exec, -1
    ds_read_b128 v[80:83], v1 offset:14336
    ds_read_b128 v[84:87], v1 offset:15360
    ds_read_b128 v[88:91], v1 offset:16384
    ds_read_b128 v[92:95], v1 offset:17408
    ds_read_b128 v[96:99], v1 offset:18432
    ds_read_b128 v[100:103], v1 offset:19456
    s_waitcnt lgkmcnt(5)
    v_mfma_f32_16x16x32_bf16 v[140:143], v[80:83], v[16:19], 0
    ds_read_b128 v[104:107], v1 offset:20480
    s_waitcnt lgkmcnt(5)
    v_mfma_f32_16x16x32_bf16 v[144:147], v[84:87], v[16:19], 0
    ds_read_b128 v[108:111], v1 offset:21504
    s_waitcnt lgkmcnt(5)
    v_mfma_f32_16x16x32_bf16 v[148:151], v[88:91], v[16:19], 0
    ds_read_b128 v[80:83], v1 offset:22528
    s_waitcnt lgkmcnt(5)
    v_mfma_f32_16x16x32_bf16 v[152:155], v[92:95], v[16:19], 0
    ds_read_b128 v[84:87], v1 offset:23552
    s_waitcnt lgkmcnt(5)
    v_mfma_f32_16x16x32_bf16 v[156:159], v[96:99], v[16:19], 0
    ds_read_b128 v[88:91], v1 offset:24576
    s_waitcnt lgkmcnt(5)
    v_mfma_f32_16x16x32_bf16 v[160:163], v[100:103], v[16:19], 0
    ds_read_b128 v[92:95], v1 offset:25600
    s_waitcnt lgkmcnt(5)
    v_mfma_f32_16x16x32_bf16 v[164:167], v[104:107], v[16:19], 0
    ds_read_b128 v[96:99], v1 offset:26624
    s_waitcnt lgkmcnt(5)
    v_mfma_f32_16x16x32_bf16 v[140:143], v[108:111], v[20:23], v[140:143]
    ds_read_b128 v[100:103], v1 offset:27648
    s_waitcnt lgkmcnt(5)
    v_mfma_f32_16x16x32_bf16 v[144:147], v[80:83], v[20:23], v[144:147]
    ds_read_b128 v[104:107], v1 offset:28672
    s_waitcnt lgkmcnt(5)
    v_mfma_f32_16x16x32_bf16 v[148:151], v[84:87], v[20:23], v[148:151]
    ds_read_b128 v[108:111], v1 offset:29696
    s_waitcnt lgkmcnt(5)
    v_mfma_f32_16x16x32_bf16 v[152:155], v[88:91], v[20:23], v[152:155]
    ds_read_b128 v[80:83], v1 offset:30720
    s_waitcnt lgkmcnt(5)
    v_mfma_f32_16x16x32_bf16 v[156:159], v[92:95], v[20:23], v[156:159]
    ds_read_b128 v[84:87], v1 offset:31744
    s_waitcnt lgkmcnt(5)
    v_mfma_f32_16x16x32_bf16 v[160:163], v[96:99], v[20:23], v[160:163]
    ds_read_b128 v[88:91], v1 offset:32768
    s_waitcnt lgkmcnt(5)
    v_mfma_f32_16x16x32_bf16 v[164:167], v[100:103], v[20:23], v[164:167]
    ds_read_b128 v[92:95], v1 offset:33792
    s_waitcnt lgkmcnt(5)
    v_mfma_f32_16x16x32_bf16 v[140:143], v[104:107], v[24:27], v[140:143]
    ds_read_b128 v[96:99], v1 offset:34816
    s_waitcnt lgkmcnt(5)
    v_mfma_f32_16x16x32_bf16 v[144:147], v[108:111], v[24:27], v[144:147]
    ds_read_b128 v[100:103], v1 offset:35840
    s_waitcnt lgkmcnt(5)
    v_mfma_f32_16x16x32_bf16 v[148:151], v[80:83], v[24:27], v[148:151]
    ds_read_b128 v[104:107], v1 offset:36864
    s_waitcnt lgkmcnt(5)
    v_mfma_f32_16x16x32_bf16 v[152:155], v[84:87], v[24:27], v[152:155]
    ds_read_b128 v[108:111], v1 offset:37888
    s_waitcnt lgkmcnt(5)
    v_mfma_f32_16x16x32_bf16 v[156:159], v[88:91], v[24:27], v[156:159]
    ds_read_b128 v[80:83], v1 offset:38912
    s_waitcnt lgkmcnt(5)
    v_mfma_f32_16x16x32_bf16 v[160:163], v[92:95], v[24:27], v[160:163]
    ds_read_b128 v[84:87], v1 offset:39936
    s_waitcnt lgkmcnt(5)
    v_mfma_f32_16x16x32_bf16 v[164:167], v[96:99], v[24:27], v[164:167]
    ds_read_b128 v[88:91], v1 offset:40960
    s_waitcnt lgkmcnt(5)
    v_mfma_f32_16x16x32_bf16 v[140:143], v[100:103], v[28:31], v[140:143]
    ds_read_b128 v[92:95], v1 offset:41984
    buffer_load_dwordx4 v[204:207], v9, s[16:19], s88 offen sc1
    s_waitcnt lgkmcnt(5)
    v_mfma_f32_16x16x32_bf16 v[144:147], v[104:107], v[28:31], v[144:147]
    ds_read_b128 v[96:99], v1 offset:43008
    s_waitcnt lgkmcnt(5)
    v_mfma_f32_16x16x32_bf16 v[148:151], v[108:111], v[28:31], v[148:151]
    ds_read_b128 v[100:103], v1 offset:44032
    s_waitcnt lgkmcnt(5)
    v_mfma_f32_16x16x32_bf16 v[152:155], v[80:83], v[28:31], v[152:155]
    ds_read_b128 v[104:107], v1 offset:45056
    s_waitcnt lgkmcnt(5)
    v_mfma_f32_16x16x32_bf16 v[156:159], v[84:87], v[28:31], v[156:159]
    ds_read_b128 v[108:111], v1 offset:46080
    s_waitcnt lgkmcnt(5)
    v_mfma_f32_16x16x32_bf16 v[160:163], v[88:91], v[28:31], v[160:163]
    ds_read_b128 v[80:83], v1 offset:47104
    s_waitcnt lgkmcnt(5)
    v_mfma_f32_16x16x32_bf16 v[164:167], v[92:95], v[28:31], v[164:167]
    ds_read_b128 v[84:87], v1 offset:48128
    s_waitcnt lgkmcnt(5)
    v_mfma_f32_16x16x32_bf16 v[140:143], v[96:99], v[32:35], v[140:143]
    ds_read_b128 v[88:91], v1 offset:49152
    s_waitcnt lgkmcnt(5)
    v_mfma_f32_16x16x32_bf16 v[144:147], v[100:103], v[32:35], v[144:147]
    ds_read_b128 v[92:95], v1 offset:50176
    s_waitcnt lgkmcnt(5)
    v_mfma_f32_16x16x32_bf16 v[148:151], v[104:107], v[32:35], v[148:151]
    ds_read_b128 v[96:99], v1 offset:51200
    s_waitcnt lgkmcnt(5)
    v_mfma_f32_16x16x32_bf16 v[152:155], v[108:111], v[32:35], v[152:155]
    ds_read_b128 v[100:103], v1 offset:52224
    s_waitcnt lgkmcnt(5)
    v_mfma_f32_16x16x32_bf16 v[156:159], v[80:83], v[32:35], v[156:159]
    ds_read_b128 v[104:107], v1 offset:53248
    s_waitcnt lgkmcnt(5)
    v_mfma_f32_16x16x32_bf16 v[160:163], v[84:87], v[32:35], v[160:163]
    ds_read_b128 v[108:111], v1 offset:54272
    s_waitcnt lgkmcnt(5)
    v_mfma_f32_16x16x32_bf16 v[164:167], v[88:91], v[32:35], v[164:167]
    ds_read_b128 v[80:83], v1 offset:55296
    s_waitcnt lgkmcnt(5)
    v_mfma_f32_16x16x32_bf16 v[140:143], v[92:95], v[36:39], v[140:143]
    ds_read_b128 v[84:87], v1 offset:56320
    s_waitcnt lgkmcnt(5)
    v_mfma_f32_16x16x32_bf16 v[144:147], v[96:99], v[36:39], v[144:147]
    ds_read_b128 v[88:91], v1 offset:57344
    s_waitcnt lgkmcnt(5)
    v_mfma_f32_16x16x32_bf16 v[148:151], v[100:103], v[36:39], v[148:151]
    ds_read_b128 v[92:95], v1 offset:58368
    s_waitcnt lgkmcnt(5)
    v_mfma_f32_16x16x32_bf16 v[152:155], v[104:107], v[36:39], v[152:155]
    ds_read_b128 v[96:99], v1 offset:59392
    s_waitcnt lgkmcnt(5)
    v_mfma_f32_16x16x32_bf16 v[156:159], v[108:111], v[36:39], v[156:159]
    ds_read_b128 v[100:103], v1 offset:60416
    s_waitcnt lgkmcnt(5)
    v_mfma_f32_16x16x32_bf16 v[160:163], v[80:83], v[36:39], v[160:163]
    ds_read_b128 v[104:107], v1 offset:61440
    s_waitcnt lgkmcnt(5)
    v_mfma_f32_16x16x32_bf16 v[164:167], v[84:87], v[36:39], v[164:167]
    ds_read_b128 v[108:111], v1 offset:62464
.Lst_30:
    s_waitcnt vmcnt(0)
    v_max3_u32 v10, v204, v205, v206
    v_max_u32 v10, v10, v207
    v_cmp_eq_u32 vcc, -1, v10
    s_cbranch_vccz .Lstd_31
    buffer_load_dwordx4 v[204:207], v9, s[16:19], s88 offen sc1
    s_sub_u32 s59, s59, 1
    s_cmp_lg_u32 s59, 0
    s_cbranch_scc1 .Lst_30
    s_branch .Lexit
.Lstd_31:
    v_add_f32_dpp v204, v204, v204 quad_perm:[1,0,3,2] row_mask:0xf bank_mask:0xf
    v_add_f32_dpp v205, v205, v205 quad_perm:[1,0,3,2] row_mask:0xf bank_mask:0xf
    v_add_f32_dpp v206, v206, v206 quad_perm:[1,0,3,2] row_mask:0xf bank_mask:0xf
    v_add_f32_dpp v207, v207, v207 quad_perm:[1,0,3,2] row_mask:0xf bank_mask:0xf
    v_add_f32_dpp v204, v204, v204 quad_perm:[2,3,0,1] row_mask:0xf bank_mask:0xf
    v_add_f32_dpp v205, v205, v205 quad_perm:[2,3,0,1] row_mask:0xf bank_mask:0xf
    v_add_f32_dpp v206, v206, v206 quad_perm:[2,3,0,1] row_mask:0xf bank_mask:0xf
    v_add_f32_dpp v207, v207, v207 quad_perm:[2,3,0,1] row_mask:0xf bank_mask:0xf
    v_add_f32_dpp v204, v204, v204 row_half_mirror row_mask:0xf bank_mask:0xf
    v_add_f32_dpp v205, v205, v205 row_half_mirror row_mask:0xf bank_mask:0xf
    v_add_f32_dpp v206, v206, v206 row_half_mirror row_mask:0xf bank_mask:0xf
    v_add_f32_dpp v207, v207, v207 row_half_mirror row_mask:0xf bank_mask:0xf
    v_mul_f32 v204, 0xba924925, v204
    v_mul_f32 v206, 0xba924925, v206
    v_mul_f32 v10, v204, v204
    v_mul_f32 v11, v206, v206
    v_sub_f32 v10, 0x3727c5ac, v10
    v_sub_f32 v11, 0x3727c5ac, v11
    v_fmac_f32 v10, 0x3a924925, v205
    v_fmac_f32 v11, 0x3a924925, v207
    v_max_f32 v10, 0x3727c5ac, v10
    v_max_f32 v11, 0x3727c5ac, v11
    v_rsq_f32 v205, v10
    v_rsq_f32 v207, v11
    v_mul_f32 v204, v204, v205
    v_mul_f32 v206, v206, v207
    v_mov_b32 v180, v205
    v_mov_b32 v184, v204
    v_mov_b32 v181, v207
    v_mov_b32 v185, v206
    v_mov_b32 v182, v205
    v_mov_b32 v186, v204
    v_mov_b32 v183, v207
    v_mov_b32 v187, v206
    v_mov_b32_dpp v180, v205 row_ror:8 row_mask:0xf bank_mask:0xc
    v_mov_b32_dpp v184, v204 row_ror:8 row_mask:0xf bank_mask:0xc
    v_mov_b32_dpp v181, v207 row_ror:8 row_mask:0xf bank_mask:0xc
    v_mov_b32_dpp v185, v206 row_ror:8 row_mask:0xf bank_mask:0xc
    v_mov_b32_dpp v182, v205 row_ror:8 row_mask:0xf bank_mask:0x3
    v_mov_b32_dpp v186, v204 row_ror:8 row_mask:0xf bank_mask:0x3
    v_mov_b32_dpp v183, v207 row_ror:8 row_mask:0xf bank_mask:0x3
    v_mov_b32_dpp v187, v206 row_ror:8 row_mask:0xf bank_mask:0x3
    v_pk_fma_f32 v[112:113], v[112:113], v[180:181], v[184:185]
    v_pk_fma_f32 v[114:115], v[114:115], v[182:183], v[186:187]
    v_cvt_pk_bf16_f32 v188, v112, v113
    v_cvt_pk_bf16_f32 v189, v114, v115
    v_pk_fma_f32 v[116:117], v[116:117], v[180:181], v[184:185]
    v_pk_fma_f32 v[118:119], v[118:119], v[182:183], v[186:187]
    v_cvt_pk_bf16_f32 v190, v116, v117
    v_cvt_pk_bf16_f32 v191, v118, v119
    s_nop 0
    v_permlane16_swap_b32 v188, v190
    v_permlane16_swap_b32 v189, v191
    buffer_store_dwordx4 v[188:191], v12, s[16:19], s90 offen sc1
    v_pk_fma_f32 v[120:121], v[120:121], v[180:181], v[184:185]
    v_pk_fma_f32 v[122:123], v[122:123], v[182:183], v[186:187]
    v_cvt_pk_bf16_f32 v192, v120, v121
    v_cvt_pk_bf16_f32 v193, v122, v123
    v_pk_fma_f32 v[124:125], v[124:125], v[180:181], v[184:185]
    v_pk_fma_f32 v[126:127], v[126:127], v[182:183], v[186:187]
    v_cvt_pk_bf16_f32 v194, v124, v125
    v_cvt_pk_bf16_f32 v195, v126, v127
    s_nop 0
    v_permlane16_swap_b32 v192, v194
    v_permlane16_swap_b32 v193, v195
    buffer_store_dwordx4 v[192:195], v12, s[16:19], s90 offen offset:2048 sc1
    v_pk_fma_f32 v[128:129], v[128:129], v[180:181], v[184:185]
    v_pk_fma_f32 v[130:131], v[130:131], v[182:183], v[186:187]
    v_cvt_pk_bf16_f32 v196, v128, v129
    v_cvt_pk_bf16_f32 v197, v130, v131
    v_pk_fma_f32 v[132:133], v[132:133], v[180:181], v[184:185]
    v_pk_fma_f32 v[134:135], v[134:135], v[182:183], v[186:187]
    v_cvt_pk_bf16_f32 v198, v132, v133
    v_cvt_pk_bf16_f32 v199, v134, v135
    s_nop 0
    v_permlane16_swap_b32 v196, v198
    v_permlane16_swap_b32 v197, v199
    buffer_store_dwordx4 v[196:199], v12, s[16:19], s91 offen sc1
    v_pk_fma_f32 v[136:137], v[136:137], v[180:181], v[184:185]
    v_pk_fma_f32 v[138:139], v[138:139], v[182:183], v[186:187]
    v_cvt_pk_bf16_f32 v200, v136, v137
    v_cvt_pk_bf16_f32 v201, v138, v139
    s_nop 0
    v_permlane16_swap_b32 v200, v202
    v_permlane16_swap_b32 v201, v203
    buffer_store_dwordx4 v[200:203], v15, s[16:19], s91 offen offset:2048 sc1
    s_waitcnt lgkmcnt(5)
    v_mfma_f32_16x16x32_bf16 v[140:143], v[88:91], v[40:43], v[140:143]
    ds_read_b128 v[80:83], v1 offset:63488
    s_waitcnt lgkmcnt(5)
    v_mfma_f32_16x16x32_bf16 v[144:147], v[92:95], v[40:43], v[144:147]
    s_barrier
    ds_read_b128 v[84:87], v4
    s_waitcnt lgkmcnt(5)
    v_mfma_f32_16x16x32_bf16 v[148:151], v[96:99], v[40:43], v[148:151]
    ds_read_b128 v[88:91], v4 offset:1024
    s_waitcnt lgkmcnt(5)
    v_mfma_f32_16x16x32_bf16 v[152:155], v[100:103], v[40:43], v[152:155]
    ds_read_b128 v[92:95], v4 offset:2048
    s_waitcnt lgkmcnt(5)
    v_mfma_f32_16x16x32_bf16 v[156:159], v[104:107], v[40:43], v[156:159]
    ds_read_b128 v[96:99], v4 offset:3072
    s_waitcnt lgkmcnt(5)
    v_mfma_f32_16x16x32_bf16 v[160:163], v[108:111], v[40:43], v[160:163]
    ds_read_b128 v[100:103], v4 offset:4096
    s_waitcnt lgkmcnt(5)
    v_mfma_f32_16x16x32_bf16 v[164:167], v[80:83], v[40:43], v[164:167]
    ds_read_b128 v[104:107], v4 offset:5120
    s_waitcnt lgkmcnt(5)
    v_mfma_f32_16x16x32_bf16 v[140:143], v[84:87], v[44:47], v[140:143]
    ds_read_b128 v[108:111], v4 offset:6144
    s_waitcnt lgkmcnt(5)
    v_mfma_f32_16x16x32_bf16 v[144:147], v[88:91], v[44:47], v[144:147]
    ds_read_b128 v[80:83], v4 offset:7168
    s_waitcnt lgkmcnt(5)
    v_mfma_f32_16x16x32_bf16 v[148:151], v[92:95], v[44:47], v[148:151]
    ds_read_b128 v[84:87], v4 offset:8192
    s_waitcnt lgkmcnt(5)
    v_mfma_f32_16x16x32_bf16 v[152:155], v[96:99], v[44:47], v[152:155]
    ds_read_b128 v[88:91], v4 offset:9216
    s_waitcnt lgkmcnt(5)
    v_mfma_f32_16x16x32_bf16 v[156:159], v[100:103], v[44:47], v[156:159]
    ds_read_b128 v[92:95], v4 offset:10240
    s_waitcnt lgkmcnt(5)
    v_mfma_f32_16x16x32_bf16 v[160:163], v[104:107], v[44:47], v[160:163]
    ds_read_b128 v[96:99], v4 offset:11264
    s_waitcnt lgkmcnt(5)
    v_mfma_f32_16x16x32_bf16 v[164:167], v[108:111], v[44:47], v[164:167]
    ds_read_b128 v[100:103], v4 offset:12288
    s_waitcnt lgkmcnt(5)
    v_mfma_f32_16x16x32_bf16 v[140:143], v[80:83], v[48:51], v[140:143]
    ds_read_b128 v[104:107], v4 offset:13312
    s_waitcnt lgkmcnt(5)
    v_mfma_f32_16x16x32_bf16 v[144:147], v[84:87], v[48:51], v[144:147]
    ds_read_b128 v[108:111], v4 offset:14336
    s_waitcnt lgkmcnt(5)
    v_mfma_f32_16x16x32_bf16 v[148:151], v[88:91], v[48:51], v[148:151]
    ds_read_b128 v[80:83], v4 offset:15360
    s_waitcnt lgkmcnt(5)
    v_mfma_f32_16x16x32_bf16 v[152:155], v[92:95], v[48:51], v[152:155]
    ds_read_b128 v[84:87], v4 offset:16384
    s_waitcnt lgkmcnt(5)
    v_mfma_f32_16x16x32_bf16 v[156:159], v[96:99], v[48:51], v[156:159]
    ds_read_b128 v[88:91], v4 offset:17408
    s_waitcnt lgkmcnt(5)
    v_mfma_f32_16x16x32_bf16 v[160:163], v[100:103], v[48:51], v[160:163]
    ds_read_b128 v[92:95], v4 offset:18432
    s_waitcnt lgkmcnt(5)
    v_mfma_f32_16x16x32_bf16 v[164:167], v[104:107], v[48:51], v[164:167]
    ds_read_b128 v[96:99], v4 offset:19456
    s_waitcnt lgkmcnt(5)
    v_mfma_f32_16x16x32_bf16 v[140:143], v[108:111], v[52:55], v[140:143]
    ds_read_b128 v[100:103], v4 offset:20480
    s_waitcnt lgkmcnt(5)
    v_mfma_f32_16x16x32_bf16 v[144:147], v[80:83], v[52:55], v[144:147]
    ds_read_b128 v[104:107], v4 offset:21504
    s_waitcnt lgkmcnt(5)
    v_mfma_f32_16x16x32_bf16 v[148:151], v[84:87], v[52:55], v[148:151]
    ds_read_b128 v[108:111], v4 offset:22528
    s_waitcnt lgkmcnt(5)
    v_mfma_f32_16x16x32_bf16 v[152:155], v[88:91], v[52:55], v[152:155]
    ds_read_b128 v[80:83], v4 offset:23552
    s_waitcnt lgkmcnt(5)
    v_mfma_f32_16x16x32_bf16 v[156:159], v[92:95], v[52:55], v[156:159]
    ds_read_b128 v[84:87], v4 offset:24576
    s_waitcnt lgkmcnt(5)
    v_mfma_f32_16x16x32_bf16 v[160:163], v[96:99], v[52:55], v[160:163]
    ds_read_b128 v[88:91], v4 offset:25600
    s_waitcnt lgkmcnt(5)
    v_mfma_f32_16x16x32_bf16 v[164:167], v[100:103], v[52:55], v[164:167]
    ds_read_b128 v[92:95], v4 offset:26624
    s_waitcnt lgkmcnt(5)
    v_mfma_f32_16x16x32_bf16 v[140:143], v[104:107], v[56:59], v[140:143]
    ds_read_b128 v[96:99], v4 offset:27648
    s_waitcnt lgkmcnt(5)
    v_mfma_f32_16x16x32_bf16 v[144:147], v[108:111], v[56:59], v[144:147]
    ds_read_b128 v[100:103], v4 offset:28672
    s_waitcnt lgkmcnt(5)
    v_mfma_f32_16x16x32_bf16 v[148:151], v[80:83], v[56:59], v[148:151]
    ds_read_b128 v[104:107], v4 offset:29696
    s_waitcnt lgkmcnt(5)
    v_mfma_f32_16x16x32_bf16 v[152:155], v[84:87], v[56:59], v[152:155]
    ds_read_b128 v[108:111], v4 offset:30720
    s_waitcnt lgkmcnt(5)
    v_mfma_f32_16x16x32_bf16 v[156:159], v[88:91], v[56:59], v[156:159]
    ds_read_b128 v[80:83], v4 offset:31744
    s_waitcnt lgkmcnt(5)
    v_mfma_f32_16x16x32_bf16 v[160:163], v[92:95], v[56:59], v[160:163]
    ds_read_b128 v[84:87], v4 offset:32768
    s_waitcnt lgkmcnt(5)
    v_mfma_f32_16x16x32_bf16 v[164:167], v[96:99], v[56:59], v[164:167]
    ds_read_b128 v[88:91], v4 offset:33792
    s_waitcnt lgkmcnt(5)
    v_mfma_f32_16x16x32_bf16 v[140:143], v[100:103], v[60:63], v[140:143]
    ds_read_b128 v[92:95], v4 offset:34816
    s_waitcnt lgkmcnt(5)
    v_mfma_f32_16x16x32_bf16 v[144:147], v[104:107], v[60:63], v[144:147]
    ds_read_b128 v[96:99], v4 offset:35840
    s_waitcnt lgkmcnt(5)
    v_mfma_f32_16x16x32_bf16 v[148:151], v[108:111], v[60:63], v[148:151]
    ds_read_b128 v[100:103], v4 offset:36864
    s_waitcnt lgkmcnt(5)
    v_mfma_f32_16x16x32_bf16 v[152:155], v[80:83], v[60:63], v[152:155]
    ds_read_b128 v[104:107], v4 offset:37888
    s_waitcnt lgkmcnt(5)
    v_mfma_f32_16x16x32_bf16 v[156:159], v[84:87], v[60:63], v[156:159]
    ds_read_b128 v[108:111], v4 offset:38912
    s_waitcnt lgkmcnt(5)
    v_mfma_f32_16x16x32_bf16 v[160:163], v[88:91], v[60:63], v[160:163]
    ds_read_b128 v[80:83], v4 offset:39936
    s_waitcnt lgkmcnt(5)
    v_mfma_f32_16x16x32_bf16 v[164:167], v[92:95], v[60:63], v[164:167]
    ds_read_b128 v[84:87], v4 offset:40960
    s_waitcnt vmcnt(0)
    s_barrier
    s_cmp_lg_u32 s48, 0
    s_cbranch_scc1 .Lnoarr_32
    s_mov_b64 exec, 15
    buffer_atomic_add v225, v208, s[16:19], 0 offen sc1
    s_mov_b64 exec, -1
.Lnoarr_32:
    s_waitcnt lgkmcnt(5)
    v_mfma_f32_16x16x32_bf16 v[140:143], v[96:99], v[64:67], v[140:143]
    ds_read_b128 v[88:91], v4 offset:41984
    s_mul_i32 s67, s48, 8192
    s_min_u32 s67, s67, 24576
    s_add_u32 s79, s64, s67
    s_add_u32 s80, s67, 122880
    s_add_u32 s79, s79, 0
    s_waitcnt lgkmcnt(5)
    v_mfma_f32_16x16x32_bf16 v[144:147], v[100:103], v[64:67], v[144:147]
    ds_read_b128 v[92:95], v4 offset:43008
    s_mov_b32 m0, s80
    s_waitcnt lgkmcnt(5)
    v_mfma_f32_16x16x32_bf16 v[148:151], v[104:107], v[64:67], v[148:151]
    ds_read_b128 v[96:99], v4 offset:44032
    buffer_load_dwordx4 v1, s[16:19], s79 offen sc1 lds
    s_waitcnt lgkmcnt(5)
    v_mfma_f32_16x16x32_bf16 v[152:155], v[108:111], v[64:67], v[152:155]
    ds_read_b128 v[100:103], v4 offset:45056
    buffer_load_dwordx4 v1, s[16:19], s79 offen offset:1024 sc1 lds
    s_waitcnt lgkmcnt(5)
    v_mfma_f32_16x16x32_bf16 v[156:159], v[80:83], v[64:67], v[156:159]
    ds_read_b128 v[104:107], v4 offset:46080
    buffer_load_dwordx4 v1, s[16:19], s79 offen offset:2048 sc1 lds
    s_waitcnt lgkmcnt(5)
    v_mfma_f32_16x16x32_bf16 v[160:163], v[84:87], v[64:67], v[160:163]
    ds_read_b128 v[108:111], v4 offset:47104
    buffer_load_dwordx4 v1, s[16:19], s79 offen offset:3072 sc1 lds
    s_waitcnt lgkmcnt(5)
    v_mfma_f32_16x16x32_bf16 v[164:167], v[88:91], v[64:67], v[164:167]
    ds_read_b128 v[80:83], v4 offset:48128
    s_add_u32 s79, s79, 4096
    s_add_u32 s80, s80, 4096
    s_mov_b32 m0, s80
    s_waitcnt lgkmcnt(5)
    v_mfma_f32_16x16x32_bf16 v[140:143], v[92:95], v[68:71], v[140:143]
    ds_read_b128 v[84:87], v4 offset:49152
    buffer_load_dwordx4 v1, s[16:19], s79 offen sc1 lds
    s_waitcnt lgkmcnt(5)
    v_mfma_f32_16x16x32_bf16 v[144:147], v[96:99], v[68:71], v[144:147]
    ds_read_b128 v[88:91], v4 offset:50176
    buffer_load_dwordx4 v1, s[16:19], s79 offen offset:1024 sc1 lds
    s_waitcnt lgkmcnt(5)
    v_mfma_f32_16x16x32_bf16 v[148:151], v[100:103], v[68:71], v[148:151]
    ds_read_b128 v[92:95], v4 offset:51200
    buffer_load_dwordx4 v1, s[16:19], s79 offen offset:2048 sc1 lds
    s_waitcnt lgkmcnt(5)
    v_mfma_f32_16x16x32_bf16 v[152:155], v[104:107], v[68:71], v[152:155]
    ds_read_b128 v[96:99], v4 offset:52224
    buffer_load_dwordx4 v1, s[16:19], s79 offen offset:3072 sc1 lds
    s_waitcnt lgkmcnt(5)
    v_mfma_f32_16x16x32_bf16 v[156:159], v[108:111], v[68:71], v[156:159]
    ds_read_b128 v[100:103], v4 offset:53248
    s_waitcnt lgkmcnt(5)
    v_mfma_f32_16x16x32_bf16 v[160:163], v[80:83], v[68:71], v[160:163]
    ds_read_b128 v[104:107], v4 offset:54272
    s_waitcnt lgkmcnt(5)
    v_mfma_f32_16x16x32_bf16 v[164:167], v[84:87], v[68:71], v[164:167]
    ds_read_b128 v[108:111], v4 offset:55296
    s_waitcnt lgkmcnt(5)
    v_mfma_f32_16x16x32_bf16 v[140:143], v[88:91], v[72:75], v[140:143]
    ds_read_b128 v[80:83], v4 offset:56320
    s_waitcnt lgkmcnt(5)
    v_mfma_f32_16x16x32_bf16 v[144:147], v[92:95], v[72:75], v[144:147]
    s_waitcnt lgkmcnt(4)
    v_mfma_f32_16x16x32_bf16 v[148:151], v[96:99], v[72:75], v[148:151]
    s_waitcnt lgkmcnt(3)
    v_mfma_f32_16x16x32_bf16 v[152:155], v[100:103], v[72:75], v[152:155]
    s_waitcnt lgkmcnt(2)
    v_mfma_f32_16x16x32_bf16 v[156:159], v[104:107], v[72:75], v[156:159]
    s_waitcnt lgkmcnt(1)
    v_mfma_f32_16x16x32_bf16 v[160:163], v[108:111], v[72:75], v[160:163]
    s_waitcnt lgkmcnt(0)
    v_mfma_f32_16x16x32_bf16 v[164:167], v[80:83], v[72:75], v[164:167]
    s_barrier
    v_pk_mul_f32 v[140:141], v[140:141], v[176:177] op_sel_hi:[1,0]
    v_pk_mul_f32 v[142:143], v[142:143], v[176:177] op_sel_hi:[1,0]
    v_pk_mul_f32 v[180:181], v[140:141], v[140:141]
    s_mul_i32 s67, s48, 9216
    s_min_u32 s67, s67, 27648
    s_add_u32 s79, s64, s67
    s_add_u32 s80, s67, 86016
    s_add_u32 s79, s79, 32768
    v_pk_mul_f32 v[182:183], v[142:143], v[142:143]
    v_pk_fma_f32 v[180:181], v[180:181], v[168:169], v[170:171]
    v_pk_fma_f32 v[182:183], v[182:183], v[168:169], v[170:171]
    s_mov_b32 m0, s80
    v_pk_mul_f32 v[180:181], v[180:181], v[140:141]
    v_pk_mul_f32 v[182:183], v[182:183], v[142:143]
    buffer_load_dwordx4 v1, s[16:19], s79 offen sc1 lds
    v_exp_f32 v180, v180
    v_exp_f32 v182, v182
    v_exp_f32 v181, v181
    buffer_load_dwordx4 v1, s[16:19], s79 offen offset:1024 sc1 lds
    v_exp_f32 v183, v183
    v_pk_add_f32 v[180:181], v[180:181], 1.0 op_sel_hi:[1,0]
    v_pk_add_f32 v[182:183], v[182:183], 1.0 op_sel_hi:[1,0]
    buffer_load_dwordx4 v1, s[16:19], s79 offen offset:2048 sc1 lds
    v_rcp_f32 v180, v180
    v_rcp_f32 v182, v182
    buffer_load_dwordx4 v1, s[16:19], s79 offen offset:3072 sc1 lds
    v_rcp_f32 v181, v181
    v_rcp_f32 v183, v183
    v_pk_mul_f32 v[140:141], v[140:141], v[180:181]
    s_add_u32 s79, s79, 4096
    s_add_u32 s80, s80, 4096
    s_mov_b32 m0, s80
    v_pk_mul_f32 v[142:143], v[142:143], v[182:183]
    v_pk_mul_f32 v[144:145], v[144:145], v[176:177] op_sel_hi:[1,0]
    v_pk_mul_f32 v[146:147], v[146:147], v[176:177] op_sel_hi:[1,0]
    buffer_load_dwordx4 v1, s[16:19], s79 offen sc1 lds
    v_pk_mul_f32 v[184:185], v[144:145], v[144:145]
    v_pk_mul_f32 v[186:187], v[146:147], v[146:147]
    buffer_load_dwordx4 v1, s[16:19], s79 offen offset:1024 sc1 lds
    v_pk_fma_f32 v[184:185], v[184:185], v[168:169], v[170:171]
    v_pk_fma_f32 v[186:187], v[186:187], v[168:169], v[170:171]
    v_pk_mul_f32 v[184:185], v[184:185], v[144:145]
    buffer_load_dwordx4 v1, s[16:19], s79 offen offset:2048 sc1 lds
    v_pk_mul_f32 v[186:187], v[186:187], v[146:147]
    v_exp_f32 v184, v184
    v_exp_f32 v186, v186
    buffer_load_dwordx4 v1, s[16:19], s79 offen offset:3072 sc1 lds
    v_exp_f32 v185, v185
    v_exp_f32 v187, v187
    s_add_u32 s79, s79, 4096
    s_add_u32 s80, s80, 4096
    s_mov_b32 m0, s80
    v_pk_add_f32 v[184:185], v[184:185], 1.0 op_sel_hi:[1,0]
    v_pk_add_f32 v[186:187], v[186:187], 1.0 op_sel_hi:[1,0]
    v_rcp_f32 v184, v184
    buffer_load_dwordx4 v1, s[16:19], s79 offen sc1 lds
    v_rcp_f32 v186, v186
    v_rcp_f32 v185, v185
    v_rcp_f32 v187, v187
    v_pk_mul_f32 v[144:145], v[144:145], v[184:185]
    v_pk_mul_f32 v[146:147], v[146:147], v[186:187]
    s_mul_i32 s77, s85, 112
    s_add_u32 s74, s92, s77
    s_add_u32 s75, s74, 4096
.Lpoll_33:
    buffer_load_dword v6, v209, s[16:19], 0 offen sc1
    s_waitcnt vmcnt(0)
    v_cmp_gt_u32 vcc, 8, v6
    s_cbranch_vccz .Lgot_34
    s_sub_u32 s59, s59, 1
    s_cmp_lg_u32 s59, 0
    s_cbranch_scc1 .Lpoll_33
    s_branch .Lexit
.Lgot_34:
    buffer_load_dwordx4 v[16:19], v1, s[16:19], s74 offen sc1
    buffer_load_dwordx4 v[20:23], v1, s[16:19], s74 offen offset:1024 sc1
    buffer_load_dwordx4 v[24:27], v1, s[16:19], s74 offen offset:2048 sc1
    buffer_load_dwordx4 v[28:31], v1, s[16:19], s74 offen offset:3072 sc1
    buffer_load_dwordx4 v[32:35], v1, s[16:19], s75 offen sc1
    buffer_load_dwordx4 v[36:39], v1, s[16:19], s75 offen offset:1024 sc1
    buffer_load_dwordx4 v[40:43], v1, s[16:19], s75 offen offset:2048 sc1
    s_add_u32 s77, s77, 7168
    s_add_u32 s74, s92, s77
    buffer_load_dwordx4 v[44:47], v1, s[16:19], s74 offen sc1
    v_pk_mul_f32 v[148:149], v[148:149], v[176:177] op_sel_hi:[1,0]
    v_pk_mul_f32 v[150:151], v[150:151], v[176:177] op_sel_hi:[1,0]
    v_pk_mul_f32 v[180:181], v[148:149], v[148:149]
    v_pk_mul_f32 v[182:183], v[150:151], v[150:151]
    v_pk_fma_f32 v[180:181], v[180:181], v[168:169], v[170:171]
    v_pk_fma_f32 v[182:183], v[182:183], v[168:169], v[170:171]
    v_pk_mul_f32 v[180:181], v[180:181], v[148:149]
    v_pk_mul_f32 v[182:183], v[182:183], v[150:151]
    v_exp_f32 v180, v180
    v_exp_f32 v182, v182
    buffer_load_dwordx4 v[48:51], v1, s[16:19], s74 offen offset:1024 sc1
    v_exp_f32 v181, v181
    v_exp_f32 v183, v183
    v_pk_add_f32 v[180:181], v[180:181], 1.0 op_sel_hi:[1,0]
    v_pk_add_f32 v[182:183], v[182:183], 1.0 op_sel_hi:[1,0]
    v_rcp_f32 v180, v180
    v_rcp_f32 v182, v182
    v_rcp_f32 v181, v181
    v_rcp_f32 v183, v183
    v_pk_mul_f32 v[148:149], v[148:149], v[180:181]
    buffer_load_dwordx4 v[52:55], v1, s[16:19], s74 offen offset:2048 sc1
    v_pk_mul_f32 v[150:151], v[150:151], v[182:183]
    v_pk_mul_f32 v[152:153], v[152:153], v[176:177] op_sel_hi:[1,0]
    v_pk_mul_f32 v[154:155], v[154:155], v[176:177] op_sel_hi:[1,0]
    v_pk_mul_f32 v[184:185], v[152:153], v[152:153]
    v_pk_mul_f32 v[186:187], v[154:155], v[154:155]
    v_pk_fma_f32 v[184:185], v[184:185], v[168:169], v[170:171]
    v_pk_fma_f32 v[186:187], v[186:187], v[168:169], v[170:171]
    v_pk_mul_f32 v[184:185], v[184:185], v[152:153]
    v_pk_mul_f32 v[186:187], v[186:187], v[154:155]
    buffer_load_dwordx4 v[56:59], v1, s[16:19], s74 offen offset:3072 sc1
    v_exp_f32 v184, v184
    v_exp_f32 v186, v186
    v_exp_f32 v185, v185
    v_exp_f32 v187, v187
    v_pk_add_f32 v[184:185], v[184:185], 1.0 op_sel_hi:[1,0]
    v_pk_add_f32 v[186:187], v[186:187], 1.0 op_sel_hi:[1,0]
    v_rcp_f32 v184, v184
    v_rcp_f32 v186, v186
    v_rcp_f32 v185, v185
    v_rcp_f32 v187, v187
    s_add_u32 s75, s74, 4096
    buffer_load_dwordx4 v[60:63], v1, s[16:19], s75 offen sc1
    v_pk_mul_f32 v[152:153], v[152:153], v[184:185]
    v_pk_mul_f32 v[154:155], v[154:155], v[186:187]
    v_pk_mul_f32 v[156:157], v[156:157], v[176:177] op_sel_hi:[1,0]
    v_pk_mul_f32 v[158:159], v[158:159], v[176:177] op_sel_hi:[1,0]
    v_pk_mul_f32 v[180:181], v[156:157], v[156:157]
    v_pk_mul_f32 v[182:183], v[158:159], v[158:159]
    v_pk_fma_f32 v[180:181], v[180:181], v[168:169], v[170:171]
    v_pk_fma_f32 v[182:183], v[182:183], v[168:169], v[170:171]
    v_pk_mul_f32 v[180:181], v[180:181], v[156:157]
    buffer_load_dwordx4 v[64:67], v1, s[16:19], s75 offen offset:1024 sc1
    v_pk_mul_f32 v[182:183], v[182:183], v[158:159]
    v_exp_f32 v180, v180
    v_exp_f32 v182, v182
    v_exp_f32 v181, v181
    v_exp_f32 v183, v183
    v_pk_add_f32 v[180:181], v[180:181], 1.0 op_sel_hi:[1,0]
    v_pk_add_f32 v[182:183], v[182:183], 1.0 op_sel_hi:[1,0]
    v_rcp_f32 v180, v180
    v_rcp_f32 v182, v182
    buffer_load_dwordx4 v[68:71], v1, s[16:19], s75 offen offset:2048 sc1
    v_rcp_f32 v181, v181
    v_rcp_f32 v183, v183
    v_pk_mul_f32 v[156:157], v[156:157], v[180:181]
    v_pk_mul_f32 v[158:159], v[158:159], v[182:183]
    v_pk_mul_f32 v[160:161], v[160:161], v[176:177] op_sel_hi:[1,0]
    v_pk_mul_f32 v[162:163], v[162:163], v[176:177] op_sel_hi:[1,0]
    v_pk_mul_f32 v[184:185], v[160:161], v[160:161]
    v_pk_mul_f32 v[186:187], v[162:163], v[162:163]
    v_pk_fma_f32 v[184:185], v[184:185], v[168:169], v[170:171]
    s_add_u32 s77, s77, 7168
    s_cmp_eq_u32 s77, 114688
    s_cselect_b32 s77, 0, s77
    s_add_u32 s74, s92, s77
    buffer_load_dwordx4 v[72:75], v1, s[16:19], s74 offen sc1
    v_pk_fma_f32 v[186:187], v[186:187], v[168:169], v[170:171]
    v_pk_mul_f32 v[184:185], v[184:185], v[160:161]
    v_pk_mul_f32 v[186:187], v[186:187], v[162:163]
    v_exp_f32 v184, v184
    v_exp_f32 v186, v186
    v_exp_f32 v185, v185
    v_exp_f32 v187, v187
    v_pk_add_f32 v[184:185], v[184:185], 1.0 op_sel_hi:[1,0]
    v_pk_add_f32 v[186:187], v[186:187], 1.0 op_sel_hi:[1,0]
    v_rcp_f32 v184, v184
    buffer_load_dwordx4 v[76:79], v1, s[16:19], s74 offen offset:1024 sc1
    v_rcp_f32 v186, v186
    v_rcp_f32 v185, v185
    v_rcp_f32 v187, v187
    v_pk_mul_f32 v[160:161], v[160:161], v[184:185]
    v_pk_mul_f32 v[162:163], v[162:163], v[186:187]
    v_pk_mul_f32 v[164:165], v[164:165], v[176:177] op_sel_hi:[1,0]
    v_pk_mul_f32 v[166:167], v[166:167], v[176:177] op_sel_hi:[1,0]
    v_pk_mul_f32 v[180:181], v[164:165], v[164:165]
    v_pk_mul_f32 v[182:183], v[166:167], v[166:167]
    buffer_load_dwordx4 v[80:83], v1, s[16:19], s74 offen offset:2048 sc1
    v_pk_fma_f32 v[180:181], v[180:181], v[168:169], v[170:171]
    v_pk_fma_f32 v[182:183], v[182:183], v[168:169], v[170:171]
    v_pk_mul_f32 v[180:181], v[180:181], v[164:165]
    v_pk_mul_f32 v[182:183], v[182:183], v[166:167]
    v_exp_f32 v180, v180
    v_exp_f32 v182, v182
    v_exp_f32 v181, v181
    v_exp_f32 v183, v183
    v_pk_add_f32 v[180:181], v[180:181], 1.0 op_sel_hi:[1,0]
    buffer_load_dwordx4 v[84:87], v1, s[16:19], s74 offen offset:3072 sc1
    v_pk_add_f32 v[182:183], v[182:183], 1.0 op_sel_hi:[1,0]
    v_rcp_f32 v180, v180
    v_rcp_f32 v182, v182
    v_rcp_f32 v181, v181
    v_rcp_f32 v183, v183
    v_pk_mul_f32 v[164:165], v[164:165], v[180:181]
    v_pk_mul_f32 v[166:167], v[166:167], v[182:183]
    v_cvt_pk_bf16_f32 v226, v140, v141
    v_cvt_pk_bf16_f32 v227, v142, v143
    v_cvt_pk_bf16_f32 v228, v144, v145
    v_cvt_pk_bf16_f32 v229, v146, v147
    v_cvt_pk_bf16_f32 v230, v148, v149
    v_cvt_pk_bf16_f32 v231, v150, v151
    v_cvt_pk_bf16_f32 v232, v152, v153
    v_cvt_pk_bf16_f32 v233, v154, v155
    v_cvt_pk_bf16_f32 v234, v156, v157
    v_cvt_pk_bf16_f32 v235, v158, v159
    v_cvt_pk_bf16_f32 v236, v160, v161
    v_cvt_pk_bf16_f32 v237, v162, v163
    v_cvt_pk_bf16_f32 v238, v164, v165
    v_cvt_pk_bf16_f32 v239, v166, v167
    s_add_u32 s62, s48, 1
    s_and_b32 s62, s62, 3
    s_mul_i32 s62, s62, 21504
    s_add_u32 s62, s62, 0
    v_add_u32 v8, s62, v1
    s_add_u32 s62, s48, 2
    s_and_b32 s62, s62, 3
    s_mul_i32 s62, s62, 21504
    s_add_u32 s62, s62, 7168
    v_add_u32 v9, s62, v1
    s_add_u32 s62, s48, 3
    s_and_b32 s62, s62, 3
    s_mul_i32 s62, s62, 21504
    s_add_u32 s62, s62, 14336
    v_add_u32 v10, s62, v1
    s_waitcnt vmcnt(17)
    v_mfma_f32_16x16x32_bf16 v[100:103], v[16:19], a[0:3], 0
    v_mfma_f32_16x16x32_bf16 v[128:131], v[16:19], a[64:67], 0
    s_add_u32 s75, s74, 4096
    buffer_load_dwordx4 v[88:91], v1, s[16:19], s75 offen sc1
    v_mfma_f32_16x16x32_bf16 v[156:159], v[16:19], a[128:131], 0
    v_mfma_f32_16x16x32_bf16 v[184:187], v[16:19], a[192:195], 0
    buffer_load_dwordx4 v[92:95], v1, s[16:19], s75 offen offset:1024 sc1
    s_waitcnt vmcnt(18)
    v_mfma_f32_16x16x32_bf16 v[104:107], v[20:23], a[0:3], 0
    v_mfma_f32_16x16x32_bf16 v[132:135], v[20:23], a[64:67], 0
    buffer_load_dwordx4 v[96:99], v1, s[16:19], s75 offen offset:2048 sc1
    v_mfma_f32_16x16x32_bf16 v[160:163], v[20:23], a[128:131], 0
    v_mfma_f32_16x16x32_bf16 v[188:191], v[20:23], a[192:195], 0
    s_add_u32 s77, s77, 7168
    s_add_u32 s74, s92, s77
    buffer_load_dwordx4 v[16:19], v1, s[16:19], s74 offen sc1
    s_waitcnt vmcnt(19)
    v_mfma_f32_16x16x32_bf16 v[108:111], v[24:27], a[0:3], 0
    v_mfma_f32_16x16x32_bf16 v[136:139], v[24:27], a[64:67], 0
    buffer_load_dwordx4 v[20:23], v1, s[16:19], s74 offen offset:1024 sc1
    v_mfma_f32_16x16x32_bf16 v[164:167], v[24:27], a[128:131], 0
    v_mfma_f32_16x16x32_bf16 v[192:195], v[24:27], a[192:195], 0
    buffer_load_dwordx4 v[24:27], v1, s[16:19], s74 offen offset:2048 sc1
    s_waitcnt vmcnt(20)
    v_mfma_f32_16x16x32_bf16 v[112:115], v[28:31], a[0:3], 0
    v_mfma_f32_16x16x32_bf16 v[140:143], v[28:31], a[64:67], 0
    v_mfma_f32_16x16x32_bf16 v[168:171], v[28:31], a[128:131], 0
    v_mfma_f32_16x16x32_bf16 v[196:199], v[28:31], a[192:195], 0
    buffer_load_dwordx4 v[28:31], v1, s[16:19], s74 offen offset:3072 sc1
    s_waitcnt vmcnt(20)
    v_mfma_f32_16x16x32_bf16 v[116:119], v[32:35], a[0:3], 0
    s_add_u32 s75, s74, 4096
    v_mfma_f32_16x16x32_bf16 v[144:147], v[32:35], a[64:67], 0
    v_mfma_f32_16x16x32_bf16 v[172:175], v[32:35], a[128:131], 0
    v_mfma_f32_16x16x32_bf16 v[200:203], v[32:35], a[192:195], 0
    buffer_load_dwordx4 v[32:35], v1, s[16:19], s75 offen sc1
    s_waitcnt vmcnt(20)
    v_mfma_f32_16x16x32_bf16 v[120:123], v[36:39], a[0:3], 0
    v_mfma_f32_16x16x32_bf16 v[148:151], v[36:39], a[64:67], 0
    v_mfma_f32_16x16x32_bf16 v[176:179], v[36:39], a[128:131], 0
    v_mfma_f32_16x16x32_bf16 v[204:207], v[36:39], a[192:195], 0
    buffer_load_dwordx4 v[36:39], v1, s[16:19], s75 offen offset:1024 sc1
    s_waitcnt vmcnt(20)
    v_mfma_f32_16x16x32_bf16 v[124:127], v[40:43], a[0:3], 0
    v_mfma_f32_16x16x32_bf16 v[152:155], v[40:43], a[64:67], 0
    v_mfma_f32_16x16x32_bf16 v[180:183], v[40:43], a[128:131], 0
    v_mfma_f32_16x16x32_bf16 v[208:211], v[40:43], a[192:195], 0
    buffer_load_dwordx4 v[40:43], v1, s[16:19], s75 offen offset:2048 sc1
    s_waitcnt vmcnt(20)
    v_mfma_f32_16x16x32_bf16 v[100:103], v[44:47], a[4:7], v[100:103]
    s_add_u32 s77, s77, 7168
    v_mfma_f32_16x16x32_bf16 v[128:131], v[44:47], a[68:71], v[128:131]
    s_cmp_eq_u32 s77, 114688
    v_mfma_f32_16x16x32_bf16 v[156:159], v[44:47], a[132:135], v[156:159]
    s_cselect_b32 s77, 0, s77
    v_mfma_f32_16x16x32_bf16 v[184:187], v[44:47], a[196:199], v[184:187]
    s_add_u32 s74, s92, s77
    buffer_load_dwordx4 v[44:47], v1, s[16:19], s74 offen sc1
    s_waitcnt vmcnt(20)
    v_mfma_f32_16x16x32_bf16 v[104:107], v[48:51], a[4:7], v[104:107]
    v_mfma_f32_16x16x32_bf16 v[132:135], v[48:51], a[68:71], v[132:135]
    v_mfma_f32_16x16x32_bf16 v[160:163], v[48:51], a[132:135], v[160:163]
    v_mfma_f32_16x16x32_bf16 v[188:191], v[48:51], a[196:199], v[188:191]
    buffer_load_dwordx4 v[48:51], v1, s[16:19], s74 offen offset:1024 sc1
    s_waitcnt vmcnt(20)
    v_mfma_f32_16x16x32_bf16 v[108:111], v[52:55], a[4:7], v[108:111]
    v_mfma_f32_16x16x32_bf16 v[136:139], v[52:55], a[68:71], v[136:139]
    v_mfma_f32_16x16x32_bf16 v[164:167], v[52:55], a[132:135], v[164:167]
    v_mfma_f32_16x16x32_bf16 v[192:195], v[52:55], a[196:199], v[192:195]
    buffer_load_dwordx4 v[52:55], v1, s[16:19], s74 offen offset:2048 sc1
    s_waitcnt vmcnt(20)
    v_mfma_f32_16x16x32_bf16 v[112:115], v[56:59], a[4:7], v[112:115]
    v_mfma_f32_16x16x32_bf16 v[140:143], v[56:59], a[68:71], v[140:143]
    v_mfma_f32_16x16x32_bf16 v[168:171], v[56:59], a[132:135], v[168:171]
    v_mfma_f32_16x16x32_bf16 v[196:199], v[56:59], a[196:199], v[196:199]
    buffer_load_dwordx4 v[56:59], v1, s[16:19], s74 offen offset:3072 sc1
    s_waitcnt vmcnt(20)
    v_mfma_f32_16x16x32_bf16 v[116:119], v[60:63], a[4:7], v[116:119]
    s_add_u32 s75, s74, 4096
    v_mfma_f32_16x16x32_bf16 v[144:147], v[60:63], a[68:71], v[144:147]
    v_mfma_f32_16x16x32_bf16 v[172:175], v[60:63], a[132:135], v[172:175]
    v_mfma_f32_16x16x32_bf16 v[200:203], v[60:63], a[196:199], v[200:203]
    buffer_load_dwordx4 v[60:63], v1, s[16:19], s75 offen sc1
    s_waitcnt vmcnt(20)
    v_mfma_f32_16x16x32_bf16 v[120:123], v[64:67], a[4:7], v[120:123]
    v_mfma_f32_16x16x32_bf16 v[148:151], v[64:67], a[68:71], v[148:151]
    v_mfma_f32_16x16x32_bf16 v[176:179], v[64:67], a[132:135], v[176:179]
    v_mfma_f32_16x16x32_bf16 v[204:207], v[64:67], a[196:199], v[204:207]
    buffer_load_dwordx4 v[64:67], v1, s[16:19], s75 offen offset:1024 sc1
    s_waitcnt vmcnt(20)
    v_mfma_f32_16x16x32_bf16 v[124:127], v[68:71], a[4:7], v[124:127]
    v_mfma_f32_16x16x32_bf16 v[152:155], v[68:71], a[68:71], v[152:155]
    v_mfma_f32_16x16x32_bf16 v[180:183], v[68:71], a[132:135], v[180:183]
    v_mfma_f32_16x16x32_bf16 v[208:211], v[68:71], a[196:199], v[208:211]
    buffer_load_dwordx4 v[68:71], v1, s[16:19], s75 offen offset:2048 sc1
    s_waitcnt vmcnt(20)
    v_mfma_f32_16x16x32_bf16 v[100:103], v[72:75], a[8:11], v[100:103]
    s_add_u32 s77, s77, 7168
    v_mfma_f32_16x16x32_bf16 v[128:131], v[72:75], a[72:75], v[128:131]
    s_add_u32 s74, s92, s77
    v_mfma_f32_16x16x32_bf16 v[156:159], v[72:75], a[136:139], v[156:159]
    v_mfma_f32_16x16x32_bf16 v[184:187], v[72:75], a[200:203], v[184:187]
    buffer_load_dwordx4 v[72:75], v1, s[16:19], s74 offen sc1
    s_waitcnt vmcnt(20)
    v_mfma_f32_16x16x32_bf16 v[104:107], v[76:79], a[8:11], v[104:107]
    v_mfma_f32_16x16x32_bf16 v[132:135], v[76:79], a[72:75], v[132:135]
    v_mfma_f32_16x16x32_bf16 v[160:163], v[76:79], a[136:139], v[160:163]
    v_mfma_f32_16x16x32_bf16 v[188:191], v[76:79], a[200:203], v[188:191]
    buffer_load_dwordx4 v[76:79], v1, s[16:19], s74 offen offset:1024 sc1
    s_waitcnt vmcnt(20)
    v_mfma_f32_16x16x32_bf16 v[108:111], v[80:83], a[8:11], v[108:111]
    v_mfma_f32_16x16x32_bf16 v[136:139], v[80:83], a[72:75], v[136:139]
    v_mfma_f32_16x16x32_bf16 v[164:167], v[80:83], a[136:139], v[164:167]
    v_mfma_f32_16x16x32_bf16 v[192:195], v[80:83], a[200:203], v[192:195]
    buffer_load_dwordx4 v[80:83], v1, s[16:19], s74 offen offset:2048 sc1
    s_waitcnt vmcnt(20)
    v_mfma_f32_16x16x32_bf16 v[112:115], v[84:87], a[8:11], v[112:115]
    v_mfma_f32_16x16x32_bf16 v[140:143], v[84:87], a[72:75], v[140:143]
    v_mfma_f32_16x16x32_bf16 v[168:171], v[84:87], a[136:139], v[168:171]
    v_mfma_f32_16x16x32_bf16 v[196:199], v[84:87], a[200:203], v[196:199]
    buffer_load_dwordx4 v[84:87], v1, s[16:19], s74 offen offset:3072 sc1
    s_waitcnt vmcnt(20)
    v_mfma_f32_16x16x32_bf16 v[116:119], v[88:91], a[8:11], v[116:119]
    s_add_u32 s75, s74, 4096
    v_mfma_f32_16x16x32_bf16 v[144:147], v[88:91], a[72:75], v[144:147]
    v_mfma_f32_16x16x32_bf16 v[172:175], v[88:91], a[136:139], v[172:175]
    v_mfma_f32_16x16x32_bf16 v[200:203], v[88:91], a[200:203], v[200:203]
    buffer_load_dwordx4 v[88:91], v1, s[16:19], s75 offen sc1
    s_waitcnt vmcnt(20)
    v_mfma_f32_16x16x32_bf16 v[120:123], v[92:95], a[8:11], v[120:123]
    v_mfma_f32_16x16x32_bf16 v[148:151], v[92:95], a[72:75], v[148:151]
    v_mfma_f32_16x16x32_bf16 v[176:179], v[92:95], a[136:139], v[176:179]
    v_mfma_f32_16x16x32_bf16 v[204:207], v[92:95], a[200:203], v[204:207]
    buffer_load_dwordx4 v[92:95], v1, s[16:19], s75 offen offset:1024 sc1
    s_waitcnt vmcnt(20)
    v_mfma_f32_16x16x32_bf16 v[124:127], v[96:99], a[8:11], v[124:127]
    v_mfma_f32_16x16x32_bf16 v[152:155], v[96:99], a[72:75], v[152:155]
    v_mfma_f32_16x16x32_bf16 v[180:183], v[96:99], a[136:139], v[180:183]
    v_mfma_f32_16x16x32_bf16 v[208:211], v[96:99], a[200:203], v[208:211]
    buffer_load_dwordx4 v[96:99], v1, s[16:19], s75 offen offset:2048 sc1
    s_waitcnt vmcnt(20)
    v_mfma_f32_16x16x32_bf16 v[100:103], v[16:19], a[12:15], v[100:103]
    s_add_u32 s77, s77, 7168
    v_mfma_f32_16x16x32_bf16 v[128:131], v[16:19], a[76:79], v[128:131]
    s_cmp_eq_u32 s77, 114688
    v_mfma_f32_16x16x32_bf16 v[156:159], v[16:19], a[140:143], v[156:159]
    s_cselect_b32 s77, 0, s77
    v_mfma_f32_16x16x32_bf16 v[184:187], v[16:19], a[204:207], v[184:187]
    s_add_u32 s74, s92, s77
    buffer_load_dwordx4 v[16:19], v1, s[16:19], s74 offen sc1
    s_waitcnt vmcnt(20)
    v_mfma_f32_16x16x32_bf16 v[104:107], v[20:23], a[12:15], v[104:107]
    v_mfma_f32_16x16x32_bf16 v[132:135], v[20:23], a[76:79], v[132:135]
    s_mul_i32 s62, s48, 21504
    v_mfma_f32_16x16x32_bf16 v[160:163], v[20:23], a[140:143], v[160:163]
    v_mfma_f32_16x16x32_bf16 v[188:191], v[20:23], a[204:207], v[188:191]
    buffer_load_dwordx4 v[20:23], v1, s[16:19], s74 offen offset:1024 sc1
    s_waitcnt vmcnt(20)
    v_mfma_f32_16x16x32_bf16 v[108:111], v[24:27], a[12:15], v[108:111]
    v_mfma_f32_16x16x32_bf16 v[136:139], v[24:27], a[76:79], v[136:139]
    v_add_u32 v7, s62, v1
    v_mfma_f32_16x16x32_bf16 v[164:167], v[24:27], a[140:143], v[164:167]
    v_mfma_f32_16x16x32_bf16 v[192:195], v[24:27], a[204:207], v[192:195]
    buffer_load_dwordx4 v[24:27], v1, s[16:19], s74 offen offset:2048 sc1
    s_waitcnt vmcnt(20)
    v_mfma_f32_16x16x32_bf16 v[112:115], v[28:31], a[12:15], v[112:115]
    v_mfma_f32_16x16x32_bf16 v[140:143], v[28:31], a[76:79], v[140:143]
    s_mul_i32 s66, s61, 28672
    v_mfma_f32_16x16x32_bf16 v[168:171], v[28:31], a[140:143], v[168:171]
    v_mfma_f32_16x16x32_bf16 v[196:199], v[28:31], a[204:207], v[196:199]
    buffer_load_dwordx4 v[28:31], v1, s[16:19], s74 offen offset:3072 sc1
    s_waitcnt vmcnt(20)
    v_mfma_f32_16x16x32_bf16 v[116:119], v[32:35], a[12:15], v[116:119]
    s_add_u32 s75, s74, 4096
    v_mfma_f32_16x16x32_bf16 v[144:147], v[32:35], a[76:79], v[144:147]
    s_mul_i32 s63, s50, 3584
    v_mfma_f32_16x16x32_bf16 v[172:175], v[32:35], a[140:143], v[172:175]
    v_mfma_f32_16x16x32_bf16 v[200:203], v[32:35], a[204:207], v[200:203]
    buffer_load_dwordx4 v[32:35], v1, s[16:19], s75 offen sc1
    s_waitcnt vmcnt(20)
    v_mfma_f32_16x16x32_bf16 v[120:123], v[36:39], a[12:15], v[120:123]
    v_mfma_f32_16x16x32_bf16 v[148:151], v[36:39], a[76:79], v[148:151]
    s_add_u32 s66, s66, s63
    v_mfma_f32_16x16x32_bf16 v[176:179], v[36:39], a[140:143], v[176:179]
    v_mfma_f32_16x16x32_bf16 v[204:207], v[36:39], a[204:207], v[204:207]
    buffer_load_dwordx4 v[36:39], v1, s[16:19], s75 offen offset:1024 sc1
    s_waitcnt vmcnt(20)
    v_mfma_f32_16x16x32_bf16 v[124:127], v[40:43], a[12:15], v[124:127]
    v_mfma_f32_16x16x32_bf16 v[152:155], v[40:43], a[76:79], v[152:155]
    s_add_u32 s66, s66, 15728640
    v_mfma_f32_16x16x32_bf16 v[180:183], v[40:43], a[140:143], v[180:183]
    v_mfma_f32_16x16x32_bf16 v[208:211], v[40:43], a[204:207], v[208:211]
    buffer_load_dwordx4 v[40:43], v1, s[16:19], s75 offen offset:2048 sc1
    s_waitcnt vmcnt(20)
    v_mfma_f32_16x16x32_bf16 v[100:103], v[44:47], a[16:19], v[100:103]
    s_add_u32 s77, s77, 7168
    v_mfma_f32_16x16x32_bf16 v[128:131], v[44:47], a[80:83], v[128:131]
    s_add_u32 s74, s92, s77
    v_mfma_f32_16x16x32_bf16 v[156:159], v[44:47], a[144:147], v[156:159]
    v_mfma_f32_16x16x32_bf16 v[184:187], v[44:47], a[208:211], v[184:187]
    buffer_load_dwordx4 v[44:47], v1, s[16:19], s74 offen sc1
    s_waitcnt vmcnt(20)
    v_mfma_f32_16x16x32_bf16 v[104:107], v[48:51], a[16:19], v[104:107]
    v_mfma_f32_16x16x32_bf16 v[132:135], v[48:51], a[80:83], v[132:135]
    v_and_b32 v14, 1, v3
    v_mfma_f32_16x16x32_bf16 v[160:163], v[48:51], a[144:147], v[160:163]
    v_mfma_f32_16x16x32_bf16 v[188:191], v[48:51], a[208:211], v[188:191]
    buffer_load_dwordx4 v[48:51], v1, s[16:19], s74 offen offset:1024 sc1
    s_waitcnt vmcnt(20)
    v_mfma_f32_16x16x32_bf16 v[108:111], v[52:55], a[16:19], v[108:111]
    v_mfma_f32_16x16x32_bf16 v[136:139], v[52:55], a[80:83], v[136:139]
    v_cmp_ne_u32 s[68:69], 0, v14
    v_mfma_f32_16x16x32_bf16 v[164:167], v[52:55], a[144:147], v[164:167]
    v_mfma_f32_16x16x32_bf16 v[192:195], v[52:55], a[208:211], v[192:195]
    buffer_load_dwordx4 v[52:55], v1, s[16:19], s74 offen offset:2048 sc1
    s_waitcnt vmcnt(20)
    v_mfma_f32_16x16x32_bf16 v[112:115], v[56:59], a[16:19], v[112:115]
    v_mfma_f32_16x16x32_bf16 v[140:143], v[56:59], a[80:83], v[140:143]
    v_lshrrev_b32 v14, 1, v3
    v_mfma_f32_16x16x32_bf16 v[168:171], v[56:59], a[144:147], v[168:171]
    v_mfma_f32_16x16x32_bf16 v[196:199], v[56:59], a[208:211], v[196:199]
    buffer_load_dwordx4 v[56:59], v1, s[16:19], s74 offen offset:3072 sc1
    s_waitcnt vmcnt(20)
    v_mfma_f32_16x16x32_bf16 v[116:119], v[60:63], a[16:19], v[116:119]
    s_add_u32 s75, s74, 4096
    v_mfma_f32_16x16x32_bf16 v[144:147], v[60:63], a[80:83], v[144:147]
    v_lshlrev_b32 v11, 8, v14
    v_mfma_f32_16x16x32_bf16 v[172:175], v[60:63], a[144:147], v[172:175]
    v_mfma_f32_16x16x32_bf16 v[200:203], v[60:63], a[208:211], v[200:203]
    buffer_load_dwordx4 v[60:63], v1, s[16:19], s75 offen sc1
    s_waitcnt vmcnt(20)
    v_mfma_f32_16x16x32_bf16 v[120:123], v[64:67], a[16:19], v[120:123]
    v_mfma_f32_16x16x32_bf16 v[148:151], v[64:67], a[80:83], v[148:151]
    v_lshl_add_u32 v11, v2, 4, v11
    v_mfma_f32_16x16x32_bf16 v[176:179], v[64:67], a[144:147], v[176:179]
    v_mfma_f32_16x16x32_bf16 v[204:207], v[64:67], a[208:211], v[204:207]
    buffer_load_dwordx4 v[64:67], v1, s[16:19], s75 offen offset:1024 sc1
    s_waitcnt vmcnt(20)
    v_mfma_f32_16x16x32_bf16 v[124:127], v[68:71], a[16:19], v[124:127]
    v_mfma_f32_16x16x32_bf16 v[152:155], v[68:71], a[80:83], v[152:155]
    v_mov_b32 v14, 2130706432
    v_mfma_f32_16x16x32_bf16 v[180:183], v[68:71], a[144:147], v[180:183]
    v_mfma_f32_16x16x32_bf16 v[208:211], v[68:71], a[208:211], v[208:211]
    buffer_load_dwordx4 v[68:71], v1, s[16:19], s75 offen offset:2048 sc1
    s_waitcnt vmcnt(20)
    v_mfma_f32_16x16x32_bf16 v[100:103], v[72:75], a[20:23], v[100:103]
    s_add_u32 s77, s77, 7168
    v_mfma_f32_16x16x32_bf16 v[128:131], v[72:75], a[84:87], v[128:131]
    s_cmp_eq_u32 s77, 114688
    v_mfma_f32_16x16x32_bf16 v[156:159], v[72:75], a[148:151], v[156:159]
    s_cselect_b32 s77, 0, s77
    v_mfma_f32_16x16x32_bf16 v[184:187], v[72:75], a[212:215], v[184:187]
    s_add_u32 s74, s92, s77
    buffer_load_dwordx4 v[72:75], v1, s[16:19], s74 offen sc1
    s_waitcnt vmcnt(20)
    v_mfma_f32_16x16x32_bf16 v[104:107], v[76:79], a[20:23], v[104:107]
    v_mfma_f32_16x16x32_bf16 v[132:135], v[76:79], a[84:87], v[132:135]
    v_cndmask_b32 v11, v11, v14, s[68:69]
    v_mfma_f32_16x16x32_bf16 v[160:163], v[76:79], a[148:151], v[160:163]
    v_mfma_f32_16x16x32_bf16 v[188:191], v[76:79], a[212:215], v[188:191]
    buffer_load_dwordx4 v[76:79], v1, s[16:19], s74 offen offset:1024 sc1
    s_waitcnt vmcnt(20)
    v_mfma_f32_16x16x32_bf16 v[108:111], v[80:83], a[20:23], v[108:111]
    v_mfma_f32_16x16x32_bf16 v[136:139], v[80:83], a[84:87], v[136:139]
    v_lshlrev_b32 v14, 16, v224
    v_mfma_f32_16x16x32_bf16 v[164:167], v[80:83], a[148:151], v[164:167]
    v_mfma_f32_16x16x32_bf16 v[192:195], v[80:83], a[212:215], v[192:195]
    buffer_load_dwordx4 v[80:83], v1, s[16:19], s74 offen offset:2048 sc1
    s_waitcnt vmcnt(20)
    v_mfma_f32_16x16x32_bf16 v[112:115], v[84:87], a[20:23], v[112:115]
    v_mfma_f32_16x16x32_bf16 v[140:143], v[84:87], a[84:87], v[140:143]
    v_mov_b32 v15, v14
    v_mfma_f32_16x16x32_bf16 v[168:171], v[84:87], a[148:151], v[168:171]
    v_mfma_f32_16x16x32_bf16 v[196:199], v[84:87], a[212:215], v[196:199]
    buffer_load_dwordx4 v[84:87], v1, s[16:19], s74 offen offset:3072 sc1
    s_waitcnt vmcnt(20)
    v_mfma_f32_16x16x32_bf16 v[116:119], v[88:91], a[20:23], v[116:119]
    s_add_u32 s75, s74, 4096
    v_mfma_f32_16x16x32_bf16 v[144:147], v[88:91], a[84:87], v[144:147]
    v_mfma_f32_16x16x32_bf16 v[172:175], v[88:91], a[148:151], v[172:175]
    v_mfma_f32_16x16x32_bf16 v[200:203], v[88:91], a[212:215], v[200:203]
    buffer_load_dwordx4 v[88:91], v1, s[16:19], s75 offen sc1
    s_waitcnt vmcnt(20)
    v_mfma_f32_16x16x32_bf16 v[120:123], v[92:95], a[20:23], v[120:123]
    v_mfma_f32_16x16x32_bf16 v[148:151], v[92:95], a[84:87], v[148:151]
    v_mfma_f32_16x16x32_bf16 v[176:179], v[92:95], a[148:151], v[176:179]
    v_mfma_f32_16x16x32_bf16 v[204:207], v[92:95], a[212:215], v[204:207]
    buffer_load_dwordx4 v[92:95], v1, s[16:19], s75 offen offset:1024 sc1
    s_waitcnt vmcnt(20)
    v_mfma_f32_16x16x32_bf16 v[124:127], v[96:99], a[20:23], v[124:127]
    v_mfma_f32_16x16x32_bf16 v[152:155], v[96:99], a[84:87], v[152:155]
    v_mfma_f32_16x16x32_bf16 v[180:183], v[96:99], a[148:151], v[180:183]
    v_mfma_f32_16x16x32_bf16 v[208:211], v[96:99], a[212:215], v[208:211]
    buffer_load_dwordx4 v[96:99], v1, s[16:19], s75 offen offset:2048 sc1
    s_waitcnt vmcnt(20)
    v_mfma_f32_16x16x32_bf16 v[100:103], v[16:19], a[24:27], v[100:103]
    s_add_u32 s77, s77, 7168
    v_mfma_f32_16x16x32_bf16 v[128:131], v[16:19], a[88:91], v[128:131]
    s_add_u32 s74, s92, s77
    v_mfma_f32_16x16x32_bf16 v[156:159], v[16:19], a[152:155], v[156:159]
    v_mfma_f32_16x16x32_bf16 v[184:187], v[16:19], a[216:219], v[184:187]
    buffer_load_dwordx4 v[16:19], v1, s[16:19], s74 offen sc1
    s_waitcnt vmcnt(20)
    v_mfma_f32_16x16x32_bf16 v[104:107], v[20:23], a[24:27], v[104:107]
    v_mfma_f32_16x16x32_bf16 v[132:135], v[20:23], a[88:91], v[132:135]
    v_mfma_f32_16x16x32_bf16 v[160:163], v[20:23], a[152:155], v[160:163]
    v_mfma_f32_16x16x32_bf16 v[188:191], v[20:23], a[216:219], v[188:191]
    buffer_load_dwordx4 v[20:23], v1, s[16:19], s74 offen offset:1024 sc1
    s_waitcnt vmcnt(20)
    v_mfma_f32_16x16x32_bf16 v[108:111], v[24:27], a[24:27], v[108:111]
    v_mfma_f32_16x16x32_bf16 v[136:139], v[24:27], a[88:91], v[136:139]
    v_mfma_f32_16x16x32_bf16 v[164:167], v[24:27], a[152:155], v[164:167]
    v_mfma_f32_16x16x32_bf16 v[192:195], v[24:27], a[216:219], v[192:195]
    buffer_load_dwordx4 v[24:27], v1, s[16:19], s74 offen offset:2048 sc1
    s_waitcnt vmcnt(20)
    v_mfma_f32_16x16x32_bf16 v[112:115], v[28:31], a[24:27], v[112:115]
    v_mfma_f32_16x16x32_bf16 v[140:143], v[28:31], a[88:91], v[140:143]
    v_mfma_f32_16x16x32_bf16 v[168:171], v[28:31], a[152:155], v[168:171]
    v_mfma_f32_16x16x32_bf16 v[196:199], v[28:31], a[216:219], v[196:199]
    buffer_load_dwordx4 v[28:31], v1, s[16:19], s74 offen offset:3072 sc1
    s_waitcnt vmcnt(20)
    v_mfma_f32_16x16x32_bf16 v[116:119], v[32:35], a[24:27], v[116:119]
    s_add_u32 s75, s74, 4096
    v_mfma_f32_16x16x32_bf16 v[144:147], v[32:35], a[88:91], v[144:147]
    v_mfma_f32_16x16x32_bf16 v[172:175], v[32:35], a[152:155], v[172:175]
    v_mfma_f32_16x16x32_bf16 v[200:203], v[32:35], a[216:219], v[200:203]
    buffer_load_dwordx4 v[32:35], v1, s[16:19], s75 offen sc1
    s_waitcnt vmcnt(20)
    v_mfma_f32_16x16x32_bf16 v[120:123], v[36:39], a[24:27], v[120:123]
    v_mfma_f32_16x16x32_bf16 v[148:151], v[36:39], a[88:91], v[148:151]
    v_mfma_f32_16x16x32_bf16 v[176:179], v[36:39], a[152:155], v[176:179]
    v_mfma_f32_16x16x32_bf16 v[204:207], v[36:39], a[216:219], v[204:207]
    buffer_load_dwordx4 v[36:39], v1, s[16:19], s75 offen offset:1024 sc1
    s_waitcnt vmcnt(20)
    v_mfma_f32_16x16x32_bf16 v[124:127], v[40:43], a[24:27], v[124:127]
    v_mfma_f32_16x16x32_bf16 v[152:155], v[40:43], a[88:91], v[152:155]
    v_mfma_f32_16x16x32_bf16 v[180:183], v[40:43], a[152:155], v[180:183]
    v_mfma_f32_16x16x32_bf16 v[208:211], v[40:43], a[216:219], v[208:211]
    buffer_load_dwordx4 v[40:43], v1, s[16:19], s75 offen offset:2048 sc1
    s_waitcnt vmcnt(20)
    v_mfma_f32_16x16x32_bf16 v[100:103], v[44:47], a[28:31], v[100:103]
    s_add_u32 s77, s77, 7168
    v_mfma_f32_16x16x32_bf16 v[128:131], v[44:47], a[92:95], v[128:131]
    s_cmp_eq_u32 s77, 114688
    v_mfma_f32_16x16x32_bf16 v[156:159], v[44:47], a[156:159], v[156:159]
    s_cselect_b32 s77, 0, s77
    v_mfma_f32_16x16x32_bf16 v[184:187], v[44:47], a[220:223], v[184:187]
    s_add_u32 s74, s92, s77
    buffer_load_dwordx4 v[44:47], v1, s[16:19], s74 offen sc1
    s_waitcnt vmcnt(20)
    v_mfma_f32_16x16x32_bf16 v[104:107], v[48:51], a[28:31], v[104:107]
    v_mfma_f32_16x16x32_bf16 v[132:135], v[48:51], a[92:95], v[132:135]
    v_mfma_f32_16x16x32_bf16 v[160:163], v[48:51], a[156:159], v[160:163]
    v_mfma_f32_16x16x32_bf16 v[188:191], v[48:51], a[220:223], v[188:191]
    buffer_load_dwordx4 v[48:51], v1, s[16:19], s74 offen offset:1024 sc1
    s_waitcnt vmcnt(20)
    v_mfma_f32_16x16x32_bf16 v[108:111], v[52:55], a[28:31], v[108:111]
    v_mfma_f32_16x16x32_bf16 v[136:139], v[52:55], a[92:95], v[136:139]
    v_mfma_f32_16x16x32_bf16 v[164:167], v[52:55], a[156:159], v[164:167]
    v_mfma_f32_16x16x32_bf16 v[192:195], v[52:55], a[220:223], v[192:195]
    buffer_load_dwordx4 v[52:55], v1, s[16:19], s74 offen offset:2048 sc1
    s_waitcnt vmcnt(20)
    v_mfma_f32_16x16x32_bf16 v[112:115], v[56:59], a[28:31], v[112:115]
    v_mfma_f32_16x16x32_bf16 v[140:143], v[56:59], a[92:95], v[140:143]
    v_mfma_f32_16x16x32_bf16 v[168:171], v[56:59], a[156:159], v[168:171]
    v_mfma_f32_16x16x32_bf16 v[196:199], v[56:59], a[220:223], v[196:199]
    buffer_load_dwordx4 v[56:59], v1, s[16:19], s74 offen offset:3072 sc1
    s_waitcnt vmcnt(20)
    v_mfma_f32_16x16x32_bf16 v[116:119], v[60:63], a[28:31], v[116:119]
    s_add_u32 s75, s74, 4096
    v_mfma_f32_16x16x32_bf16 v[144:147], v[60:63], a[92:95], v[144:147]
    v_mfma_f32_16x16x32_bf16 v[172:175], v[60:63], a[156:159], v[172:175]
    v_mfma_f32_16x16x32_bf16 v[200:203], v[60:63], a[220:223], v[200:203]
    buffer_load_dwordx4 v[60:63], v1, s[16:19], s75 offen sc1
    s_waitcnt vmcnt(20)
    v_mfma_f32_16x16x32_bf16 v[120:123], v[64:67], a[28:31], v[120:123]
    v_mfma_f32_16x16x32_bf16 v[148:151], v[64:67], a[92:95], v[148:151]
    v_mfma_f32_16x16x32_bf16 v[176:179], v[64:67], a[156:159], v[176:179]
    v_mfma_f32_16x16x32_bf16 v[204:207], v[64:67], a[220:223], v[204:207]
    buffer_load_dwordx4 v[64:67], v1, s[16:19], s75 offen offset:1024 sc1
    s_waitcnt vmcnt(20)
    v_mfma_f32_16x16x32_bf16 v[124:127], v[68:71], a[28:31], v[124:127]
    v_mfma_f32_16x16x32_bf16 v[152:155], v[68:71], a[92:95], v[152:155]
    v_mfma_f32_16x16x32_bf16 v[180:183], v[68:71], a[156:159], v[180:183]
    v_mfma_f32_16x16x32_bf16 v[208:211], v[68:71], a[220:223], v[208:211]
    buffer_load_dwordx4 v[68:71], v1, s[16:19], s75 offen offset:2048 sc1
    s_waitcnt vmcnt(20)
    v_mfma_f32_16x16x32_bf16 v[100:103], v[72:75], a[32:35], v[100:103]
    s_add_u32 s77, s77, 7168
    v_mfma_f32_16x16x32_bf16 v[128:131], v[72:75], a[96:99], v[128:131]
    s_add_u32 s74, s92, s77
    v_mfma_f32_16x16x32_bf16 v[156:159], v[72:75], a[160:163], v[156:159]
    v_mfma_f32_16x16x32_bf16 v[184:187], v[72:75], a[224:227], v[184:187]
    buffer_load_dwordx4 v[72:75], v1, s[16:19], s74 offen sc1
    s_waitcnt vmcnt(20)
    v_mfma_f32_16x16x32_bf16 v[104:107], v[76:79], a[32:35], v[104:107]
    v_mfma_f32_16x16x32_bf16 v[132:135], v[76:79], a[96:99], v[132:135]
    v_mfma_f32_16x16x32_bf16 v[160:163], v[76:79], a[160:163], v[160:163]
    v_mfma_f32_16x16x32_bf16 v[188:191], v[76:79], a[224:227], v[188:191]
    buffer_load_dwordx4 v[76:79], v1, s[16:19], s74 offen offset:1024 sc1
    s_waitcnt vmcnt(20)
    v_mfma_f32_16x16x32_bf16 v[108:111], v[80:83], a[32:35], v[108:111]
    v_mfma_f32_16x16x32_bf16 v[136:139], v[80:83], a[96:99], v[136:139]
    v_mfma_f32_16x16x32_bf16 v[164:167], v[80:83], a[160:163], v[164:167]
    v_mfma_f32_16x16x32_bf16 v[192:195], v[80:83], a[224:227], v[192:195]
    buffer_load_dwordx4 v[80:83], v1, s[16:19], s74 offen offset:2048 sc1
    s_waitcnt vmcnt(20)
    v_mfma_f32_16x16x32_bf16 v[112:115], v[84:87], a[32:35], v[112:115]
    v_mfma_f32_16x16x32_bf16 v[140:143], v[84:87], a[96:99], v[140:143]
    v_mfma_f32_16x16x32_bf16 v[168:171], v[84:87], a[160:163], v[168:171]
    v_mfma_f32_16x16x32_bf16 v[196:199], v[84:87], a[224:227], v[196:199]
    buffer_load_dwordx4 v[84:87], v1, s[16:19], s74 offen offset:3072 sc1
    s_waitcnt vmcnt(20)
    v_mfma_f32_16x16x32_bf16 v[116:119], v[88:91], a[32:35], v[116:119]
    s_add_u32 s75, s74, 4096
    v_mfma_f32_16x16x32_bf16 v[144:147], v[88:91], a[96:99], v[144:147]
    v_mfma_f32_16x16x32_bf16 v[172:175], v[88:91], a[160:163], v[172:175]
    v_mfma_f32_16x16x32_bf16 v[200:203], v[88:91], a[224:227], v[200:203]
    buffer_load_dwordx4 v[88:91], v1, s[16:19], s75 offen sc1
    s_waitcnt vmcnt(20)
    v_mfma_f32_16x16x32_bf16 v[120:123], v[92:95], a[32:35], v[120:123]
    v_mfma_f32_16x16x32_bf16 v[148:151], v[92:95], a[96:99], v[148:151]
    v_mfma_f32_16x16x32_bf16 v[176:179], v[92:95], a[160:163], v[176:179]
    v_mfma_f32_16x16x32_bf16 v[204:207], v[92:95], a[224:227], v[204:207]
    buffer_load_dwordx4 v[92:95], v1, s[16:19], s75 offen offset:1024 sc1
    s_waitcnt vmcnt(20)
    v_mfma_f32_16x16x32_bf16 v[124:127], v[96:99], a[32:35], v[124:127]
    v_mfma_f32_16x16x32_bf16 v[152:155], v[96:99], a[96:99], v[152:155]
    v_mfma_f32_16x16x32_bf16 v[180:183], v[96:99], a[160:163], v[180:183]
    v_mfma_f32_16x16x32_bf16 v[208:211], v[96:99], a[224:227], v[208:211]
    buffer_load_dwordx4 v[96:99], v1, s[16:19], s75 offen offset:2048 sc1
    s_waitcnt vmcnt(20)
    v_mfma_f32_16x16x32_bf16 v[100:103], v[16:19], a[36:39], v[100:103]
    s_add_u32 s77, s77, 7168
    v_mfma_f32_16x16x32_bf16 v[128:131], v[16:19], a[100:103], v[128:131]
    s_cmp_eq_u32 s77, 114688
    v_mfma_f32_16x16x32_bf16 v[156:159], v[16:19], a[164:167], v[156:159]
    s_cselect_b32 s77, 0, s77
    v_mfma_f32_16x16x32_bf16 v[184:187], v[16:19], a[228:231], v[184:187]
    s_add_u32 s74, s92, s77
    buffer_load_dwordx4 v[16:19], v1, s[16:19], s74 offen sc1
    s_waitcnt vmcnt(20)
    v_mfma_f32_16x16x32_bf16 v[104:107], v[20:23], a[36:39], v[104:107]
    v_mfma_f32_16x16x32_bf16 v[132:135], v[20:23], a[100:103], v[132:135]
    v_mfma_f32_16x16x32_bf16 v[160:163], v[20:23], a[164:167], v[160:163]
    v_mfma_f32_16x16x32_bf16 v[188:191], v[20:23], a[228:231], v[188:191]
    buffer_load_dwordx4 v[20:23], v1, s[16:19], s74 offen offset:1024 sc1
    s_waitcnt vmcnt(20)
    v_mfma_f32_16x16x32_bf16 v[108:111], v[24:27], a[36:39], v[108:111]
    v_mfma_f32_16x16x32_bf16 v[136:139], v[24:27], a[100:103], v[136:139]
    v_mfma_f32_16x16x32_bf16 v[164:167], v[24:27], a[164:167], v[164:167]
    v_mfma_f32_16x16x32_bf16 v[192:195], v[24:27], a[228:231], v[192:195]
    buffer_load_dwordx4 v[24:27], v1, s[16:19], s74 offen offset:2048 sc1
    s_waitcnt vmcnt(20)
    v_mfma_f32_16x16x32_bf16 v[112:115], v[28:31], a[36:39], v[112:115]
    v_mfma_f32_16x16x32_bf16 v[140:143], v[28:31], a[100:103], v[140:143]
    v_mfma_f32_16x16x32_bf16 v[168:171], v[28:31], a[164:167], v[168:171]
    v_mfma_f32_16x16x32_bf16 v[196:199], v[28:31], a[228:231], v[196:199]
    buffer_load_dwordx4 v[28:31], v1, s[16:19], s74 offen offset:3072 sc1
    s_waitcnt vmcnt(20)
    v_mfma_f32_16x16x32_bf16 v[116:119], v[32:35], a[36:39], v[116:119]
    s_add_u32 s75, s74, 4096
    v_mfma_f32_16x16x32_bf16 v[144:147], v[32:35], a[100:103], v[144:147]
    v_mfma_f32_16x16x32_bf16 v[172:175], v[32:35], a[164:167], v[172:175]
    v_mfma_f32_16x16x32_bf16 v[200:203], v[32:35], a[228:231], v[200:203]
    buffer_load_dwordx4 v[32:35], v1, s[16:19], s75 offen sc1
    s_waitcnt vmcnt(20)
    v_mfma_f32_16x16x32_bf16 v[120:123], v[36:39], a[36:39], v[120:123]
    v_mfma_f32_16x16x32_bf16 v[148:151], v[36:39], a[100:103], v[148:151]
    v_mfma_f32_16x16x32_bf16 v[176:179], v[36:39], a[164:167], v[176:179]
    v_mfma_f32_16x16x32_bf16 v[204:207], v[36:39], a[228:231], v[204:207]
    buffer_load_dwordx4 v[36:39], v1, s[16:19], s75 offen offset:1024 sc1
    s_waitcnt vmcnt(20)
    v_mfma_f32_16x16x32_bf16 v[124:127], v[40:43], a[36:39], v[124:127]
    v_mfma_f32_16x16x32_bf16 v[152:155], v[40:43], a[100:103], v[152:155]
    v_mfma_f32_16x16x32_bf16 v[180:183], v[40:43], a[164:167], v[180:183]
    v_mfma_f32_16x16x32_bf16 v[208:211], v[40:43], a[228:231], v[208:211]
    buffer_load_dwordx4 v[40:43], v1, s[16:19], s75 offen offset:2048 sc1
    s_waitcnt vmcnt(20)
    v_mfma_f32_16x16x32_bf16 v[100:103], v[44:47], a[40:43], v[100:103]
    s_add_u32 s77, s77, 7168
    v_mfma_f32_16x16x32_bf16 v[128:131], v[44:47], a[104:107], v[128:131]
    s_add_u32 s74, s92, s77
    v_mfma_f32_16x16x32_bf16 v[156:159], v[44:47], a[168:171], v[156:159]
    v_mfma_f32_16x16x32_bf16 v[184:187], v[44:47], a[232:235], v[184:187]
    buffer_load_dwordx4 v[44:47], v1, s[16:19], s74 offen sc1
    s_waitcnt vmcnt(20)
    v_mfma_f32_16x16x32_bf16 v[104:107], v[48:51], a[40:43], v[104:107]
    v_mfma_f32_16x16x32_bf16 v[132:135], v[48:51], a[104:107], v[132:135]
    v_mfma_f32_16x16x32_bf16 v[160:163], v[48:51], a[168:171], v[160:163]
    v_mfma_f32_16x16x32_bf16 v[188:191], v[48:51], a[232:235], v[188:191]
    buffer_load_dwordx4 v[48:51], v1, s[16:19], s74 offen offset:1024 sc1
    s_waitcnt vmcnt(20)
    v_mfma_f32_16x16x32_bf16 v[108:111], v[52:55], a[40:43], v[108:111]
    v_mfma_f32_16x16x32_bf16 v[136:139], v[52:55], a[104:107], v[136:139]
    v_mfma_f32_16x16x32_bf16 v[164:167], v[52:55], a[168:171], v[164:167]
    v_mfma_f32_16x16x32_bf16 v[192:195], v[52:55], a[232:235], v[192:195]
    buffer_load_dwordx4 v[52:55], v1, s[16:19], s74 offen offset:2048 sc1
    s_waitcnt vmcnt(20)
    v_mfma_f32_16x16x32_bf16 v[112:115], v[56:59], a[40:43], v[112:115]
    v_mfma_f32_16x16x32_bf16 v[140:143], v[56:59], a[104:107], v[140:143]
    v_mfma_f32_16x16x32_bf16 v[168:171], v[56:59], a[168:171], v[168:171]
    v_mfma_f32_16x16x32_bf16 v[196:199], v[56:59], a[232:235], v[196:199]
    buffer_load_dwordx4 v[56:59], v1, s[16:19], s74 offen offset:3072 sc1
    s_waitcnt vmcnt(20)
    v_mfma_f32_16x16x32_bf16 v[116:119], v[60:63], a[40:43], v[116:119]
    s_add_u32 s75, s74, 4096
    v_mfma_f32_16x16x32_bf16 v[144:147], v[60:63], a[104:107], v[144:147]
    v_mfma_f32_16x16x32_bf16 v[172:175], v[60:63], a[168:171], v[172:175]
    v_mfma_f32_16x16x32_bf16 v[200:203], v[60:63], a[232:235], v[200:203]
    buffer_load_dwordx4 v[60:63], v1, s[16:19], s75 offen sc1
    s_waitcnt vmcnt(20)
    v_mfma_f32_16x16x32_bf16 v[120:123], v[64:67], a[40:43], v[120:123]
    v_mfma_f32_16x16x32_bf16 v[148:151], v[64:67], a[104:107], v[148:151]
    v_mfma_f32_16x16x32_bf16 v[176:179], v[64:67], a[168:171], v[176:179]
    v_mfma_f32_16x16x32_bf16 v[204:207], v[64:67], a[232:235], v[204:207]
    buffer_load_dwordx4 v[64:67], v1, s[16:19], s75 offen offset:1024 sc1
    s_waitcnt vmcnt(20)
    v_mfma_f32_16x16x32_bf16 v[124:127], v[68:71], a[40:43], v[124:127]
    v_mfma_f32_16x16x32_bf16 v[152:155], v[68:71], a[104:107], v[152:155]
    v_mfma_f32_16x16x32_bf16 v[180:183], v[68:71], a[168:171], v[180:183]
    v_mfma_f32_16x16x32_bf16 v[208:211], v[68:71], a[232:235], v[208:211]
    buffer_load_dwordx4 v[68:71], v1, s[16:19], s75 offen offset:2048 sc1
    s_waitcnt vmcnt(20)
    v_mfma_f32_16x16x32_bf16 v[100:103], v[72:75], a[44:47], v[100:103]
    s_add_u32 s77, s77, 7168
    v_mfma_f32_16x16x32_bf16 v[128:131], v[72:75], a[108:111], v[128:131]
    s_cmp_eq_u32 s77, 114688
    v_mfma_f32_16x16x32_bf16 v[156:159], v[72:75], a[172:175], v[156:159]
    s_cselect_b32 s77, 0, s77
    v_mfma_f32_16x16x32_bf16 v[184:187], v[72:75], a[236:239], v[184:187]
    s_add_u32 s74, s92, s77
    buffer_load_dwordx4 v[72:75], v1, s[16:19], s74 offen sc1
    s_waitcnt vmcnt(20)
    v_mfma_f32_16x16x32_bf16 v[104:107], v[76:79], a[44:47], v[104:107]
    v_mfma_f32_16x16x32_bf16 v[132:135], v[76:79], a[108:111], v[132:135]
    v_mfma_f32_16x16x32_bf16 v[160:163], v[76:79], a[172:175], v[160:163]
    v_mfma_f32_16x16x32_bf16 v[188:191], v[76:79], a[236:239], v[188:191]
    buffer_load_dwordx4 v[76:79], v1, s[16:19], s74 offen offset:1024 sc1
    s_waitcnt vmcnt(20)
    v_mfma_f32_16x16x32_bf16 v[108:111], v[80:83], a[44:47], v[108:111]
    v_mfma_f32_16x16x32_bf16 v[136:139], v[80:83], a[108:111], v[136:139]
    v_mfma_f32_16x16x32_bf16 v[164:167], v[80:83], a[172:175], v[164:167]
    v_mfma_f32_16x16x32_bf16 v[192:195], v[80:83], a[236:239], v[192:195]
    buffer_load_dwordx4 v[80:83], v1, s[16:19], s74 offen offset:2048 sc1
    s_waitcnt vmcnt(20)
    v_mfma_f32_16x16x32_bf16 v[112:115], v[84:87], a[44:47], v[112:115]
    v_mfma_f32_16x16x32_bf16 v[140:143], v[84:87], a[108:111], v[140:143]
    v_mfma_f32_16x16x32_bf16 v[168:171], v[84:87], a[172:175], v[168:171]
    v_mfma_f32_16x16x32_bf16 v[196:199], v[84:87], a[236:239], v[196:199]
    buffer_load_dwordx4 v[84:87], v1, s[16:19], s74 offen offset:3072 sc1
    s_waitcnt vmcnt(20)
    v_mfma_f32_16x16x32_bf16 v[116:119], v[88:91], a[44:47], v[116:119]
    s_add_u32 s75, s74, 4096
    v_mfma_f32_16x16x32_bf16 v[144:147], v[88:91], a[108:111], v[144:147]
    v_mfma_f32_16x16x32_bf16 v[172:175], v[88:91], a[172:175], v[172:175]
    v_mfma_f32_16x16x32_bf16 v[200:203], v[88:91], a[236:239], v[200:203]
    buffer_load_dwordx4 v[88:91], v1, s[16:19], s75 offen sc1
    s_waitcnt vmcnt(20)
    v_mfma_f32_16x16x32_bf16 v[120:123], v[92:95], a[44:47], v[120:123]
    v_mfma_f32_16x16x32_bf16 v[148:151], v[92:95], a[108:111], v[148:151]
    v_mfma_f32_16x16x32_bf16 v[176:179], v[92:95], a[172:175], v[176:179]
    v_mfma_f32_16x16x32_bf16 v[204:207], v[92:95], a[236:239], v[204:207]
    buffer_load_dwordx4 v[92:95], v1, s[16:19], s75 offen offset:1024 sc1
    s_waitcnt vmcnt(20)
    v_mfma_f32_16x16x32_bf16 v[124:127], v[96:99], a[44:47], v[124:127]
    v_mfma_f32_16x16x32_bf16 v[152:155], v[96:99], a[108:111], v[152:155]
    v_mfma_f32_16x16x32_bf16 v[180:183], v[96:99], a[172:175], v[180:183]
    v_mfma_f32_16x16x32_bf16 v[208:211], v[96:99], a[236:239], v[208:211]
    buffer_load_dwordx4 v[96:99], v1, s[16:19], s75 offen offset:2048 sc1
    s_waitcnt vmcnt(20)
    v_mfma_f32_16x16x32_bf16 v[100:103], v[16:19], a[48:51], v[100:103]
    s_add_u32 s77, s77, 7168
    v_mfma_f32_16x16x32_bf16 v[128:131], v[16:19], a[112:115], v[128:131]
    s_add_u32 s74, s92, s77
    v_mfma_f32_16x16x32_bf16 v[156:159], v[16:19], a[176:179], v[156:159]
    v_mfma_f32_16x16x32_bf16 v[184:187], v[16:19], a[240:243], v[184:187]
    buffer_load_dwordx4 v[16:19], v1, s[16:19], s74 offen sc1
    s_waitcnt vmcnt(20)
    v_mfma_f32_16x16x32_bf16 v[104:107], v[20:23], a[48:51], v[104:107]
    v_mfma_f32_16x16x32_bf16 v[132:135], v[20:23], a[112:115], v[132:135]
    v_mfma_f32_16x16x32_bf16 v[160:163], v[20:23], a[176:179], v[160:163]
    v_mfma_f32_16x16x32_bf16 v[188:191], v[20:23], a[240:243], v[188:191]
    buffer_load_dwordx4 v[20:23], v1, s[16:19], s74 offen offset:1024 sc1
    s_waitcnt vmcnt(20)
    v_mfma_f32_16x16x32_bf16 v[108:111], v[24:27], a[48:51], v[108:111]
    v_mfma_f32_16x16x32_bf16 v[136:139], v[24:27], a[112:115], v[136:139]
    v_mfma_f32_16x16x32_bf16 v[164:167], v[24:27], a[176:179], v[164:167]
    v_mfma_f32_16x16x32_bf16 v[192:195], v[24:27], a[240:243], v[192:195]
    buffer_load_dwordx4 v[24:27], v1, s[16:19], s74 offen offset:2048 sc1
    s_waitcnt vmcnt(20)
    v_mfma_f32_16x16x32_bf16 v[112:115], v[28:31], a[48:51], v[112:115]
    v_mfma_f32_16x16x32_bf16 v[140:143], v[28:31], a[112:115], v[140:143]
    v_mfma_f32_16x16x32_bf16 v[168:171], v[28:31], a[176:179], v[168:171]
    v_mfma_f32_16x16x32_bf16 v[196:199], v[28:31], a[240:243], v[196:199]
    buffer_load_dwordx4 v[28:31], v1, s[16:19], s74 offen offset:3072 sc1
    s_waitcnt vmcnt(20)
    v_mfma_f32_16x16x32_bf16 v[116:119], v[32:35], a[48:51], v[116:119]
    s_add_u32 s75, s74, 4096
    v_mfma_f32_16x16x32_bf16 v[144:147], v[32:35], a[112:115], v[144:147]
    v_mfma_f32_16x16x32_bf16 v[172:175], v[32:35], a[176:179], v[172:175]
    v_mfma_f32_16x16x32_bf16 v[200:203], v[32:35], a[240:243], v[200:203]
    buffer_load_dwordx4 v[32:35], v1, s[16:19], s75 offen sc1
    s_waitcnt vmcnt(20)
    v_mfma_f32_16x16x32_bf16 v[120:123], v[36:39], a[48:51], v[120:123]
    v_mfma_f32_16x16x32_bf16 v[148:151], v[36:39], a[112:115], v[148:151]
    v_mfma_f32_16x16x32_bf16 v[176:179], v[36:39], a[176:179], v[176:179]
    v_mfma_f32_16x16x32_bf16 v[204:207], v[36:39], a[240:243], v[204:207]
    buffer_load_dwordx4 v[36:39], v1, s[16:19], s75 offen offset:1024 sc1
    s_waitcnt vmcnt(20)
    v_mfma_f32_16x16x32_bf16 v[124:127], v[40:43], a[48:51], v[124:127]
    v_mfma_f32_16x16x32_bf16 v[152:155], v[40:43], a[112:115], v[152:155]
    v_mfma_f32_16x16x32_bf16 v[180:183], v[40:43], a[176:179], v[180:183]
    v_mfma_f32_16x16x32_bf16 v[208:211], v[40:43], a[240:243], v[208:211]
    buffer_load_dwordx4 v[40:43], v1, s[16:19], s75 offen offset:2048 sc1
    s_waitcnt vmcnt(20)
    v_mfma_f32_16x16x32_bf16 v[100:103], v[44:47], a[52:55], v[100:103]
    s_waitcnt vmcnt(19)
    v_mfma_f32_16x16x32_bf16 v[104:107], v[48:51], a[52:55], v[104:107]
    s_waitcnt vmcnt(18)
    v_mfma_f32_16x16x32_bf16 v[108:111], v[52:55], a[52:55], v[108:111]
    s_waitcnt vmcnt(17)
    v_mfma_f32_16x16x32_bf16 v[112:115], v[56:59], a[52:55], v[112:115]
    s_waitcnt vmcnt(16)
    v_mfma_f32_16x16x32_bf16 v[116:119], v[60:63], a[52:55], v[116:119]
    s_waitcnt vmcnt(15)
    v_mfma_f32_16x16x32_bf16 v[120:123], v[64:67], a[52:55], v[120:123]
    s_waitcnt vmcnt(14)
    v_mfma_f32_16x16x32_bf16 v[124:127], v[68:71], a[52:55], v[124:127]
    s_waitcnt vmcnt(13)
    v_mfma_f32_16x16x32_bf16 v[100:103], v[72:75], a[56:59], v[100:103]
    s_waitcnt vmcnt(12)
    v_mfma_f32_16x16x32_bf16 v[104:107], v[76:79], a[56:59], v[104:107]
    s_waitcnt vmcnt(11)
    v_mfma_f32_16x16x32_bf16 v[108:111], v[80:83], a[56:59], v[108:111]
    s_waitcnt vmcnt(10)
    v_mfma_f32_16x16x32_bf16 v[112:115], v[84:87], a[56:59], v[112:115]
    s_waitcnt vmcnt(9)
    v_mfma_f32_16x16x32_bf16 v[116:119], v[88:91], a[56:59], v[116:119]
    s_waitcnt vmcnt(8)
    v_mfma_f32_16x16x32_bf16 v[120:123], v[92:95], a[56:59], v[120:123]
    s_waitcnt vmcnt(7)
    v_mfma_f32_16x16x32_bf16 v[124:127], v[96:99], a[56:59], v[124:127]
    s_waitcnt vmcnt(6)
    v_mfma_f32_16x16x32_bf16 v[100:103], v[16:19], a[60:63], v[100:103]
    s_waitcnt vmcnt(5)
    v_mfma_f32_16x16x32_bf16 v[104:107], v[20:23], a[60:63], v[104:107]
    s_waitcnt vmcnt(4)
    v_mfma_f32_16x16x32_bf16 v[108:111], v[24:27], a[60:63], v[108:111]
    s_waitcnt vmcnt(3)
    v_mfma_f32_16x16x32_bf16 v[112:115], v[28:31], a[60:63], v[112:115]
    s_waitcnt vmcnt(2)
    v_mfma_f32_16x16x32_bf16 v[116:119], v[32:35], a[60:63], v[116:119]
    s_waitcnt vmcnt(1)
    v_mfma_f32_16x16x32_bf16 v[120:123], v[36:39], a[60:63], v[120:123]
    s_waitcnt vmcnt(0)
    v_mfma_f32_16x16x32_bf16 v[124:127], v[40:43], a[60:63], v[124:127]
    v_mfma_f32_16x16x32_bf16 v[128:131], v[44:47], a[116:119], v[128:131]
    v_mfma_f32_16x16x32_bf16 v[132:135], v[48:51], a[116:119], v[132:135]
    ds_write_b128 v8, v[100:103]
    v_mfma_f32_16x16x32_bf16 v[136:139], v[52:55], a[116:119], v[136:139]
    v_mfma_f32_16x16x32_bf16 v[140:143], v[56:59], a[116:119], v[140:143]
    v_mfma_f32_16x16x32_bf16 v[144:147], v[60:63], a[116:119], v[144:147]
    ds_write_b128 v8, v[104:107] offset:1024
    v_mfma_f32_16x16x32_bf16 v[148:151], v[64:67], a[116:119], v[148:151]
    v_mfma_f32_16x16x32_bf16 v[152:155], v[68:71], a[116:119], v[152:155]
    v_mfma_f32_16x16x32_bf16 v[128:131], v[72:75], a[120:123], v[128:131]
    ds_write_b128 v8, v[108:111] offset:2048
    v_mfma_f32_16x16x32_bf16 v[132:135], v[76:79], a[120:123], v[132:135]
    v_mfma_f32_16x16x32_bf16 v[136:139], v[80:83], a[120:123], v[136:139]
    v_mfma_f32_16x16x32_bf16 v[140:143], v[84:87], a[120:123], v[140:143]
    ds_write_b128 v8, v[112:115] offset:3072
    v_mfma_f32_16x16x32_bf16 v[144:147], v[88:91], a[120:123], v[144:147]
    v_mfma_f32_16x16x32_bf16 v[148:151], v[92:95], a[120:123], v[148:151]
    v_mfma_f32_16x16x32_bf16 v[152:155], v[96:99], a[120:123], v[152:155]
    ds_write_b128 v8, v[116:119] offset:4096
    v_mfma_f32_16x16x32_bf16 v[128:131], v[16:19], a[124:127], v[128:131]
    v_mfma_f32_16x16x32_bf16 v[132:135], v[20:23], a[124:127], v[132:135]
    v_mfma_f32_16x16x32_bf16 v[136:139], v[24:27], a[124:127], v[136:139]
    ds_write_b128 v8, v[120:123] offset:5120
    v_mfma_f32_16x16x32_bf16 v[140:143], v[28:31], a[124:127], v[140:143]
    v_mfma_f32_16x16x32_bf16 v[144:147], v[32:35], a[124:127], v[144:147]
    v_mfma_f32_16x16x32_bf16 v[148:151], v[36:39], a[124:127], v[148:151]
    ds_write_b128 v8, v[124:127] offset:6144
    v_mfma_f32_16x16x32_bf16 v[152:155], v[40:43], a[124:127], v[152:155]
    v_mfma_f32_16x16x32_bf16 v[156:159], v[44:47], a[180:183], v[156:159]
    v_mfma_f32_16x16x32_bf16 v[160:163], v[48:51], a[180:183], v[160:163]
    ds_write_b128 v9, v[128:131]
    v_mfma_f32_16x16x32_bf16 v[164:167], v[52:55], a[180:183], v[164:167]
    v_mfma_f32_16x16x32_bf16 v[168:171], v[56:59], a[180:183], v[168:171]
    v_mfma_f32_16x16x32_bf16 v[172:175], v[60:63], a[180:183], v[172:175]
    ds_write_b128 v9, v[132:135] offset:1024
    v_mfma_f32_16x16x32_bf16 v[176:179], v[64:67], a[180:183], v[176:179]
    v_mfma_f32_16x16x32_bf16 v[180:183], v[68:71], a[180:183], v[180:183]
    v_mfma_f32_16x16x32_bf16 v[156:159], v[72:75], a[184:187], v[156:159]
    ds_write_b128 v9, v[136:139] offset:2048
    v_mfma_f32_16x16x32_bf16 v[160:163], v[76:79], a[184:187], v[160:163]
    v_mfma_f32_16x16x32_bf16 v[164:167], v[80:83], a[184:187], v[164:167]
    v_mfma_f32_16x16x32_bf16 v[168:171], v[84:87], a[184:187], v[168:171]
    ds_write_b128 v9, v[140:143] offset:3072
    v_mfma_f32_16x16x32_bf16 v[172:175], v[88:91], a[184:187], v[172:175]
    v_mfma_f32_16x16x32_bf16 v[176:179], v[92:95], a[184:187], v[176:179]
    v_mfma_f32_16x16x32_bf16 v[180:183], v[96:99], a[184:187], v[180:183]
    ds_write_b128 v9, v[144:147] offset:4096
    v_mfma_f32_16x16x32_bf16 v[156:159], v[16:19], a[188:191], v[156:159]
    v_mfma_f32_16x16x32_bf16 v[160:163], v[20:23], a[188:191], v[160:163]
    v_mfma_f32_16x16x32_bf16 v[164:167], v[24:27], a[188:191], v[164:167]
    ds_write_b128 v9, v[148:151] offset:5120
    v_mfma_f32_16x16x32_bf16 v[168:171], v[28:31], a[188:191], v[168:171]
    v_mfma_f32_16x16x32_bf16 v[172:175], v[32:35], a[188:191], v[172:175]
    v_mfma_f32_16x16x32_bf16 v[176:179], v[36:39], a[188:191], v[176:179]
    ds_write_b128 v9, v[152:155] offset:6144
    v_mfma_f32_16x16x32_bf16 v[180:183], v[40:43], a[188:191], v[180:183]
    v_mfma_f32_16x16x32_bf16 v[184:187], v[44:47], a[244:247], v[184:187]
    v_mfma_f32_16x16x32_bf16 v[188:191], v[48:51], a[244:247], v[188:191]
    ds_write_b128 v10, v[156:159]
    v_mfma_f32_16x16x32_bf16 v[192:195], v[52:55], a[244:247], v[192:195]
    v_mfma_f32_16x16x32_bf16 v[196:199], v[56:59], a[244:247], v[196:199]
    v_mfma_f32_16x16x32_bf16 v[200:203], v[60:63], a[244:247], v[200:203]
    ds_write_b128 v10, v[160:163] offset:1024
    v_mfma_f32_16x16x32_bf16 v[204:207], v[64:67], a[244:247], v[204:207]
    v_mfma_f32_16x16x32_bf16 v[208:211], v[68:71], a[244:247], v[208:211]
    v_mfma_f32_16x16x32_bf16 v[184:187], v[72:75], a[248:251], v[184:187]
    ds_write_b128 v10, v[164:167] offset:2048
    v_mfma_f32_16x16x32_bf16 v[188:191], v[76:79], a[248:251], v[188:191]
    v_mfma_f32_16x16x32_bf16 v[192:195], v[80:83], a[248:251], v[192:195]
    v_mfma_f32_16x16x32_bf16 v[196:199], v[84:87], a[248:251], v[196:199]
    ds_write_b128 v10, v[168:171] offset:3072
    v_mfma_f32_16x16x32_bf16 v[200:203], v[88:91], a[248:251], v[200:203]
    v_mfma_f32_16x16x32_bf16 v[204:207], v[92:95], a[248:251], v[204:207]
    v_mfma_f32_16x16x32_bf16 v[208:211], v[96:99], a[248:251], v[208:211]
    ds_write_b128 v10, v[172:175] offset:4096
    v_mfma_f32_16x16x32_bf16 v[184:187], v[16:19], a[252:255], v[184:187]
    v_mfma_f32_16x16x32_bf16 v[188:191], v[20:23], a[252:255], v[188:191]
    v_mfma_f32_16x16x32_bf16 v[192:195], v[24:27], a[252:255], v[192:195]
    ds_write_b128 v10, v[176:179] offset:5120
    v_mfma_f32_16x16x32_bf16 v[196:199], v[28:31], a[252:255], v[196:199]
    v_mfma_f32_16x16x32_bf16 v[200:203], v[32:35], a[252:255], v[200:203]
    v_mfma_f32_16x16x32_bf16 v[204:207], v[36:39], a[252:255], v[204:207]
    ds_write_b128 v10, v[180:183] offset:6144
    v_mfma_f32_16x16x32_bf16 v[208:211], v[40:43], a[252:255], v[208:211]
    s_waitcnt lgkmcnt(0)
    s_barrier
    ds_read_b128 v[16:19], v7
    ds_read_b128 v[44:47], v7 offset:7168
    ds_read_b128 v[72:75], v7 offset:14336
    ds_read_b128 v[20:23], v7 offset:1024
    ds_read_b128 v[48:51], v7 offset:8192
    ds_read_b128 v[76:79], v7 offset:15360
    ds_read_b128 v[24:27], v7 offset:2048
    ds_read_b128 v[52:55], v7 offset:9216
    ds_read_b128 v[80:83], v7 offset:16384
    ds_read_b128 v[28:31], v7 offset:3072
    ds_read_b128 v[56:59], v7 offset:10240
    ds_read_b128 v[84:87], v7 offset:17408
    ds_read_b128 v[32:35], v7 offset:4096
    ds_read_b128 v[60:63], v7 offset:11264
    ds_read_b128 v[88:91], v7 offset:18432
    ds_read_b128 v[36:39], v7 offset:5120
    ds_read_b128 v[64:67], v7 offset:12288
    ds_read_b128 v[92:95], v7 offset:19456
    ds_read_b128 v[40:43], v7 offset:6144
    ds_read_b128 v[68:71], v7 offset:13312
    ds_read_b128 v[96:99], v7 offset:20480
    v_pk_add_f32 v[184:185], v[184:185], v[14:15]
    v_pk_add_f32 v[186:187], v[186:187], v[14:15]
    v_pk_add_f32 v[188:189], v[188:189], v[14:15]
    v_pk_add_f32 v[190:191], v[190:191], v[14:15]
    v_pk_add_f32 v[192:193], v[192:193], v[14:15]
    v_pk_add_f32 v[194:195], v[194:195], v[14:15]
    v_pk_add_f32 v[196:197], v[196:197], v[14:15]
    v_pk_add_f32 v[198:199], v[198:199], v[14:15]
    v_pk_add_f32 v[200:201], v[200:201], v[14:15]
    v_pk_add_f32 v[202:203], v[202:203], v[14:15]
    v_pk_add_f32 v[204:205], v[204:205], v[14:15]
    v_pk_add_f32 v[206:207], v[206:207], v[14:15]
    v_pk_add_f32 v[208:209], v[208:209], v[14:15]
    v_pk_add_f32 v[210:211], v[210:211], v[14:15]
    v_lshlrev_b32 v116, 16, v226
    v_and_b32 v117, 0xffff0000, v226
    v_lshlrev_b32 v118, 16, v227
    v_and_b32 v119, 0xffff0000, v227
    v_lshlrev_b32 v120, 16, v228
    v_and_b32 v121, 0xffff0000, v228
    v_lshlrev_b32 v122, 16, v229
    v_and_b32 v123, 0xffff0000, v229
    v_lshlrev_b32 v124, 16, v230
    v_and_b32 v125, 0xffff0000, v230
    v_lshlrev_b32 v126, 16, v231
    v_and_b32 v127, 0xffff0000, v231
    v_lshlrev_b32 v128, 16, v232
    v_and_b32 v129, 0xffff0000, v232
    v_lshlrev_b32 v130, 16, v233
    v_and_b32 v131, 0xffff0000, v233
    v_lshlrev_b32 v132, 16, v234
    v_and_b32 v133, 0xffff0000, v234
    v_lshlrev_b32 v134, 16, v235
    v_and_b32 v135, 0xffff0000, v235
    v_lshlrev_b32 v136, 16, v236
    v_and_b32 v137, 0xffff0000, v236
    v_lshlrev_b32 v138, 16, v237
    v_and_b32 v139, 0xffff0000, v237
    v_lshlrev_b32 v140, 16, v238
    v_and_b32 v141, 0xffff0000, v238
    v_lshlrev_b32 v142, 16, v239
    v_and_b32 v143, 0xffff0000, v239
    s_waitcnt lgkmcnt(15)
    v_pk_add_f32 v[184:185], v[184:185], v[16:17]
    v_pk_add_f32 v[186:187], v[186:187], v[18:19]
    v_pk_add_f32 v[188:189], v[188:189], v[20:21]
    v_pk_add_f32 v[190:191], v[190:191], v[22:23]
    v_pk_add_f32 v[184:185], v[184:185], v[44:45]
    v_pk_add_f32 v[186:187], v[186:187], v[46:47]
    v_pk_add_f32 v[188:189], v[188:189], v[48:49]
    v_pk_add_f32 v[190:191], v[190:191], v[50:51]
    v_pk_add_f32 v[184:185], v[184:185], v[72:73]
    v_pk_add_f32 v[186:187], v[186:187], v[74:75]
    v_pk_add_f32 v[188:189], v[188:189], v[76:77]
    v_pk_add_f32 v[190:191], v[190:191], v[78:79]
    v_pk_mul_f32 v[184:185], v[184:185], v[116:117]
    v_pk_mul_f32 v[186:187], v[186:187], v[118:119]
    v_pk_mul_f32 v[188:189], v[188:189], v[120:121]
    v_pk_mul_f32 v[190:191], v[190:191], v[122:123]
    v_cvt_pk_bf16_f32 v100, v184, v185
    v_cvt_pk_bf16_f32 v101, v186, v187
    v_cvt_pk_bf16_f32 v102, v188, v189
    v_cvt_pk_bf16_f32 v103, v190, v191
    v_min_u32 v100, -2, v100
    buffer_store_dwordx4 v[100:103], v1, s[16:19], s66 offen sc1
    s_waitcnt lgkmcnt(14)
    v_pk_add_f32 v[192:193], v[192:193], v[24:25]
    v_pk_add_f32 v[194:195], v[194:195], v[26:27]
    s_waitcnt lgkmcnt(11)
    v_pk_add_f32 v[196:197], v[196:197], v[28:29]
    v_pk_add_f32 v[198:199], v[198:199], v[30:31]
    v_pk_add_f32 v[192:193], v[192:193], v[52:53]
    v_pk_add_f32 v[194:195], v[194:195], v[54:55]
    s_waitcnt lgkmcnt(10)
    v_pk_add_f32 v[196:197], v[196:197], v[56:57]
    v_pk_add_f32 v[198:199], v[198:199], v[58:59]
    v_pk_add_f32 v[192:193], v[192:193], v[80:81]
    v_pk_add_f32 v[194:195], v[194:195], v[82:83]
    s_waitcnt lgkmcnt(9)
    v_pk_add_f32 v[196:197], v[196:197], v[84:85]
    v_pk_add_f32 v[198:199], v[198:199], v[86:87]
    v_pk_mul_f32 v[192:193], v[192:193], v[124:125]
    v_pk_mul_f32 v[194:195], v[194:195], v[126:127]
    v_pk_mul_f32 v[196:197], v[196:197], v[128:129]
    v_pk_mul_f32 v[198:199], v[198:199], v[130:131]
    v_cvt_pk_bf16_f32 v104, v192, v193
    v_cvt_pk_bf16_f32 v105, v194, v195
    v_cvt_pk_bf16_f32 v106, v196, v197
    v_cvt_pk_bf16_f32 v107, v198, v199
    v_min_u32 v104, -2, v104
    buffer_store_dwordx4 v[104:107], v1, s[16:19], s66 offen offset:1024 sc1
    s_waitcnt lgkmcnt(8)
    v_pk_add_f32 v[200:201], v[200:201], v[32:33]
    v_pk_add_f32 v[202:203], v[202:203], v[34:35]
    s_waitcnt lgkmcnt(5)
    v_pk_add_f32 v[204:205], v[204:205], v[36:37]
    v_pk_add_f32 v[206:207], v[206:207], v[38:39]
    v_pk_add_f32 v[200:201], v[200:201], v[60:61]
    v_pk_add_f32 v[202:203], v[202:203], v[62:63]
    s_waitcnt lgkmcnt(4)
    v_pk_add_f32 v[204:205], v[204:205], v[64:65]
    v_pk_add_f32 v[206:207], v[206:207], v[66:67]
    v_pk_add_f32 v[200:201], v[200:201], v[88:89]
    v_pk_add_f32 v[202:203], v[202:203], v[90:91]
    s_waitcnt lgkmcnt(3)
    v_pk_add_f32 v[204:205], v[204:205], v[92:93]
    v_pk_add_f32 v[206:207], v[206:207], v[94:95]
    v_pk_mul_f32 v[200:201], v[200:201], v[132:133]
    v_pk_mul_f32 v[202:203], v[202:203], v[134:135]
    v_pk_mul_f32 v[204:205], v[204:205], v[136:137]
    v_pk_mul_f32 v[206:207], v[206:207], v[138:139]
    v_cvt_pk_bf16_f32 v108, v200, v201
    v_cvt_pk_bf16_f32 v109, v202, v203
    v_cvt_pk_bf16_f32 v110, v204, v205
    v_cvt_pk_bf16_f32 v111, v206, v207
    v_min_u32 v108, -2, v108
    buffer_store_dwordx4 v[108:111], v1, s[16:19], s66 offen offset:2048 sc1
    s_waitcnt lgkmcnt(2)
    v_pk_add_f32 v[208:209], v[208:209], v[40:41]
    v_pk_add_f32 v[210:211], v[210:211], v[42:43]
    s_waitcnt lgkmcnt(1)
    v_pk_add_f32 v[208:209], v[208:209], v[68:69]
    v_pk_add_f32 v[210:211], v[210:211], v[70:71]
    s_waitcnt lgkmcnt(0)
    v_pk_add_f32 v[208:209], v[208:209], v[96:97]
    v_pk_add_f32 v[210:211], v[210:211], v[98:99]
    v_pk_mul_f32 v[208:209], v[208:209], v[140:141]
    v_pk_mul_f32 v[210:211], v[210:211], v[142:143]
    v_cvt_pk_bf16_f32 v112, v208, v209
    v_cvt_pk_bf16_f32 v113, v210, v211
    v_min_u32 v112, -2, v112
    v_mov_b32 v114, v112
    v_mov_b32 v115, v113
    s_nop 0
    v_permlane16_swap_b32 v112, v114
    v_permlane16_swap_b32 v113, v115
    buffer_store_dwordx4 v[112:115], v11, s[16:19], s66 offen offset:3072 sc1
    s_barrier
    s_mul_i32 s67, s48, 11264
    s_min_u32 s67, s67, 33792
    s_add_u32 s79, s64, s67
    s_add_u32 s80, s67, 0
    s_add_u32 s79, s79, 69632
    s_mov_b32 m0, s80
    s_nop 0
    buffer_load_dwordx4 v1, s[16:19], s79 offen sc1 lds
    buffer_load_dwordx4 v1, s[16:19], s79 offen offset:1024 sc1 lds
    buffer_load_dwordx4 v1, s[16:19], s79 offen offset:2048 sc1 lds
    buffer_load_dwordx4 v1, s[16:19], s79 offen offset:3072 sc1 lds
    s_add_u32 s79, s79, 4096
    s_add_u32 s80, s80, 4096
    s_mov_b32 m0, s80
    s_nop 0
    buffer_load_dwordx4 v1, s[16:19], s79 offen sc1 lds
    buffer_load_dwordx4 v1, s[16:19], s79 offen offset:1024 sc1 lds
    buffer_load_dwordx4 v1, s[16:19], s79 offen offset:2048 sc1 lds
    buffer_load_dwordx4 v1, s[16:19], s79 offen offset:3072 sc1 lds
    s_add_u32 s79, s79, 4096
    s_add_u32 s80, s80, 4096
    s_mov_b32 m0, s80
    s_nop 0
    buffer_load_dwordx4 v1, s[16:19], s79 offen sc1 lds
    buffer_load_dwordx4 v1, s[16:19], s79 offen offset:1024 sc1 lds
    buffer_load_dwordx4 v1, s[16:19], s79 offen offset:2048 sc1 lds
    s_mul_i32 s62, s61, 28672
    s_add_u32 s62, s62, 15728640
    s_mul_i32 s63, s61, 14336
    s_mul_i32 s65, s50, 112
    s_add_u32 s63, s63, s65
    v_mov_b32 v9, 2130706432
    v_lshrrev_b32 v11, 2, v0
    v_and_b32 v12, 3, v0
    v_mul_u32_u24 v8, 896, v11
    v_lshl_add_u32 v8, v12, 4, v8
    v_cmp_eq_u32 vcc, 3, v12
    v_lshl_add_u32 v12, v12, 4, v11
    s_lshl_b32 s65, s48, 11
    s_add_u32 s65, s65, 49152
    v_lshlrev_b32 v12, 4, v12
    v_add_u32 v12, s65, v12
    v_add_u32 v11, s65, v1
    v_cndmask_b32 v9, v8, v9, vcc
    s_mov_b32 s66, 0
    s_and_b32 s66, s66, 3
    s_mul_i32 s66, s66, 7168
    s_add_u32 s88, s66, s62
    s_add_u32 s89, s88, 4096
    s_mov_b32 s66, 1
    s_and_b32 s66, s66, 3
    s_mul_i32 s66, s66, 7168
    s_add_u32 s90, s66, s62
    s_add_u32 s91, s90, 4096
    s_mov_b32 s66, 2
    s_and_b32 s66, s66, 3
    s_mul_i32 s66, s66, 7168
    s_add_u32 s92, s66, s62
    s_add_u32 s93, s92, 4096
    s_mov_b32 s66, 3
    s_and_b32 s66, s66, 3
    s_mul_i32 s66, s66, 7168
    s_add_u32 s94, s66, s62
    s_add_u32 s95, s94, 4096
    v_lshlrev_b32 v176, 16, v216
    v_and_b32 v177, 0xffff0000, v216
    v_lshlrev_b32 v178, 16, v217
    v_and_b32 v179, 0xffff0000, v217
    v_lshlrev_b32 v180, 16, v218
    v_and_b32 v181, 0xffff0000, v218
    v_lshlrev_b32 v182, 16, v219
    v_and_b32 v183, 0xffff0000, v219
    v_lshlrev_b32 v184, 16, v220
    v_and_b32 v185, 0xffff0000, v220
    v_lshlrev_b32 v186, 16, v221
    v_and_b32 v187, 0xffff0000, v221
    v_lshlrev_b32 v188, 16, v222
    v_and_b32 v189, 0xffff0000, v222
    v_lshlrev_b32 v190, 16, v223
    v_and_b32 v191, 0xffff0000, v223
    buffer_load_dwordx4 v[16:19], v1, s[16:19], s88 offen sc1
    buffer_load_dwordx4 v[20:23], v1, s[16:19], s88 offen offset:1024 sc1
    buffer_load_dwordx4 v[24:27], v1, s[16:19], s88 offen offset:2048 sc1
    buffer_load_dwordx4 v[28:31], v1, s[16:19], s88 offen offset:3072 sc1
    buffer_load_dwordx4 v[32:35], v1, s[16:19], s89 offen sc1
    buffer_load_dwordx4 v[36:39], v1, s[16:19], s89 offen offset:1024 sc1
    buffer_load_dwordx4 v[40:43], v1, s[16:19], s89 offen offset:2048 sc1
    buffer_load_dwordx4 v[44:47], v1, s[16:19], s90 offen sc1
    buffer_load_dwordx4 v[48:51], v1, s[16:19], s90 offen offset:1024 sc1
    buffer_load_dwordx4 v[52:55], v1, s[16:19], s90 offen offset:2048 sc1
    ds_read_b128 v[128:131], v4 offset:57344
    ds_read_b128 v[132:135], v4 offset:58368
    ds_read_b128 v[136:139], v4 offset:59392
    ds_read_b128 v[140:143], v4 offset:60416
    ds_read_b128 v[144:147], v4 offset:61440
    ds_read_b128 v[148:151], v4 offset:62464
    s_waitcnt vmcnt(7)
    v_max3_u32 v10, v16, v20, v24
    s_waitcnt vmcnt(6)
    v_max_u32 v10, v10, v28
    v_cmp_eq_u32 vcc, -1, v10
    s_cbranch_vccnz .Lagain_35
.Lback_36:
    s_waitcnt lgkmcnt(5)
    v_mfma_f32_16x16x32_bf16 v[160:163], v[128:131], v[16:19], v[176:179]
    ds_read_b128 v[152:155], v4 offset:63488
    buffer_load_dwordx4 v[56:59], v1, s[16:19], s90 offen offset:3072 sc1
    s_waitcnt lgkmcnt(5)
    v_mfma_f32_16x16x32_bf16 v[164:167], v[132:135], v[16:19], v[180:183]
    ds_read_b128 v[156:159], v4 offset:64512
    s_waitcnt lgkmcnt(5)
    v_mfma_f32_16x16x32_bf16 v[168:171], v[136:139], v[16:19], v[184:187]
    ds_read_b128 v[128:131], v5
    s_waitcnt lgkmcnt(5)
    v_mfma_f32_16x16x32_bf16 v[172:175], v[140:143], v[16:19], v[188:191]
    ds_read_b128 v[132:135], v5 offset:1024
    s_waitcnt lgkmcnt(5)
    v_mfma_f32_16x16x32_bf16 v[160:163], v[144:147], v[20:23], v[160:163]
    ds_read_b128 v[136:139], v5 offset:2048
    buffer_load_dwordx4 v[60:63], v1, s[16:19], s91 offen sc1
    s_waitcnt lgkmcnt(5)
    v_mfma_f32_16x16x32_bf16 v[164:167], v[148:151], v[20:23], v[164:167]
    ds_read_b128 v[140:143], v5 offset:3072
    s_waitcnt lgkmcnt(5)
    v_mfma_f32_16x16x32_bf16 v[168:171], v[152:155], v[20:23], v[168:171]
    ds_read_b128 v[144:147], v5 offset:4096
    s_waitcnt lgkmcnt(5)
    v_mfma_f32_16x16x32_bf16 v[172:175], v[156:159], v[20:23], v[172:175]
    ds_read_b128 v[148:151], v5 offset:5120
    s_waitcnt lgkmcnt(5)
    v_mfma_f32_16x16x32_bf16 v[160:163], v[128:131], v[24:27], v[160:163]
    ds_read_b128 v[152:155], v5 offset:6144
    buffer_load_dwordx4 v[64:67], v1, s[16:19], s91 offen offset:1024 sc1
    s_waitcnt lgkmcnt(5)
    v_mfma_f32_16x16x32_bf16 v[164:167], v[132:135], v[24:27], v[164:167]
    ds_read_b128 v[156:159], v5 offset:7168
    s_waitcnt lgkmcnt(5)
    v_mfma_f32_16x16x32_bf16 v[168:171], v[136:139], v[24:27], v[168:171]
    ds_read_b128 v[128:131], v5 offset:8192
    s_waitcnt lgkmcnt(5)
    v_mfma_f32_16x16x32_bf16 v[172:175], v[140:143], v[24:27], v[172:175]
    ds_read_b128 v[132:135], v5 offset:9216
    s_waitcnt lgkmcnt(5)
    v_mfma_f32_16x16x32_bf16 v[160:163], v[144:147], v[28:31], v[160:163]
    ds_read_b128 v[136:139], v5 offset:10240
    buffer_load_dwordx4 v[68:71], v1, s[16:19], s91 offen offset:2048 sc1
    s_waitcnt lgkmcnt(5)
    v_mfma_f32_16x16x32_bf16 v[164:167], v[148:151], v[28:31], v[164:167]
    ds_read_b128 v[140:143], v5 offset:11264
    s_waitcnt vmcnt(7)
    v_max3_u32 v10, v32, v36, v40
    s_waitcnt lgkmcnt(5)
    v_mfma_f32_16x16x32_bf16 v[168:171], v[152:155], v[28:31], v[168:171]
    ds_read_b128 v[144:147], v5 offset:12288
    s_waitcnt vmcnt(6)
    v_max_u32 v10, v10, v44
    s_waitcnt lgkmcnt(5)
    v_mfma_f32_16x16x32_bf16 v[172:175], v[156:159], v[28:31], v[172:175]
    ds_read_b128 v[148:151], v5 offset:13312
    v_cmp_eq_u32 vcc, -1, v10
    s_cbranch_vccnz .Lagain_37
.Lback_38:
    s_waitcnt lgkmcnt(5)
    v_mfma_f32_16x16x32_bf16 v[160:163], v[128:131], v[32:35], v[160:163]
    ds_read_b128 v[152:155], v5 offset:14336
    buffer_load_dwordx4 v[72:75], v1, s[16:19], s92 offen sc1
    s_waitcnt lgkmcnt(5)
    v_mfma_f32_16x16x32_bf16 v[164:167], v[132:135], v[32:35], v[164:167]
    ds_read_b128 v[156:159], v5 offset:15360
    s_waitcnt lgkmcnt(5)
    v_mfma_f32_16x16x32_bf16 v[168:171], v[136:139], v[32:35], v[168:171]
    ds_read_b128 v[128:131], v5 offset:16384
    s_waitcnt lgkmcnt(5)
    v_mfma_f32_16x16x32_bf16 v[172:175], v[140:143], v[32:35], v[172:175]
    ds_read_b128 v[132:135], v5 offset:17408
    s_waitcnt lgkmcnt(5)
    v_mfma_f32_16x16x32_bf16 v[160:163], v[144:147], v[36:39], v[160:163]
    ds_read_b128 v[136:139], v5 offset:18432
    buffer_load_dwordx4 v[76:79], v1, s[16:19], s92 offen offset:1024 sc1
    s_waitcnt lgkmcnt(5)
    v_mfma_f32_16x16x32_bf16 v[164:167], v[148:151], v[36:39], v[164:167]
    ds_read_b128 v[140:143], v5 offset:19456
    s_waitcnt lgkmcnt(5)
    v_mfma_f32_16x16x32_bf16 v[168:171], v[152:155], v[36:39], v[168:171]
    ds_read_b128 v[144:147], v5 offset:20480
    s_waitcnt lgkmcnt(5)
    v_mfma_f32_16x16x32_bf16 v[172:175], v[156:159], v[36:39], v[172:175]
    ds_read_b128 v[148:151], v5 offset:21504
    s_waitcnt lgkmcnt(5)
    v_mfma_f32_16x16x32_bf16 v[160:163], v[128:131], v[40:43], v[160:163]
    ds_read_b128 v[152:155], v5 offset:22528
    buffer_load_dwordx4 v[80:83], v1, s[16:19], s92 offen offset:2048 sc1
    s_waitcnt lgkmcnt(5)
    v_mfma_f32_16x16x32_bf16 v[164:167], v[132:135], v[40:43], v[164:167]
    ds_read_b128 v[156:159], v5 offset:23552
    s_waitcnt lgkmcnt(5)
    v_mfma_f32_16x16x32_bf16 v[168:171], v[136:139], v[40:43], v[168:171]
    ds_read_b128 v[128:131], v4 offset:20480
    s_waitcnt lgkmcnt(5)
    v_mfma_f32_16x16x32_bf16 v[172:175], v[140:143], v[40:43], v[172:175]
    ds_read_b128 v[132:135], v4 offset:21504
    s_waitcnt lgkmcnt(5)
    v_mfma_f32_16x16x32_bf16 v[160:163], v[144:147], v[44:47], v[160:163]
    ds_read_b128 v[136:139], v4 offset:22528
    buffer_load_dwordx4 v[84:87], v1, s[16:19], s92 offen offset:3072 sc1
    s_waitcnt lgkmcnt(5)
    v_mfma_f32_16x16x32_bf16 v[164:167], v[148:151], v[44:47], v[164:167]
    ds_read_b128 v[140:143], v4 offset:23552
    s_waitcnt vmcnt(7)
    v_max3_u32 v10, v48, v52, v56
    s_waitcnt lgkmcnt(5)
    v_mfma_f32_16x16x32_bf16 v[168:171], v[152:155], v[44:47], v[168:171]
    ds_read_b128 v[144:147], v4 offset:24576
    s_waitcnt vmcnt(6)
    v_max_u32 v10, v10, v60
    s_waitcnt lgkmcnt(5)
    v_mfma_f32_16x16x32_bf16 v[172:175], v[156:159], v[44:47], v[172:175]
    ds_read_b128 v[148:151], v4 offset:25600
    v_cmp_eq_u32 vcc, -1, v10
    s_cbranch_vccnz .Lagain_39
.Lback_40:
    s_waitcnt lgkmcnt(5)
    v_mfma_f32_16x16x32_bf16 v[160:163], v[128:131], v[48:51], v[160:163]
    ds_read_b128 v[152:155], v4 offset:26624
    buffer_load_dwordx4 v[88:91], v1, s[16:19], s93 offen sc1
    s_waitcnt lgkmcnt(5)
    v_mfma_f32_16x16x32_bf16 v[164:167], v[132:135], v[48:51], v[164:167]
    ds_read_b128 v[156:159], v4 offset:27648
    s_waitcnt lgkmcnt(5)
    v_mfma_f32_16x16x32_bf16 v[168:171], v[136:139], v[48:51], v[168:171]
    ds_read_b128 v[128:131], v4 offset:28672
    s_waitcnt lgkmcnt(5)
    v_mfma_f32_16x16x32_bf16 v[172:175], v[140:143], v[48:51], v[172:175]
    ds_read_b128 v[132:135], v4 offset:29696
    s_waitcnt lgkmcnt(5)
    v_mfma_f32_16x16x32_bf16 v[160:163], v[144:147], v[52:55], v[160:163]
    ds_read_b128 v[136:139], v4 offset:30720
    buffer_load_dwordx4 v[92:95], v1, s[16:19], s93 offen offset:1024 sc1
    s_waitcnt lgkmcnt(5)
    v_mfma_f32_16x16x32_bf16 v[164:167], v[148:151], v[52:55], v[164:167]
    ds_read_b128 v[140:143], v4 offset:31744
    s_waitcnt lgkmcnt(5)
    v_mfma_f32_16x16x32_bf16 v[168:171], v[152:155], v[52:55], v[168:171]
    ds_read_b128 v[144:147], v4 offset:32768
    s_waitcnt lgkmcnt(5)
    v_mfma_f32_16x16x32_bf16 v[172:175], v[156:159], v[52:55], v[172:175]
    ds_read_b128 v[148:151], v4 offset:33792
    s_waitcnt lgkmcnt(5)
    v_mfma_f32_16x16x32_bf16 v[160:163], v[128:131], v[56:59], v[160:163]
    ds_read_b128 v[152:155], v4 offset:34816
    buffer_load_dwordx4 v[96:99], v1, s[16:19], s93 offen offset:2048 sc1
    s_waitcnt lgkmcnt(5)
    v_mfma_f32_16x16x32_bf16 v[164:167], v[132:135], v[56:59], v[164:167]
    ds_read_b128 v[156:159], v4 offset:35840
    s_waitcnt lgkmcnt(5)
    v_mfma_f32_16x16x32_bf16 v[168:171], v[136:139], v[56:59], v[168:171]
    ds_read_b128 v[128:131], v4 offset:36864
    s_waitcnt lgkmcnt(5)
    v_mfma_f32_16x16x32_bf16 v[172:175], v[140:143], v[56:59], v[172:175]
    ds_read_b128 v[132:135], v4 offset:37888
    s_waitcnt lgkmcnt(5)
    v_mfma_f32_16x16x32_bf16 v[160:163], v[144:147], v[60:63], v[160:163]
    ds_read_b128 v[136:139], v4 offset:38912
    buffer_load_dwordx4 v[100:103], v1, s[16:19], s94 offen sc1
    s_waitcnt lgkmcnt(5)
    v_mfma_f32_16x16x32_bf16 v[164:167], v[148:151], v[60:63], v[164:167]
    ds_read_b128 v[140:143], v4 offset:39936
    s_waitcnt vmcnt(7)
    v_max3_u32 v10, v64, v68, v72
    s_waitcnt lgkmcnt(5)
    v_mfma_f32_16x16x32_bf16 v[168:171], v[152:155], v[60:63], v[168:171]
    ds_read_b128 v[144:147], v4 offset:40960
    s_waitcnt vmcnt(6)
    v_max_u32 v10, v10, v76
    s_waitcnt lgkmcnt(5)
    v_mfma_f32_16x16x32_bf16 v[172:175], v[156:159], v[60:63], v[172:175]
    ds_read_b128 v[148:151], v4 offset:41984
    v_cmp_eq_u32 vcc, -1, v10
    s_cbranch_vccnz .Lagain_41
.Lback_42:
    s_waitcnt lgkmcnt(5)
    v_mfma_f32_16x16x32_bf16 v[160:163], v[128:131], v[64:67], v[160:163]
    ds_read_b128 v[152:155], v4 offset:43008
    buffer_load_dwordx4 v[104:107], v1, s[16:19], s94 offen offset:1024 sc1
    s_waitcnt lgkmcnt(5)
    v_mfma_f32_16x16x32_bf16 v[164:167], v[132:135], v[64:67], v[164:167]
    ds_read_b128 v[156:159], v4 offset:44032
    s_waitcnt lgkmcnt(5)
    v_mfma_f32_16x16x32_bf16 v[168:171], v[136:139], v[64:67], v[168:171]
    ds_read_b128 v[128:131], v4 offset:45056
    s_waitcnt lgkmcnt(5)
    v_mfma_f32_16x16x32_bf16 v[172:175], v[140:143], v[64:67], v[172:175]
    ds_read_b128 v[132:135], v4 offset:46080
    s_waitcnt lgkmcnt(5)
    v_mfma_f32_16x16x32_bf16 v[160:163], v[144:147], v[68:71], v[160:163]
    ds_read_b128 v[136:139], v4 offset:47104
    buffer_load_dwordx4 v[108:111], v1, s[16:19], s94 offen offset:2048 sc1
    s_waitcnt lgkmcnt(5)
    v_mfma_f32_16x16x32_bf16 v[164:167], v[148:151], v[68:71], v[164:167]
    ds_read_b128 v[140:143], v4 offset:48128
    s_waitcnt lgkmcnt(5)
    v_mfma_f32_16x16x32_bf16 v[168:171], v[152:155], v[68:71], v[168:171]
    ds_read_b128 v[144:147], v4 offset:49152
    s_waitcnt lgkmcnt(5)
    v_mfma_f32_16x16x32_bf16 v[172:175], v[156:159], v[68:71], v[172:175]
    ds_read_b128 v[148:151], v4 offset:50176
    s_waitcnt lgkmcnt(5)
    v_mfma_f32_16x16x32_bf16 v[160:163], v[128:131], v[72:75], v[160:163]
    ds_read_b128 v[152:155], v4 offset:51200
    buffer_load_dwordx4 v[112:115], v1, s[16:19], s94 offen offset:3072 sc1
    s_waitcnt lgkmcnt(5)
    v_mfma_f32_16x16x32_bf16 v[164:167], v[132:135], v[72:75], v[164:167]
    ds_read_b128 v[156:159], v4 offset:52224
    s_waitcnt lgkmcnt(5)
    v_mfma_f32_16x16x32_bf16 v[168:171], v[136:139], v[72:75], v[168:171]
    ds_read_b128 v[128:131], v4 offset:53248
    s_waitcnt lgkmcnt(5)
    v_mfma_f32_16x16x32_bf16 v[172:175], v[140:143], v[72:75], v[172:175]
    ds_read_b128 v[132:135], v4 offset:54272
    s_waitcnt lgkmcnt(5)
    v_mfma_f32_16x16x32_bf16 v[160:163], v[144:147], v[76:79], v[160:163]
    ds_read_b128 v[136:139], v4 offset:55296
    buffer_load_dwordx4 v[116:119], v1, s[16:19], s95 offen sc1
    s_waitcnt lgkmcnt(5)
    v_mfma_f32_16x16x32_bf16 v[164:167], v[148:151], v[76:79], v[164:167]
    ds_read_b128 v[140:143], v4 offset:56320
    s_waitcnt vmcnt(7)
    v_max3_u32 v10, v80, v84, v88
    s_waitcnt lgkmcnt(5)
    v_mfma_f32_16x16x32_bf16 v[168:171], v[152:155], v[76:79], v[168:171]
    s_barrier
    ds_read_b128 v[144:147], v1
    s_waitcnt vmcnt(6)
    v_max_u32 v10, v10, v92
    s_waitcnt lgkmcnt(5)
    v_mfma_f32_16x16x32_bf16 v[172:175], v[156:159], v[76:79], v[172:175]
    ds_read_b128 v[148:151], v1 offset:1024
    v_cmp_eq_u32 vcc, -1, v10
    s_cbranch_vccnz .Lagain_43
.Lback_44:
    s_waitcnt lgkmcnt(5)
    v_mfma_f32_16x16x32_bf16 v[160:163], v[128:131], v[80:83], v[160:163]
    ds_read_b128 v[152:155], v1 offset:2048
    buffer_load_dwordx4 v[120:123], v1, s[16:19], s95 offen offset:1024 sc1
    s_waitcnt lgkmcnt(5)
    v_mfma_f32_16x16x32_bf16 v[164:167], v[132:135], v[80:83], v[164:167]
    ds_read_b128 v[156:159], v1 offset:3072
    s_waitcnt lgkmcnt(5)
    v_mfma_f32_16x16x32_bf16 v[168:171], v[136:139], v[80:83], v[168:171]
    ds_read_b128 v[128:131], v1 offset:4096
    s_waitcnt lgkmcnt(5)
    v_mfma_f32_16x16x32_bf16 v[172:175], v[140:143], v[80:83], v[172:175]
    ds_read_b128 v[132:135], v1 offset:5120
    s_waitcnt lgkmcnt(5)
    v_mfma_f32_16x16x32_bf16 v[160:163], v[144:147], v[84:87], v[160:163]
    ds_read_b128 v[136:139], v1 offset:6144
    buffer_load_dwordx4 v[124:127], v1, s[16:19], s95 offen offset:2048 sc1
    s_waitcnt lgkmcnt(5)
    v_mfma_f32_16x16x32_bf16 v[164:167], v[148:151], v[84:87], v[164:167]
    ds_read_b128 v[140:143], v1 offset:7168
    s_waitcnt lgkmcnt(5)
    v_mfma_f32_16x16x32_bf16 v[168:171], v[152:155], v[84:87], v[168:171]
    ds_read_b128 v[144:147], v1 offset:8192
    s_waitcnt lgkmcnt(5)
    v_mfma_f32_16x16x32_bf16 v[172:175], v[156:159], v[84:87], v[172:175]
    ds_read_b128 v[148:151], v1 offset:9216
    s_waitcnt lgkmcnt(5)
    v_mfma_f32_16x16x32_bf16 v[160:163], v[128:131], v[88:91], v[160:163]
    ds_read_b128 v[152:155], v1 offset:10240
    s_waitcnt lgkmcnt(5)
    v_mfma_f32_16x16x32_bf16 v[164:167], v[132:135], v[88:91], v[164:167]
    ds_read_b128 v[156:159], v1 offset:11264
    s_waitcnt lgkmcnt(5)
    v_mfma_f32_16x16x32_bf16 v[168:171], v[136:139], v[88:91], v[168:171]
    ds_read_b128 v[128:131], v1 offset:12288
    s_waitcnt lgkmcnt(5)
    v_mfma_f32_16x16x32_bf16 v[172:175], v[140:143], v[88:91], v[172:175]
    ds_read_b128 v[132:135], v1 offset:13312
    s_waitcnt lgkmcnt(5)
    v_mfma_f32_16x16x32_bf16 v[160:163], v[144:147], v[92:95], v[160:163]
    ds_read_b128 v[136:139], v1 offset:14336
    s_waitcnt lgkmcnt(5)
    v_mfma_f32_16x16x32_bf16 v[164:167], v[148:151], v[92:95], v[164:167]
    ds_read_b128 v[140:143], v1 offset:15360
    s_waitcnt vmcnt(5)
    v_max3_u32 v10, v96, v100, v104
    s_waitcnt lgkmcnt(5)
    v_mfma_f32_16x16x32_bf16 v[168:171], v[152:155], v[92:95], v[168:171]
    ds_read_b128 v[144:147], v1 offset:16384
    s_waitcnt vmcnt(4)
    v_max_u32 v10, v10, v108
    s_waitcnt lgkmcnt(5)
    v_mfma_f32_16x16x32_bf16 v[172:175], v[156:159], v[92:95], v[172:175]
    ds_read_b128 v[148:151], v1 offset:17408
    v_cmp_eq_u32 vcc, -1, v10
    s_cbranch_vccnz .Lagain_45
.Lback_46:
    s_waitcnt lgkmcnt(5)
    v_mfma_f32_16x16x32_bf16 v[160:163], v[128:131], v[96:99], v[160:163]
    ds_read_b128 v[152:155], v1 offset:18432
    s_waitcnt lgkmcnt(5)
    v_mfma_f32_16x16x32_bf16 v[164:167], v[132:135], v[96:99], v[164:167]
    ds_read_b128 v[156:159], v1 offset:19456
    s_waitcnt lgkmcnt(5)
    v_mfma_f32_16x16x32_bf16 v[168:171], v[136:139], v[96:99], v[168:171]
    ds_read_b128 v[128:131], v1 offset:20480
    s_waitcnt lgkmcnt(5)
    v_mfma_f32_16x16x32_bf16 v[172:175], v[140:143], v[96:99], v[172:175]
    ds_read_b128 v[132:135], v1 offset:21504
    s_waitcnt lgkmcnt(5)
    v_mfma_f32_16x16x32_bf16 v[160:163], v[144:147], v[100:103], v[160:163]
    ds_read_b128 v[136:139], v1 offset:22528
    s_waitcnt lgkmcnt(5)
    v_mfma_f32_16x16x32_bf16 v[164:167], v[148:151], v[100:103], v[164:167]
    ds_read_b128 v[140:143], v1 offset:23552
    s_waitcnt lgkmcnt(5)
    v_mfma_f32_16x16x32_bf16 v[168:171], v[152:155], v[100:103], v[168:171]
    ds_read_b128 v[144:147], v1 offset:24576
    s_waitcnt lgkmcnt(5)
    v_mfma_f32_16x16x32_bf16 v[172:175], v[156:159], v[100:103], v[172:175]
    ds_read_b128 v[148:151], v1 offset:25600
    s_waitcnt lgkmcnt(5)
    v_mfma_f32_16x16x32_bf16 v[160:163], v[128:131], v[104:107], v[160:163]
    ds_read_b128 v[152:155], v1 offset:26624
    s_waitcnt lgkmcnt(5)
    v_mfma_f32_16x16x32_bf16 v[164:167], v[132:135], v[104:107], v[164:167]
    ds_read_b128 v[156:159], v1 offset:27648
    s_waitcnt lgkmcnt(5)
    v_mfma_f32_16x16x32_bf16 v[168:171], v[136:139], v[104:107], v[168:171]
    ds_read_b128 v[128:131], v1 offset:28672
    s_waitcnt lgkmcnt(5)
    v_mfma_f32_16x16x32_bf16 v[172:175], v[140:143], v[104:107], v[172:175]
    ds_read_b128 v[132:135], v1 offset:29696
    s_waitcnt lgkmcnt(5)
    v_mfma_f32_16x16x32_bf16 v[160:163], v[144:147], v[108:111], v[160:163]
    ds_read_b128 v[136:139], v1 offset:30720
    s_waitcnt lgkmcnt(5)
    v_mfma_f32_16x16x32_bf16 v[164:167], v[148:151], v[108:111], v[164:167]
    ds_read_b128 v[140:143], v1 offset:31744
    s_waitcnt vmcnt(1)
    v_max3_u32 v10, v112, v116, v120
    s_waitcnt lgkmcnt(5)
    v_mfma_f32_16x16x32_bf16 v[168:171], v[152:155], v[108:111], v[168:171]
    ds_read_b128 v[144:147], v1 offset:32768
    s_waitcnt vmcnt(0)
    v_max_u32 v10, v10, v124
    s_waitcnt lgkmcnt(5)
    v_mfma_f32_16x16x32_bf16 v[172:175], v[156:159], v[108:111], v[172:175]
    ds_read_b128 v[148:151], v1 offset:33792
    v_cmp_eq_u32 vcc, -1, v10
    s_cbranch_vccnz .Lagain_47
.Lback_48:
    s_waitcnt lgkmcnt(5)
    v_mfma_f32_16x16x32_bf16 v[160:163], v[128:131], v[112:115], v[160:163]
    ds_read_b128 v[152:155], v1 offset:34816
    s_waitcnt lgkmcnt(5)
    v_mfma_f32_16x16x32_bf16 v[164:167], v[132:135], v[112:115], v[164:167]
    ds_read_b128 v[156:159], v1 offset:35840
    s_waitcnt lgkmcnt(5)
    v_mfma_f32_16x16x32_bf16 v[168:171], v[136:139], v[112:115], v[168:171]
    ds_read_b128 v[128:131], v1 offset:36864
    s_waitcnt lgkmcnt(5)
    v_mfma_f32_16x16x32_bf16 v[172:175], v[140:143], v[112:115], v[172:175]
    ds_read_b128 v[132:135], v1 offset:37888
    s_waitcnt lgkmcnt(5)
    v_mfma_f32_16x16x32_bf16 v[160:163], v[144:147], v[116:119], v[160:163]
    ds_read_b128 v[136:139], v1 offset:38912
    s_waitcnt lgkmcnt(5)
    v_mfma_f32_16x16x32_bf16 v[164:167], v[148:151], v[116:119], v[164:167]
    ds_read_b128 v[140:143], v1 offset:39936
    s_waitcnt lgkmcnt(5)
    v_mfma_f32_16x16x32_bf16 v[168:171], v[152:155], v[116:119], v[168:171]
    ds_read_b128 v[144:147], v1 offset:40960
    s_waitcnt lgkmcnt(5)
    v_mfma_f32_16x16x32_bf16 v[172:175], v[156:159], v[116:119], v[172:175]
    ds_read_b128 v[148:151], v1 offset:41984
    s_waitcnt lgkmcnt(5)
    v_mfma_f32_16x16x32_bf16 v[160:163], v[128:131], v[120:123], v[160:163]
    ds_read_b128 v[152:155], v1 offset:43008
    s_waitcnt lgkmcnt(5)
    v_mfma_f32_16x16x32_bf16 v[164:167], v[132:135], v[120:123], v[164:167]
    ds_read_b128 v[156:159], v1 offset:44032
    s_waitcnt lgkmcnt(5)
    v_mfma_f32_16x16x32_bf16 v[168:171], v[136:139], v[120:123], v[168:171]
    s_waitcnt lgkmcnt(4)
    v_mfma_f32_16x16x32_bf16 v[172:175], v[140:143], v[120:123], v[172:175]
    s_waitcnt lgkmcnt(3)
    v_mfma_f32_16x16x32_bf16 v[160:163], v[144:147], v[124:127], v[160:163]
    s_waitcnt lgkmcnt(2)
    v_mfma_f32_16x16x32_bf16 v[164:167], v[148:151], v[124:127], v[164:167]
    s_waitcnt lgkmcnt(1)
    v_mfma_f32_16x16x32_bf16 v[168:171], v[152:155], v[124:127], v[168:171]
    s_waitcnt lgkmcnt(0)
    v_mfma_f32_16x16x32_bf16 v[172:175], v[156:159], v[124:127], v[172:175]
    s_nop 1
    v_cvt_pk_bf16_f32 v216, v160, v161
    v_cvt_pk_bf16_f32 v217, v162, v163
    v_cvt_pk_bf16_f32 v218, v164, v165
    v_cvt_pk_bf16_f32 v219, v166, v167
    ds_write_b128 v11, v[216:219]
    v_cvt_pk_bf16_f32 v220, v168, v169
    v_cvt_pk_bf16_f32 v221, v170, v171
    v_cvt_pk_bf16_f32 v222, v172, v173
    v_cvt_pk_bf16_f32 v223, v174, v175
    ds_write_b128 v11, v[220:223] offset:1024
    ds_read_b128 v[176:179], v12
    ds_read_b128 v[180:183], v12 offset:1024
    s_waitcnt lgkmcnt(1)
    buffer_store_dwordx4 v[176:179], v8, s[28:31], s63 offen
    s_waitcnt lgkmcnt(0)
    buffer_store_dwordx4 v[180:183], v9, s[28:31], s63 offen offset:64
    s_cmp_lg_u32 s2, 224
    s_cbranch_scc1 .Lnz_49
    s_cmp_lg_u32 s48, 0
    s_cbranch_scc1 .Lnz_49
    v_mov_b32 v6, 0
    s_mov_b64 exec, 1
    buffer_store_dword v6, v6, s[32:35], 0 offen sc1
    s_mov_b64 exec, -1
.Lnz_49:
.Lexit:
    s_endpgm
.Ltruemax:
    s_waitcnt vmcnt(0) lgkmcnt(0)
    s_barrier
    s_mov_b32 s60, 1
    s_mov_b32 s95, 2130706432
    s_mov_b32 s81, 2130706432
    s_mov_b32 s89, 2130706432
    s_mov_b32 s90, 2130706432
    v_cndmask_b32 v22, v22, 0, s[72:73]
    v_cndmask_b32 v23, v23, 0, s[72:73]
    v_mov_b32 v240, 0xff7fffff
    v_cndmask_b32 v30, v30, 0, s[72:73]
    v_cndmask_b32 v31, v31, 0, s[72:73]
    v_mov_b32 v241, 0xff7fffff
    v_cndmask_b32 v38, v38, 0, s[72:73]
    v_cndmask_b32 v39, v39, 0, s[72:73]
    v_mov_b32 v242, 0xff7fffff
    v_cndmask_b32 v46, v46, 0, s[72:73]
    v_cndmask_b32 v47, v47, 0, s[72:73]
    v_mov_b32 v243, 0xff7fffff
    s_mov_b32 s78, s93
    s_mov_b32 s62, 16
.Ltm_loop:
    buffer_load_dwordx4 v[200:203], v1, s[16:19], s78 offen sc1
    buffer_load_dwordx4 v[204:207], v1, s[16:19], s78 offen offset:1024 sc1
    s_waitcnt vmcnt(1)
    v_mfma_f32_32x32x16_bf16 v[112:127], v[200:203], v[16:19], 0
    s_waitcnt vmcnt(0)
    v_mfma_f32_32x32x16_bf16 v[112:127], v[204:207], v[20:23], v[112:127]
    v_mfma_f32_32x32x16_bf16 v[128:143], v[200:203], v[24:27], 0
    v_mfma_f32_32x32x16_bf16 v[128:143], v[204:207], v[28:31], v[128:143]
    s_nop 9
    v_max3_f32 v240, v112, v113, v240
    v_max3_f32 v240, v114, v115, v240
    v_max3_f32 v240, v116, v117, v240
    v_max3_f32 v240, v118, v119, v240
    v_max3_f32 v240, v120, v121, v240
    v_max3_f32 v240, v122, v123, v240
    v_max3_f32 v240, v124, v125, v240
    v_max3_f32 v240, v126, v127, v240
    v_mfma_f32_32x32x16_bf16 v[112:127], v[200:203], v[32:35], 0
    v_mfma_f32_32x32x16_bf16 v[112:127], v[204:207], v[36:39], v[112:127]
    v_max3_f32 v241, v128, v129, v241
    v_max3_f32 v241, v130, v131, v241
    v_max3_f32 v241, v132, v133, v241
    v_max3_f32 v241, v134, v135, v241
    v_max3_f32 v241, v136, v137, v241
    v_max3_f32 v241, v138, v139, v241
    v_max3_f32 v241, v140, v141, v241
    v_max3_f32 v241, v142, v143, v241
    v_mfma_f32_32x32x16_bf16 v[128:143], v[200:203], v[40:43], 0
    v_mfma_f32_32x32x16_bf16 v[128:143], v[204:207], v[44:47], v[128:143]
    s_nop 1
    v_max3_f32 v242, v112, v113, v242
    v_max3_f32 v242, v114, v115, v242
    v_max3_f32 v242, v116, v117, v242
    v_max3_f32 v242, v118, v119, v242
    v_max3_f32 v242, v120, v121, v242
    v_max3_f32 v242, v122, v123, v242
    v_max3_f32 v242, v124, v125, v242
    v_max3_f32 v242, v126, v127, v242
    s_nop 1
    v_max3_f32 v243, v128, v129, v243
    v_max3_f32 v243, v130, v131, v243
    v_max3_f32 v243, v132, v133, v243
    v_max3_f32 v243, v134, v135, v243
    v_max3_f32 v243, v136, v137, v243
    v_max3_f32 v243, v138, v139, v243
    v_max3_f32 v243, v140, v141, v243
    v_max3_f32 v243, v142, v143, v243
    s_add_u32 s78, s78, 4096
    s_sub_u32 s62, s62, 1
    s_cmp_lg_u32 s62, 0
    s_cbranch_scc1 .Ltm_loop
    v_mov_b32 v244, v240
    v_mov_b32 v245, v241
    v_mov_b32 v246, v242
    v_mov_b32 v247, v243
    v_permlane32_swap_b32 v244, v240
    v_permlane32_swap_b32 v245, v241
    v_permlane32_swap_b32 v246, v242
    v_permlane32_swap_b32 v247, v243
    v_max_f32 v240, v244, v240
    v_max_f32 v241, v245, v241
    v_max_f32 v242, v246, v242
    v_max_f32 v243, v247, v243
    s_add_u32 s62, s48, 1
    s_and_b32 s62, s62, 3
    s_lshl_b32 s62, s62, 10
    s_add_u32 s62, s62, 108544
    v_lshlrev_b32 v244, 2, v0
    v_add_u32 v244, s62, v244
    s_lshl_b32 s62, s48, 8
    v_add_u32 v248, s62, v244
    ds_write_b32 v248, v240
    s_add_u32 s62, s48, 2
    s_and_b32 s62, s62, 3
    s_lshl_b32 s62, s62, 10
    s_add_u32 s62, s62, 108544
    v_lshlrev_b32 v245, 2, v0
    v_add_u32 v245, s62, v245
    s_lshl_b32 s62, s48, 8
    v_add_u32 v248, s62, v245
    ds_write_b32 v248, v241
    s_add_u32 s62, s48, 3
    s_and_b32 s62, s62, 3
    s_lshl_b32 s62, s62, 10
    s_add_u32 s62, s62, 108544
    v_lshlrev_b32 v246, 2, v0
    v_add_u32 v246, s62, v246
    s_lshl_b32 s62, s48, 8
    v_add_u32 v248, s62, v246
    ds_write_b32 v248, v242
    s_add_u32 s62, s48, 4
    s_and_b32 s62, s62, 3
    s_lshl_b32 s62, s62, 10
    s_add_u32 s62, s62, 108544
    v_lshlrev_b32 v247, 2, v0
    v_add_u32 v247, s62, v247
    s_lshl_b32 s62, s48, 8
    v_add_u32 v248, s62, v247
    ds_write_b32 v248, v243
    s_waitcnt lgkmcnt(0)
    s_barrier
    ds_read_b32 v112, v244
    ds_read_b32 v113, v244 offset:256
    ds_read_b32 v114, v244 offset:512
    ds_read_b32 v115, v244 offset:768
    ds_read_b32 v116, v245
    ds_read_b32 v117, v245 offset:256
    ds_read_b32 v118, v245 offset:512
    ds_read_b32 v119, v245 offset:768
    ds_read_b32 v120, v246
    ds_read_b32 v121, v246 offset:256
    ds_read_b32 v122, v246 offset:512
    ds_read_b32 v123, v246 offset:768
    ds_read_b32 v124, v247
    ds_read_b32 v125, v247 offset:256
    ds_read_b32 v126, v247 offset:512
    ds_read_b32 v127, v247 offset:768
    s_waitcnt lgkmcnt(13)
    v_max3_f32 v240, v112, v113, v114
    s_waitcnt lgkmcnt(12)
    v_max_f32 v240, v240, v115
    s_waitcnt lgkmcnt(9)
    v_max3_f32 v241, v116, v117, v118
    s_waitcnt lgkmcnt(8)
    v_max_f32 v241, v241, v119
    s_waitcnt lgkmcnt(5)
    v_max3_f32 v242, v120, v121, v122
    s_waitcnt lgkmcnt(4)
    v_max_f32 v242, v242, v123
    s_waitcnt lgkmcnt(1)
    v_max3_f32 v243, v124, v125, v126
    s_waitcnt lgkmcnt(0)
    v_max_f32 v243, v243, v127
    v_sub_f32 v240, 0, v240
    v_cvt_pk_bf16_f32 v244, v240, 0
    v_lshlrev_b32 v245, 16, v244
    v_sub_f32 v240, v240, v245
    v_cvt_pk_bf16_f32 v245, v240, 0
    v_lshlrev_b32 v245, 16, v245
    v_sub_f32 v240, v240, v245
    v_or_b32 v244, v244, v245
    v_cvt_pk_bf16_f32 v245, v240, 0
    v_cndmask_b32 v23, v23, v245, s[72:73]
    v_cndmask_b32 v22, v22, v244, s[72:73]
    v_sub_f32 v241, 0, v241
    v_cvt_pk_bf16_f32 v244, v241, 0
    v_lshlrev_b32 v245, 16, v244
    v_sub_f32 v241, v241, v245
    v_cvt_pk_bf16_f32 v245, v241, 0
    v_lshlrev_b32 v245, 16, v245
    v_sub_f32 v241, v241, v245
    v_or_b32 v244, v244, v245
    v_cvt_pk_bf16_f32 v245, v241, 0
    v_cndmask_b32 v31, v31, v245, s[72:73]
    v_cndmask_b32 v30, v30, v244, s[72:73]
    v_sub_f32 v242, 0, v242
    v_cvt_pk_bf16_f32 v244, v242, 0
    v_lshlrev_b32 v245, 16, v244
    v_sub_f32 v242, v242, v245
    v_cvt_pk_bf16_f32 v245, v242, 0
    v_lshlrev_b32 v245, 16, v245
    v_sub_f32 v242, v242, v245
    v_or_b32 v244, v244, v245
    v_cvt_pk_bf16_f32 v245, v242, 0
    v_cndmask_b32 v39, v39, v245, s[72:73]
    v_cndmask_b32 v38, v38, v244, s[72:73]
    v_sub_f32 v243, 0, v243
    v_cvt_pk_bf16_f32 v244, v243, 0
    v_lshlrev_b32 v245, 16, v244
    v_sub_f32 v243, v243, v245
    v_cvt_pk_bf16_f32 v245, v243, 0
    v_lshlrev_b32 v245, 16, v245
    v_sub_f32 v243, v243, v245
    v_or_b32 v244, v244, v245
    v_cvt_pk_bf16_f32 v245, v243, 0
    v_cndmask_b32 v47, v47, v245, s[72:73]
    v_cndmask_b32 v46, v46, v244, s[72:73]
    s_waitcnt lgkmcnt(0)
    s_barrier
    s_lshl_b32 s84, s51, 12
    s_add_u32 s84, s84, 4096
    s_and_b32 s84, s84, 0xffff
    s_add_u32 s78, s93, s84
    buffer_load_dwordx4 a[16:19], v1, s[16:19], s78 offen sc1
    buffer_load_dwordx4 a[20:23], v1, s[16:19], s78 offen offset:1024 sc1
    buffer_load_dwordx4 a[80:83], v1, s[16:19], s78 offen offset:2048 sc1
    buffer_load_dwordx4 a[84:87], v1, s[16:19], s78 offen offset:3072 sc1
    s_add_u32 s84, s84, 4096
    s_and_b32 s84, s84, 0xffff
    s_add_u32 s78, s93, s84
    buffer_load_dwordx4 a[144:147], v1, s[16:19], s78 offen sc1
    buffer_load_dwordx4 a[148:151], v1, s[16:19], s78 offen offset:1024 sc1
    buffer_load_dwordx4 a[208:211], v1, s[16:19], s78 offen offset:2048 sc1
    buffer_load_dwordx4 a[212:215], v1, s[16:19], s78 offen offset:3072 sc1
    s_add_u32 s84, s84, 4096
    s_and_b32 s84, s84, 0xffff
    s_add_u32 s78, s93, s84
    buffer_load_dwordx4 a[24:27], v1, s[16:19], s78 offen sc1
    buffer_load_dwordx4 a[28:31], v1, s[16:19], s78 offen offset:1024 sc1
    buffer_load_dwordx4 a[88:91], v1, s[16:19], s78 offen offset:2048 sc1
    buffer_load_dwordx4 a[92:95], v1, s[16:19], s78 offen offset:3072 sc1
    s_branch .Lsweep
.Lagain_14:
    s_sub_u32 s59, s59, 1
    s_cmp_eq_u32 s59, 0
    s_cbranch_scc1 .Lexit
    buffer_load_dwordx4 v[16:19], v1, s[16:19], s74 offen sc1
    buffer_load_dwordx4 v[20:23], v144, s[16:19], s74 offen sc1
    buffer_load_dwordx4 v[24:27], v145, s[16:19], s74 offen sc1
    buffer_load_dwordx4 v[28:31], v146, s[16:19], s74 offen sc1
    s_waitcnt vmcnt(7)
    buffer_load_dwordx4 v[32:35], v1, s[16:19], s75 offen sc1
    s_waitcnt vmcnt(7)
    buffer_load_dwordx4 v[36:39], v144, s[16:19], s75 offen sc1
    s_waitcnt vmcnt(7)
    buffer_load_dwordx4 v[40:43], v145, s[16:19], s75 offen sc1
    s_waitcnt vmcnt(7)
    buffer_load_dwordx4 v[44:47], v146, s[16:19], s75 offen sc1
    s_waitcnt vmcnt(5)
    v_max3_u32 v10, v16, v20, v24
    s_waitcnt vmcnt(4)
    v_max_u32 v10, v10, v28
    v_cmp_eq_u32 vcc, -1, v10
    s_cbranch_vccnz .Lagain_14
    s_branch .Lback_15
.Lagain_16:
    s_sub_u32 s59, s59, 1
    s_cmp_eq_u32 s59, 0
    s_cbranch_scc1 .Lexit
    buffer_load_dwordx4 v[32:35], v1, s[16:19], s75 offen sc1
    buffer_load_dwordx4 v[36:39], v144, s[16:19], s75 offen sc1
    buffer_load_dwordx4 v[40:43], v145, s[16:19], s75 offen sc1
    buffer_load_dwordx4 v[44:47], v146, s[16:19], s75 offen sc1
    s_waitcnt vmcnt(7)
    buffer_load_dwordx4 v[48:51], v1, s[16:19], s76 offen sc1
    s_waitcnt vmcnt(7)
    buffer_load_dwordx4 v[52:55], v144, s[16:19], s76 offen sc1
    s_waitcnt vmcnt(7)
    buffer_load_dwordx4 v[56:59], v145, s[16:19], s76 offen sc1
    s_waitcnt vmcnt(7)
    buffer_load_dwordx4 v[60:63], v146, s[16:19], s76 offen sc1
    s_waitcnt vmcnt(5)
    v_max3_u32 v10, v32, v36, v40
    s_waitcnt vmcnt(4)
    v_max_u32 v10, v10, v44
    v_cmp_eq_u32 vcc, -1, v10
    s_cbranch_vccnz .Lagain_16
    s_branch .Lback_17
.Lagain_18:
    s_sub_u32 s59, s59, 1
    s_cmp_eq_u32 s59, 0
    s_cbranch_scc1 .Lexit
    buffer_load_dwordx4 v[48:51], v1, s[16:19], s76 offen sc1
    buffer_load_dwordx4 v[52:55], v144, s[16:19], s76 offen sc1
    buffer_load_dwordx4 v[56:59], v145, s[16:19], s76 offen sc1
    buffer_load_dwordx4 v[60:63], v146, s[16:19], s76 offen sc1
    s_waitcnt vmcnt(7)
    buffer_load_dwordx4 v[64:67], v1, s[16:19], s77 offen sc1
    s_waitcnt vmcnt(7)
    buffer_load_dwordx4 v[68:71], v144, s[16:19], s77 offen sc1
    s_waitcnt vmcnt(7)
    buffer_load_dwordx4 v[72:75], v145, s[16:19], s77 offen sc1
    s_waitcnt vmcnt(7)
    buffer_load_dwordx4 v[76:79], v146, s[16:19], s77 offen sc1
    s_waitcnt vmcnt(5)
    v_max3_u32 v10, v48, v52, v56
    s_waitcnt vmcnt(4)
    v_max_u32 v10, v10, v60
    v_cmp_eq_u32 vcc, -1, v10
    s_cbranch_vccnz .Lagain_18
    s_branch .Lback_19
.Lagain_20:
    s_sub_u32 s59, s59, 1
    s_cmp_eq_u32 s59, 0
    s_cbranch_scc1 .Lexit
    buffer_load_dwordx4 v[64:67], v1, s[16:19], s77 offen sc1
    buffer_load_dwordx4 v[68:71], v144, s[16:19], s77 offen sc1
    buffer_load_dwordx4 v[72:75], v145, s[16:19], s77 offen sc1
    buffer_load_dwordx4 v[76:79], v146, s[16:19], s77 offen sc1
    s_waitcnt vmcnt(1)
    v_max3_u32 v10, v64, v68, v72
    s_waitcnt vmcnt(0)
    v_max_u32 v10, v10, v76
    v_cmp_eq_u32 vcc, -1, v10
    s_cbranch_vccnz .Lagain_20
    s_branch .Lback_21
.Lagain_22:
    s_sub_u32 s59, s59, 1
    s_cmp_eq_u32 s59, 0
    s_cbranch_scc1 .Lexit
    buffer_load_dwordx4 v[16:19], v1, s[16:19], s74 offen sc1
    buffer_load_dwordx4 v[20:23], v1, s[16:19], s74 offen offset:1024 sc1
    buffer_load_dwordx4 v[24:27], v1, s[16:19], s74 offen offset:2048 sc1
    buffer_load_dwordx4 v[28:31], v1, s[16:19], s74 offen offset:3072 sc1
    s_waitcnt vmcnt(7)
    buffer_load_dwordx4 v[32:35], v1, s[16:19], s75 offen sc1
    s_waitcnt vmcnt(7)
    buffer_load_dwordx4 v[36:39], v1, s[16:19], s75 offen offset:1024 sc1
    s_waitcnt vmcnt(7)
    buffer_load_dwordx4 v[40:43], v1, s[16:19], s75 offen offset:2048 sc1
    s_waitcnt vmcnt(7)
    buffer_load_dwordx4 v[44:47], v1, s[16:19], s75 offen offset:3072 sc1
    s_waitcnt vmcnt(5)
    v_max3_u32 v210, v16, v20, v24
    s_waitcnt vmcnt(4)
    v_max_u32 v210, v210, v28
    v_cmp_eq_u32 vcc, -1, v210
    s_cbranch_vccnz .Lagain_22
    s_branch .Lback_23
.Lagain_24:
    s_sub_u32 s59, s59, 1
    s_cmp_eq_u32 s59, 0
    s_cbranch_scc1 .Lexit
    buffer_load_dwordx4 v[32:35], v1, s[16:19], s75 offen sc1
    buffer_load_dwordx4 v[36:39], v1, s[16:19], s75 offen offset:1024 sc1
    buffer_load_dwordx4 v[40:43], v1, s[16:19], s75 offen offset:2048 sc1
    buffer_load_dwordx4 v[44:47], v1, s[16:19], s75 offen offset:3072 sc1
    s_waitcnt vmcnt(8)
    buffer_load_dwordx4 v[48:51], v1, s[16:19], s76 offen sc1
    s_waitcnt vmcnt(8)
    buffer_load_dwordx4 v[52:55], v1, s[16:19], s76 offen offset:1024 sc1
    s_waitcnt vmcnt(8)
    buffer_load_dwordx4 v[56:59], v1, s[16:19], s76 offen offset:2048 sc1
    s_waitcnt vmcnt(8)
    buffer_load_dwordx4 v[60:63], v1, s[16:19], s76 offen offset:3072 sc1
    s_waitcnt vmcnt(8)
    buffer_load_dwordx4 v[64:67], v1, s[16:19], s77 offen sc1
    s_waitcnt vmcnt(6)
    v_max3_u32 v210, v32, v36, v40
    s_waitcnt vmcnt(5)
    v_max_u32 v210, v210, v44
    v_cmp_eq_u32 vcc, -1, v210
    s_cbranch_vccnz .Lagain_24
    s_branch .Lback_25
.Lagain_26:
    s_sub_u32 s59, s59, 1
    s_cmp_eq_u32 s59, 0
    s_cbranch_scc1 .Lexit
    buffer_load_dwordx4 v[48:51], v1, s[16:19], s76 offen sc1
    buffer_load_dwordx4 v[52:55], v1, s[16:19], s76 offen offset:1024 sc1
    buffer_load_dwordx4 v[56:59], v1, s[16:19], s76 offen offset:2048 sc1
    buffer_load_dwordx4 v[60:63], v1, s[16:19], s76 offen offset:3072 sc1
    s_waitcnt vmcnt(5)
    buffer_load_dwordx4 v[64:67], v1, s[16:19], s77 offen sc1
    s_waitcnt vmcnt(5)
    buffer_load_dwordx4 v[68:71], v1, s[16:19], s77 offen offset:1024 sc1
    s_waitcnt vmcnt(3)
    v_max3_u32 v210, v48, v52, v56
    s_waitcnt vmcnt(2)
    v_max_u32 v210, v210, v60
    v_cmp_eq_u32 vcc, -1, v210
    s_cbranch_vccnz .Lagain_26
    s_branch .Lback_27
.Lagain_28:
    s_sub_u32 s59, s59, 1
    s_cmp_eq_u32 s59, 0
    s_cbranch_scc1 .Lexit
    buffer_load_dwordx4 v[64:67], v1, s[16:19], s77 offen sc1
    buffer_load_dwordx4 v[68:71], v1, s[16:19], s77 offen offset:1024 sc1
    s_waitcnt vmcnt(0)
    v_max_u32 v210, v64, v68
    v_cmp_eq_u32 vcc, -1, v210
    s_cbranch_vccnz .Lagain_28
    s_branch .Lback_29
.Lagain_35:
    s_sub_u32 s59, s59, 1
    s_cmp_eq_u32 s59, 0
    s_cbranch_scc1 .Lexit
    buffer_load_dwordx4 v[16:19], v1, s[16:19], s88 offen sc1
    buffer_load_dwordx4 v[20:23], v1, s[16:19], s88 offen offset:1024 sc1
    buffer_load_dwordx4 v[24:27], v1, s[16:19], s88 offen offset:2048 sc1
    buffer_load_dwordx4 v[28:31], v1, s[16:19], s88 offen offset:3072 sc1
    s_waitcnt vmcnt(9)
    buffer_load_dwordx4 v[32:35], v1, s[16:19], s89 offen sc1
    s_waitcnt vmcnt(9)
    buffer_load_dwordx4 v[36:39], v1, s[16:19], s89 offen offset:1024 sc1
    s_waitcnt vmcnt(9)
    buffer_load_dwordx4 v[40:43], v1, s[16:19], s89 offen offset:2048 sc1
    s_waitcnt vmcnt(9)
    buffer_load_dwordx4 v[44:47], v1, s[16:19], s90 offen sc1
    s_waitcnt vmcnt(9)
    buffer_load_dwordx4 v[48:51], v1, s[16:19], s90 offen offset:1024 sc1
    s_waitcnt vmcnt(9)
    buffer_load_dwordx4 v[52:55], v1, s[16:19], s90 offen offset:2048 sc1
    s_waitcnt vmcnt(7)
    v_max3_u32 v10, v16, v20, v24
    s_waitcnt vmcnt(6)
    v_max_u32 v10, v10, v28
    v_cmp_eq_u32 vcc, -1, v10
    s_cbranch_vccnz .Lagain_35
    s_branch .Lback_36
.Lagain_37:
    s_sub_u32 s59, s59, 1
    s_cmp_eq_u32 s59, 0
    s_cbranch_scc1 .Lexit
    buffer_load_dwordx4 v[32:35], v1, s[16:19], s89 offen sc1
    buffer_load_dwordx4 v[36:39], v1, s[16:19], s89 offen offset:1024 sc1
    buffer_load_dwordx4 v[40:43], v1, s[16:19], s89 offen offset:2048 sc1
    buffer_load_dwordx4 v[44:47], v1, s[16:19], s90 offen sc1
    s_waitcnt vmcnt(9)
    buffer_load_dwordx4 v[48:51], v1, s[16:19], s90 offen offset:1024 sc1
    s_waitcnt vmcnt(9)
    buffer_load_dwordx4 v[52:55], v1, s[16:19], s90 offen offset:2048 sc1
    s_waitcnt vmcnt(9)
    buffer_load_dwordx4 v[56:59], v1, s[16:19], s90 offen offset:3072 sc1
    s_waitcnt vmcnt(9)
    buffer_load_dwordx4 v[60:63], v1, s[16:19], s91 offen sc1
    s_waitcnt vmcnt(9)
    buffer_load_dwordx4 v[64:67], v1, s[16:19], s91 offen offset:1024 sc1
    s_waitcnt vmcnt(9)
    buffer_load_dwordx4 v[68:71], v1, s[16:19], s91 offen offset:2048 sc1
    s_waitcnt vmcnt(7)
    v_max3_u32 v10, v32, v36, v40
    s_waitcnt vmcnt(6)
    v_max_u32 v10, v10, v44
    v_cmp_eq_u32 vcc, -1, v10
    s_cbranch_vccnz .Lagain_37
    s_branch .Lback_38
.Lagain_39:
    s_sub_u32 s59, s59, 1
    s_cmp_eq_u32 s59, 0
    s_cbranch_scc1 .Lexit
    buffer_load_dwordx4 v[48:51], v1, s[16:19], s90 offen offset:1024 sc1
    buffer_load_dwordx4 v[52:55], v1, s[16:19], s90 offen offset:2048 sc1
    buffer_load_dwordx4 v[56:59], v1, s[16:19], s90 offen offset:3072 sc1
    buffer_load_dwordx4 v[60:63], v1, s[16:19], s91 offen sc1
    s_waitcnt vmcnt(9)
    buffer_load_dwordx4 v[64:67], v1, s[16:19], s91 offen offset:1024 sc1
    s_waitcnt vmcnt(9)
    buffer_load_dwordx4 v[68:71], v1, s[16:19], s91 offen offset:2048 sc1
    s_waitcnt vmcnt(9)
    buffer_load_dwordx4 v[72:75], v1, s[16:19], s92 offen sc1
    s_waitcnt vmcnt(9)
    buffer_load_dwordx4 v[76:79], v1, s[16:19], s92 offen offset:1024 sc1
    s_waitcnt vmcnt(9)
    buffer_load_dwordx4 v[80:83], v1, s[16:19], s92 offen offset:2048 sc1
    s_waitcnt vmcnt(9)
    buffer_load_dwordx4 v[84:87], v1, s[16:19], s92 offen offset:3072 sc1
    s_waitcnt vmcnt(7)
    v_max3_u32 v10, v48, v52, v56
    s_waitcnt vmcnt(6)
    v_max_u32 v10, v10, v60
    v_cmp_eq_u32 vcc, -1, v10
    s_cbranch_vccnz .Lagain_39
    s_branch .Lback_40
.Lagain_41:
    s_sub_u32 s59, s59, 1
    s_cmp_eq_u32 s59, 0
    s_cbranch_scc1 .Lexit
    buffer_load_dwordx4 v[64:67], v1, s[16:19], s91 offen offset:1024 sc1
    buffer_load_dwordx4 v[68:71], v1, s[16:19], s91 offen offset:2048 sc1
    buffer_load_dwordx4 v[72:75], v1, s[16:19], s92 offen sc1
    buffer_load_dwordx4 v[76:79], v1, s[16:19], s92 offen offset:1024 sc1
    s_waitcnt vmcnt(9)
    buffer_load_dwordx4 v[80:83], v1, s[16:19], s92 offen offset:2048 sc1
    s_waitcnt vmcnt(9)
    buffer_load_dwordx4 v[84:87], v1, s[16:19], s92 offen offset:3072 sc1
    s_waitcnt vmcnt(9)
    buffer_load_dwordx4 v[88:91], v1, s[16:19], s93 offen sc1
    s_waitcnt vmcnt(9)
    buffer_load_dwordx4 v[92:95], v1, s[16:19], s93 offen offset:1024 sc1
    s_waitcnt vmcnt(9)
    buffer_load_dwordx4 v[96:99], v1, s[16:19], s93 offen offset:2048 sc1
    s_waitcnt vmcnt(9)
    buffer_load_dwordx4 v[100:103], v1, s[16:19], s94 offen sc1
    s_waitcnt vmcnt(7)
    v_max3_u32 v10, v64, v68, v72
    s_waitcnt vmcnt(6)
    v_max_u32 v10, v10, v76
    v_cmp_eq_u32 vcc, -1, v10
    s_cbranch_vccnz .Lagain_41
    s_branch .Lback_42
.Lagain_43:
    s_sub_u32 s59, s59, 1
    s_cmp_eq_u32 s59, 0
    s_cbranch_scc1 .Lexit
    buffer_load_dwordx4 v[80:83], v1, s[16:19], s92 offen offset:2048 sc1
    buffer_load_dwordx4 v[84:87], v1, s[16:19], s92 offen offset:3072 sc1
    buffer_load_dwordx4 v[88:91], v1, s[16:19], s93 offen sc1
    buffer_load_dwordx4 v[92:95], v1, s[16:19], s93 offen offset:1024 sc1
    s_waitcnt vmcnt(9)
    buffer_load_dwordx4 v[96:99], v1, s[16:19], s93 offen offset:2048 sc1
    s_waitcnt vmcnt(9)
    buffer_load_dwordx4 v[100:103], v1, s[16:19], s94 offen sc1
    s_waitcnt vmcnt(9)
    buffer_load_dwordx4 v[104:107], v1, s[16:19], s94 offen offset:1024 sc1
    s_waitcnt vmcnt(9)
    buffer_load_dwordx4 v[108:111], v1, s[16:19], s94 offen offset:2048 sc1
    s_waitcnt vmcnt(9)
    buffer_load_dwordx4 v[112:115], v1, s[16:19], s94 offen offset:3072 sc1
    s_waitcnt vmcnt(9)
    buffer_load_dwordx4 v[116:119], v1, s[16:19], s95 offen sc1
    s_waitcnt vmcnt(7)
    v_max3_u32 v10, v80, v84, v88
    s_waitcnt vmcnt(6)
    v_max_u32 v10, v10, v92
    v_cmp_eq_u32 vcc, -1, v10
    s_cbranch_vccnz .Lagain_43
    s_branch .Lback_44
.Lagain_45:
    s_sub_u32 s59, s59, 1
    s_cmp_eq_u32 s59, 0
    s_cbranch_scc1 .Lexit
    buffer_load_dwordx4 v[96:99], v1, s[16:19], s93 offen offset:2048 sc1
    buffer_load_dwordx4 v[100:103], v1, s[16:19], s94 offen sc1
    buffer_load_dwordx4 v[104:107], v1, s[16:19], s94 offen offset:1024 sc1
    buffer_load_dwordx4 v[108:111], v1, s[16:19], s94 offen offset:2048 sc1
    s_waitcnt vmcnt(7)
    buffer_load_dwordx4 v[112:115], v1, s[16:19], s94 offen offset:3072 sc1
    s_waitcnt vmcnt(7)
    buffer_load_dwordx4 v[116:119], v1, s[16:19], s95 offen sc1
    s_waitcnt vmcnt(7)
    buffer_load_dwordx4 v[120:123], v1, s[16:19], s95 offen offset:1024 sc1
    s_waitcnt vmcnt(7)
    buffer_load_dwordx4 v[124:127], v1, s[16:19], s95 offen offset:2048 sc1
    s_waitcnt vmcnt(5)
    v_max3_u32 v10, v96, v100, v104
    s_waitcnt vmcnt(4)
    v_max_u32 v10, v10, v108
    v_cmp_eq_u32 vcc, -1, v10
    s_cbranch_vccnz .Lagain_45
    s_branch .Lback_46
.Lagain_47:
    s_sub_u32 s59, s59, 1
    s_cmp_eq_u32 s59, 0
    s_cbranch_scc1 .Lexit
    buffer_load_dwordx4 v[112:115], v1, s[16:19], s94 offen offset:3072 sc1
    buffer_load_dwordx4 v[116:119], v1, s[16:19], s95 offen sc1
    buffer_load_dwordx4 v[120:123], v1, s[16:19], s95 offen offset:1024 sc1
    buffer_load_dwordx4 v[124:127], v1, s[16:19], s95 offen offset:2048 sc1
    s_waitcnt vmcnt(1)
    v_max3_u32 v10, v112, v116, v120
    s_waitcnt vmcnt(0)
    v_max_u32 v10, v10, v124
    v_cmp_eq_u32 vcc, -1, v10
    s_cbranch_vccnz .Lagain_47
    s_branch .Lback_48
.Lend:
    s_endpgm
.section .rodata,"a"
.p2align 6
.amdhsa_kernel sequential_preLN__softmax_full_mha__mixer_gmlp__prompt_kernel
  .amdhsa_next_free_vgpr 512
  .amdhsa_next_free_sgpr 102
  .amdhsa_accum_offset 256
  .amdhsa_group_segment_fixed_size 0
  .amdhsa_kernarg_size 88
  .amdhsa_user_sgpr_count 2
  .amdhsa_user_sgpr_kernarg_segment_ptr 1
  .amdhsa_system_sgpr_workgroup_id_x 1
  .amdhsa_float_denorm_mode_32 3
  .amdhsa_ieee_mode 0
.end_amdhsa_kernel
```
